```python
import torch

def _softmax(x, axis=-1):
    return torch.softmax(x, dim=axis)
def _gelu(x):
    return torch.nn.functional.gelu(x, approximate="tanh")
def _silu(x):
    return torch.nn.functional.silu(x)
def _sigmoid(x):
    return torch.sigmoid(x)
def _layernorm(x, axis=-1, eps=1e-5):
    m = x.mean(dim=axis, keepdim=True)
    v = x.var(dim=axis, keepdim=True, unbiased=False)
    return (x - m) / torch.sqrt(v + eps)
def _scatter_add(tgt, idx, src, axis=0):
    return tgt.clone().index_add_(axis, idx, src)
def _segment_sum(src, seg, n):
    out = torch.zeros((n,) + src.shape[1:], dtype=src.dtype)
    return out.index_add_(0, seg, src)
def _pad(x, pw):
    flat = tuple(v for pair in reversed(pw) for v in pair)
    return torch.nn.functional.pad(x, flat)

kernel_name = 'standalone__gqa_block_cached__near_ridge'

def setup_inputs():

    _w = (lambda a: (lambda t: t.to(torch.bfloat16) if t.is_floating_point() else t)(torch.as_tensor(a)))
    B, Sq, D = 8, 192, 640
    Hq, Hkv, Sk, Dh = 32, 32, 2048, 128
    assert Hq % Hkv == 0, (Hq, Hkv)
    return {
        "x": _w((lambda *s: torch.randn(*s, dtype=torch.bfloat16) * 0.8)(B, Sq, D)),
        "k_cache": _w((lambda *s: torch.randn(*s, dtype=torch.bfloat16) * 0.8)(B, Hkv, Sk, Dh)),
        "v_cache": _w((lambda *s: torch.randn(*s, dtype=torch.bfloat16) * 0.05)(B, Hkv, Sk, Dh)),
        "wq": _w((lambda *s: torch.randn(*s, dtype=torch.bfloat16) * 0.8)(D, Hq * Dh) * (D ** -0.5)),
        "wo": _w((lambda *s: torch.randn(*s, dtype=torch.bfloat16) * 0.05)(Hq * Dh, D) * ((Hq * Dh) ** -0.5)),
    }

def reference(x, k_cache, v_cache, wq, wo):
    B, Sq, D = x.shape
    Hq, Dh = 32, 128
    Hkv = k_cache.shape[1]
    rep = Hq // Hkv
    q = (lambda x, *d: x.permute(*d))((x @ wq).reshape(B, Sq, Hq, Dh), 0, 2, 1, 3)
    k = (lambda x, n, axis: torch.repeat_interleave(x, n, dim=axis))(k_cache, rep, axis=1)
    v = (lambda x, n, axis: torch.repeat_interleave(x, n, dim=axis))(v_cache, rep, axis=1)
    scores = torch.einsum("bhqd,bhkd->bhqk", q, k) * (Dh ** -0.5)
    p = _softmax(scores, axis=-1)
    o = torch.einsum("bhqk,bhkd->bhqd", p, v)
    return (lambda x, *d: x.permute(*d))(o, 0, 2, 1, 3).reshape(B, Sq, Hq * Dh) @ wo
```

```asm
; @launch grid=(256,1,1) block=(256,1,1) lds=163840
.amdgcn_target "amdgcn-amd-amdhsa--gfx950"
.text
.globl standalone__gqa_block_cached__near_ridge_kernel
.p2align 8
.type standalone__gqa_block_cached__near_ridge_kernel,@function
standalone__gqa_block_cached__near_ridge_kernel:
    s_cmp_ge_u32 s2, 256
    s_cbranch_scc1 L_k1_end
    s_load_dwordx8 s[32:39], s[0:1], 0
    s_load_dwordx8 s[92:99], s[0:1], 32
    v_lshrrev_b32 v2, 6, v0
    v_and_b32 v1, 63, v0
    s_nop 0
    v_readfirstlane_b32 s24, v2
    s_and_b32 s44, s2, 1
    s_lshl_b32 s44, s44, 2
    s_lshr_b32 s45, s2, 3
    s_and_b32 s30, s45, 3
    s_add_u32 s30, s30, s44
    s_and_b32 s44, s2, 6
    s_lshl_b32 s44, s44, 2
    s_lshr_b32 s31, s45, 2
    s_add_u32 s31, s31, s44
    s_lshl_b32 s44, s30, 5
    s_add_u32 s44, s44, s31
    s_lshr_b32 s45, s44, 13
    s_lshl_b32 s44, s44, 19
    s_lshl_b32 s26, s24, 12
    s_and_b32 s87, s31, 7
    s_and_b32 s88, s30, 3
    s_mul_i32 s88, s88, 3
    s_add_u32 s87, s87, s88
    s_sub_u32 s88, s87, 10
    s_cmp_ge_u32 s87, 10
    s_cselect_b32 s87, s88, s87
    s_mul_i32 s27, s24, 6144
    s_mov_b32 s28, 0x4e800000
    s_mov_b32 s29, 0x3e0293ee
    v_lshrrev_b32 v2, 4, v1
    v_and_b32 v3, 15, v1
    s_and_b32 s47, s24, 1
    v_lshlrev_b32 v6, 2, v2
    v_xor_b32 v6, v6, v3
    v_lshlrev_b32 v6, 4, v6
    s_lshl_b32 s48, s24, 4
    v_add_u32 v7, s48, v2
    v_lshlrev_b32 v7, 13, v7
    v_add_u32 v6, v6, v7
    v_add_u32 v172, 0, v6
    v_add_u32 v173, 31744, v6
    v_add_u32 v174, 63488, v6
    v_add_u32 v175, 95232, v6
    v_lshrrev_b32 v4, 3, v1
    v_and_b32 v5, 7, v1
    v_lshrrev_b32 v6, 1, v4
    v_xor_b32 v6, v6, v5
    v_lshlrev_b32 v6, 4, v6
    s_mul_i32 s48, s24, 48
    v_add_u32 v7, s48, v4
    v_mul_u32_u24 v7, 1280, v7
    v_add_u32 v176, v6, v7
    v_xor_b32 v177, 64, v176
    s_waitcnt lgkmcnt(0)
    s_mov_b32 s40, s98
    s_mov_b32 s41, s99
    s_mov_b32 s100, s92
    s_mov_b32 s101, s93
    s_mov_b32 s46, s94
    s_mov_b32 s50, s95
    s_mov_b32 s56, s96
    s_mov_b32 s57, s97
    s_mov_b32 s58, 256
    s_mov_b32 s59, 0x20000
    s_mov_b32 s20, s40
    s_mov_b32 s21, s41
    s_mov_b32 s22, 23068672
    s_mov_b32 s23, 0x20000
    s_lshl_b32 s3, s30, 2
    s_add_u32 s3, s3, s24
    s_lshl_b32 s3, s3, 5
    s_add_u32 s3, s3, s31
    s_lshl_b32 s3, s3, 2
    s_add_u32 s3, s3, 12582912
    s_or_b32 s48, s2, s24
    s_cmp_lg_u32 s48, 0
    s_cbranch_scc1 L_notok
    s_memrealtime s[48:49]
    s_waitcnt lgkmcnt(0)
    s_or_b32 s48, s48, 1
    v_mov_b32 v4, s48
    s_mov_b64 exec, 1
    buffer_store_dword v4, off, s[56:59], 0 sc1
    s_mov_b64 exec, -1
L_notok:
    s_mul_i32 s48, s30, 245760
    s_add_u32 s12, s32, s48
    s_addc_u32 s13, s33, 0
    s_mov_b32 s14, 245760
    s_mov_b32 s15, 0x20000
    s_lshl_b32 s48, s31, 8
    s_add_u32 s16, s38, s48
    s_addc_u32 s17, s39, 0
    s_sub_u32 s18, 5242880, s48
    s_mov_b32 s19, 0x20000
    s_add_u32 s88, s87, 0
    s_sub_u32 s89, s88, 10
    s_cmp_ge_u32 s88, 10
    s_cselect_b32 s88, s89, s88
    s_lshl_b32 s90, s88, 7
    s_add_u32 m0, s26, 139264
    s_lshl_b32 s88, s88, 19
    buffer_load_dwordx4 v172, s[16:19], s88 offen offset:0 lds
    buffer_load_dwordx4 v173, s[16:19], s88 offen offset:1024 lds
    buffer_load_dwordx4 v174, s[16:19], s88 offen offset:2048 lds
    buffer_load_dwordx4 v175, s[16:19], s88 offen offset:3072 lds
    s_add_u32 m0, s27, 114688
    s_add_u32 s49, s90, 0
    buffer_load_dwordx4 v176, s[12:15], s49 offen lds
    s_add_u32 m0, s27, 115712
    s_add_u32 s49, s90, 10240
    buffer_load_dwordx4 v177, s[12:15], s49 offen lds
    s_add_u32 m0, s27, 116736
    s_add_u32 s49, s90, 20480
    buffer_load_dwordx4 v176, s[12:15], s49 offen lds
    s_add_u32 m0, s27, 117760
    s_add_u32 s49, s90, 30720
    buffer_load_dwordx4 v177, s[12:15], s49 offen lds
    s_add_u32 m0, s27, 118784
    s_add_u32 s49, s90, 40960
    buffer_load_dwordx4 v176, s[12:15], s49 offen lds
    s_add_u32 m0, s27, 119808
    s_add_u32 s49, s90, 51200
    buffer_load_dwordx4 v177, s[12:15], s49 offen lds
    s_lshr_b32 s48, s2, 1
    s_mul_i32 s48, s48, 40960
    s_and_b32 s49, s2, 1
    s_mul_i32 s49, s49, 640
    s_add_u32 s48, s48, s49
    s_add_u32 s52, s100, s48
    s_addc_u32 s53, s101, 0
    s_sub_u32 s54, 5242880, s48
    s_mov_b32 s55, 0x20000
    s_mul_i32 s48, s24, 10240
    s_mul_i32 s49, s24, 5120
    v_add_u32 v4, 0, v1
    v_mul_u32_u24 v7, 1639, v4
    v_lshrrev_b32 v7, 16, v7
    v_mul_u32_u24 v6, 40, v7
    v_sub_u32 v6, v4, v6
    v_lshlrev_b32 v6, 4, v6
    v_mul_u32_u24 v7, 1280, v7
    v_add_u32 v4, v7, v6
    s_add_u32 m0, s49, 0
    s_nop 0
    buffer_load_dwordx4 v4, s[52:55], s48 offen nt lds
    v_add_u32 v4, 64, v1
    v_mul_u32_u24 v7, 1639, v4
    v_lshrrev_b32 v7, 16, v7
    v_mul_u32_u24 v6, 40, v7
    v_sub_u32 v6, v4, v6
    v_lshlrev_b32 v6, 4, v6
    v_mul_u32_u24 v7, 1280, v7
    v_add_u32 v4, v7, v6
    s_add_u32 m0, s49, 1024
    s_nop 0
    buffer_load_dwordx4 v4, s[52:55], s48 offen nt lds
    v_add_u32 v4, 128, v1
    v_mul_u32_u24 v7, 1639, v4
    v_lshrrev_b32 v7, 16, v7
    v_mul_u32_u24 v6, 40, v7
    v_sub_u32 v6, v4, v6
    v_lshlrev_b32 v6, 4, v6
    v_mul_u32_u24 v7, 1280, v7
    v_add_u32 v4, v7, v6
    s_add_u32 m0, s49, 2048
    s_nop 0
    buffer_load_dwordx4 v4, s[52:55], s48 offen nt lds
    v_add_u32 v4, 192, v1
    v_mul_u32_u24 v7, 1639, v4
    v_lshrrev_b32 v7, 16, v7
    v_mul_u32_u24 v6, 40, v7
    v_sub_u32 v6, v4, v6
    v_lshlrev_b32 v6, 4, v6
    v_mul_u32_u24 v7, 1280, v7
    v_add_u32 v4, v7, v6
    s_add_u32 m0, s49, 3072
    s_nop 0
    buffer_load_dwordx4 v4, s[52:55], s48 offen nt lds
    v_add_u32 v4, 256, v1
    v_mul_u32_u24 v7, 1639, v4
    v_lshrrev_b32 v7, 16, v7
    v_mul_u32_u24 v6, 40, v7
    v_sub_u32 v6, v4, v6
    v_lshlrev_b32 v6, 4, v6
    v_mul_u32_u24 v7, 1280, v7
    v_add_u32 v4, v7, v6
    s_add_u32 m0, s49, 4096
    s_nop 0
    buffer_load_dwordx4 v4, s[52:55], s48 offen nt lds
    s_add_u32 s88, s87, 1
    s_sub_u32 s89, s88, 10
    s_cmp_ge_u32 s88, 10
    s_cselect_b32 s88, s89, s88
    s_lshl_b32 s90, s88, 7
    s_add_u32 m0, s26, 57344
    s_lshl_b32 s88, s88, 19
    buffer_load_dwordx4 v172, s[16:19], s88 offen offset:0 lds
    buffer_load_dwordx4 v173, s[16:19], s88 offen offset:1024 lds
    buffer_load_dwordx4 v174, s[16:19], s88 offen offset:2048 lds
    buffer_load_dwordx4 v175, s[16:19], s88 offen offset:3072 lds
    s_add_u32 m0, s27, 32768
    s_add_u32 s49, s90, 0
    buffer_load_dwordx4 v176, s[12:15], s49 offen lds
    s_add_u32 m0, s27, 33792
    s_add_u32 s49, s90, 10240
    buffer_load_dwordx4 v177, s[12:15], s49 offen lds
    s_add_u32 m0, s27, 34816
    s_add_u32 s49, s90, 20480
    buffer_load_dwordx4 v176, s[12:15], s49 offen lds
    s_add_u32 m0, s27, 35840
    s_add_u32 s49, s90, 30720
    buffer_load_dwordx4 v177, s[12:15], s49 offen lds
    s_add_u32 m0, s27, 36864
    s_add_u32 s49, s90, 40960
    buffer_load_dwordx4 v176, s[12:15], s49 offen lds
    s_add_u32 m0, s27, 37888
    s_add_u32 s49, s90, 51200
    buffer_load_dwordx4 v177, s[12:15], s49 offen lds
    s_add_u32 s4, s34, s44
    s_addc_u32 s5, s35, s45
    s_mov_b32 s6, 0x80000
    s_mov_b32 s7, 0x20000
    s_add_u32 s8, s36, s44
    s_addc_u32 s9, s37, s45
    s_mov_b32 s10, 0x80000
    s_mov_b32 s11, 0x20000
    s_lshl_b32 s48, s24, 4
    v_add_u32 v7, s48, v2
    v_lshlrev_b32 v7, 8, v7
    v_xor_b32 v6, v3, v2
    v_xor_b32 v144, 0, v6
    v_lshlrev_b32 v144, 4, v144
    v_add_u32 v144, v144, v7
    v_xor_b32 v145, 4, v6
    v_lshlrev_b32 v145, 4, v145
    v_add_u32 v145, v145, v7
    v_xor_b32 v146, 8, v6
    v_lshlrev_b32 v146, 4, v146
    v_add_u32 v146, v146, v7
    v_xor_b32 v147, 12, v6
    v_lshlrev_b32 v147, 4, v147
    v_add_u32 v147, v147, v7
    v_lshlrev_b32 v6, 1, v2
    v_xor_b32 v6, v6, v3
    v_lshlrev_b32 v6, 4, v6
    v_add_u32 v148, v6, v7
    v_xor_b32 v149, 128, v148
    v_lshrrev_b32 v6, 2, v3
    v_and_b32 v7, 3, v3
    v_lshrrev_b32 v4, 1, v2
    v_lshlrev_b32 v4, 3, v4
    v_add_u32 v4, v4, v6
    v_lshlrev_b32 v4, 8, v4
    v_and_b32 v5, 1, v2
    v_lshlrev_b32 v5, 5, v5
    v_add_u32 v4, v4, v5
    v_lshlrev_b32 v5, 3, v7
    v_add_u32 v4, v4, v5
    v_add_u32 v4, 57344, v4
    s_and_b32 s48, s24, 1
    s_lshl_b32 s48, s48, 1
    v_xor_b32 v5, s48, v6
    v_xor_b32 v164, 0, v5
    v_lshlrev_b32 v164, 6, v164
    v_add_u32 v164, v164, v4
    v_add_u32 v104, 81920, v164
    v_xor_b32 v165, 1, v5
    v_lshlrev_b32 v165, 6, v165
    v_add_u32 v165, v165, v4
    v_add_u32 v105, 81920, v165
    v_and_b32 v4, 31, v1
    v_lshrrev_b32 v5, 1, v4
    v_and_b32 v5, 7, v5
    v_lshrrev_b32 v180, 5, v1
    v_xor_b32 v5, v5, v180
    s_lshr_b32 s48, s24, 1
    s_mul_i32 s48, s48, 96
    v_add_u32 v4, s48, v4
    v_lshlrev_b32 v4, 7, v4
    v_add_u32 v4, 32768, v4
    v_xor_b32 v166, 0, v5
    v_lshlrev_b32 v166, 4, v166
    v_add_u32 v166, v166, v4
    v_add_u32 v106, 81920, v166
    v_xor_b32 v167, 2, v5
    v_lshlrev_b32 v167, 4, v167
    v_add_u32 v167, v167, v4
    v_add_u32 v107, 81920, v167
    v_xor_b32 v168, 4, v5
    v_lshlrev_b32 v168, 4, v168
    v_add_u32 v168, v168, v4
    v_add_u32 v108, 81920, v168
    v_xor_b32 v169, 6, v5
    v_lshlrev_b32 v169, 4, v169
    v_add_u32 v169, v169, v4
    v_add_u32 v109, 81920, v169
    v_lshlrev_b32 v4, 2, v2
    v_add_u32 v4, v4, v6
    v_mul_u32_u24 v5, 640, v4
    v_lshlrev_b32 v114, 3, v7
    v_add_u32 v114, v114, v5
    s_mul_i32 s48, s24, 160
    v_add_u32 v114, s48, v114
    s_and_b32 s48, s2, 1
    s_lshl_b32 s48, s48, 2
    s_add_u32 s48, s48, s24
    s_lshl_b32 s48, s48, 7
    s_lshr_b32 s49, s2, 1
    s_add_u32 s48, s48, s49
    s_mul_i32 s48, s48, 5120
    s_add_u32 s48, s48, 13631488
    v_lshlrev_b32 v115, 4, v1
    v_add_u32 v115, s48, v115
    v_add_u32 v116, 4096, v115
    v_and_b32 v5, 7, v4
    v_lshlrev_b32 v4, 8, v4
    v_lshlrev_b32 v7, 3, v7
    v_add_u32 v4, v4, v7
    v_add_u32 v4, 16384, v4
    v_xor_b32 v128, 0, v5
    v_lshlrev_b32 v128, 5, v128
    v_add_u32 v128, v128, v4
    v_add_u32 v136, 65536, v128
    v_xor_b32 v129, 1, v5
    v_lshlrev_b32 v129, 5, v129
    v_add_u32 v129, v129, v4
    v_add_u32 v137, 65536, v129
    v_xor_b32 v130, 2, v5
    v_lshlrev_b32 v130, 5, v130
    v_add_u32 v130, v130, v4
    v_add_u32 v138, 65536, v130
    v_xor_b32 v131, 3, v5
    v_lshlrev_b32 v131, 5, v131
    v_add_u32 v131, v131, v4
    v_add_u32 v139, 65536, v131
    v_xor_b32 v132, 4, v5
    v_lshlrev_b32 v132, 5, v132
    v_add_u32 v132, v132, v4
    v_add_u32 v140, 65536, v132
    v_xor_b32 v133, 5, v5
    v_lshlrev_b32 v133, 5, v133
    v_add_u32 v133, v133, v4
    v_add_u32 v141, 65536, v133
    v_xor_b32 v134, 6, v5
    v_lshlrev_b32 v134, 5, v134
    v_add_u32 v134, v134, v4
    v_add_u32 v142, 65536, v134
    v_xor_b32 v135, 7, v5
    v_lshlrev_b32 v135, 5, v135
    v_add_u32 v135, v135, v4
    v_add_u32 v143, 65536, v135
    v_xor_b32 v5, v2, v3
    v_lshlrev_b32 v4, 8, v3
    v_xor_b32 v120, 0, v5
    v_lshlrev_b32 v120, 4, v120
    v_add_u32 v120, v120, v4
    v_add_u32 v124, 65536, v120
    v_xor_b32 v121, 4, v5
    v_lshlrev_b32 v121, 4, v121
    v_add_u32 v121, v121, v4
    v_add_u32 v125, 65536, v121
    v_xor_b32 v122, 8, v5
    v_lshlrev_b32 v122, 4, v122
    v_add_u32 v122, v122, v4
    v_add_u32 v126, 65536, v122
    v_xor_b32 v123, 12, v5
    v_lshlrev_b32 v123, 4, v123
    v_add_u32 v123, v123, v4
    v_add_u32 v127, 65536, v123
    s_waitcnt vmcnt(15) lgkmcnt(0)
    s_barrier
    ds_read_b64_tr_b16 v[188:189], v104 offset:0
    ds_read_b64_tr_b16 v[190:191], v104 offset:1024
    ds_read_b128 a[144:147], v106 offset:0
    ds_read_b128 a[148:151], v106 offset:4096
    ds_read_b128 a[152:155], v106 offset:8192
    ds_read_b64_tr_b16 v[192:193], v105 offset:0
    ds_read_b64_tr_b16 v[194:195], v105 offset:1024
    ds_read_b64_tr_b16 v[196:197], v104 offset:4096
    ds_read_b64_tr_b16 v[198:199], v104 offset:5120
    ds_read_b128 a[156:159], v107 offset:0
    ds_read_b128 a[160:163], v107 offset:4096
    ds_read_b128 a[164:167], v107 offset:8192
    ds_read_b64_tr_b16 v[200:201], v105 offset:4096
    ds_read_b64_tr_b16 v[202:203], v105 offset:5120
    s_waitcnt lgkmcnt(0)
    v_mfma_f32_32x32x16_bf16 v[8:23], v[188:191], a[144:147], 0
    ds_read_b64_tr_b16 v[204:205], v104 offset:8192
    ds_read_b64_tr_b16 v[206:207], v104 offset:9216
    s_add_u32 s88, s87, 2
    s_sub_u32 s89, s88, 10
    s_cmp_ge_u32 s88, 10
    s_cselect_b32 s88, s89, s88
    s_lshl_b32 s90, s88, 7
    s_add_u32 m0, s26, 98304
    s_lshl_b32 s88, s88, 19
    buffer_load_dwordx4 v172, s[16:19], s88 offen offset:0 lds
    v_mfma_f32_32x32x16_bf16 v[24:39], v[188:191], a[148:151], 0
    ds_read_b128 a[168:171], v108 offset:0
    ds_read_b128 a[172:175], v108 offset:4096
    buffer_load_dwordx4 v173, s[16:19], s88 offen offset:1024 lds
    v_accvgpr_write_b32 a0, 0
    v_mfma_f32_32x32x16_bf16 v[40:55], v[188:191], a[152:155], 0
    ds_read_b128 a[176:179], v108 offset:8192
    ds_read_b64_tr_b16 v[208:209], v105 offset:8192
    buffer_load_dwordx4 v174, s[16:19], s88 offen offset:2048 lds
    v_accvgpr_write_b32 a1, 0
    v_mfma_f32_32x32x16_bf16 v[56:71], v[192:195], a[144:147], 0
    ds_read_b64_tr_b16 v[210:211], v105 offset:9216
    ds_read_b64_tr_b16 v[212:213], v104 offset:12288
    buffer_load_dwordx4 v175, s[16:19], s88 offen offset:3072 lds
    v_accvgpr_write_b32 a2, 0
    v_mfma_f32_32x32x16_bf16 v[72:87], v[192:195], a[148:151], 0
    ds_read_b64_tr_b16 v[214:215], v104 offset:13312
    ds_read_b128 a[180:183], v109 offset:0
    s_add_u32 m0, s27, 73728
    s_add_u32 s49, s90, 0
    buffer_load_dwordx4 v176, s[12:15], s49 offen lds
    v_mfma_f32_32x32x16_bf16 v[88:103], v[192:195], a[152:155], 0
    ds_read_b128 a[184:187], v109 offset:4096
    ds_read_b128 a[188:191], v109 offset:8192
    v_accvgpr_write_b32 a3, 0
    v_accvgpr_write_b32 a4, 0
    v_mfma_f32_32x32x16_bf16 v[8:23], v[196:199], a[156:159], v[8:23]
    ds_read_b64_tr_b16 v[216:217], v105 offset:12288
    ds_read_b64_tr_b16 v[218:219], v105 offset:13312
    s_add_u32 m0, s27, 74752
    s_add_u32 s49, s90, 10240
    buffer_load_dwordx4 v177, s[12:15], s49 offen lds
    v_mfma_f32_32x32x16_bf16 v[24:39], v[196:199], a[160:163], v[24:39]
    s_add_u32 m0, s27, 75776
    s_add_u32 s49, s90, 20480
    buffer_load_dwordx4 v176, s[12:15], s49 offen lds
    v_accvgpr_write_b32 a5, 0
    v_mfma_f32_32x32x16_bf16 v[40:55], v[196:199], a[164:167], v[40:55]
    s_add_u32 m0, s27, 76800
    s_add_u32 s49, s90, 30720
    buffer_load_dwordx4 v177, s[12:15], s49 offen lds
    v_accvgpr_write_b32 a6, 0
    v_mfma_f32_32x32x16_bf16 v[56:71], v[200:203], a[156:159], v[56:71]
    s_add_u32 m0, s27, 77824
    s_add_u32 s49, s90, 40960
    buffer_load_dwordx4 v176, s[12:15], s49 offen lds
    v_accvgpr_write_b32 a7, 0
    v_mfma_f32_32x32x16_bf16 v[72:87], v[200:203], a[160:163], v[72:87]
    s_add_u32 m0, s27, 78848
    s_add_u32 s49, s90, 51200
    buffer_load_dwordx4 v177, s[12:15], s49 offen lds
    v_accvgpr_write_b32 a8, 0
    v_mfma_f32_32x32x16_bf16 v[88:103], v[200:203], a[164:167], v[88:103]
    v_accvgpr_write_b32 a9, 0
    v_accvgpr_write_b32 a10, 0
    v_accvgpr_write_b32 a11, 0
    v_accvgpr_write_b32 a12, 0
    s_waitcnt vmcnt(10) lgkmcnt(0)
    s_barrier
    v_mfma_f32_32x32x16_bf16 v[8:23], v[204:207], a[168:171], v[8:23]
    ds_read_b64_tr_b16 v[188:189], v164 offset:0
    ds_read_b64_tr_b16 v[190:191], v164 offset:1024
    s_add_u32 s88, s87, 3
    s_sub_u32 s89, s88, 10
    s_cmp_ge_u32 s88, 10
    s_cselect_b32 s88, s89, s88
    s_lshl_b32 s90, s88, 7
    s_add_u32 m0, s26, 139264
    s_lshl_b32 s88, s88, 19
    buffer_load_dwordx4 v172, s[16:19], s88 offen offset:0 lds
    v_mfma_f32_32x32x16_bf16 v[24:39], v[204:207], a[172:175], v[24:39]
    ds_read_b128 a[144:147], v166 offset:0
    ds_read_b128 a[148:151], v166 offset:4096
    v_accvgpr_write_b32 a13, 0
    v_accvgpr_write_b32 a14, 0
    v_mfma_f32_32x32x16_bf16 v[40:55], v[204:207], a[176:179], v[40:55]
    ds_read_b128 a[152:155], v166 offset:8192
    ds_read_b64_tr_b16 v[192:193], v165 offset:0
    buffer_load_dwordx4 v173, s[16:19], s88 offen offset:1024 lds
    v_accvgpr_write_b32 a15, 0
    v_mfma_f32_32x32x16_bf16 v[56:71], v[208:211], a[168:171], v[56:71]
    ds_read_b64_tr_b16 v[194:195], v165 offset:1024
    ds_read_b64_tr_b16 v[196:197], v164 offset:4096
    v_accvgpr_write_b32 a16, 0
    v_accvgpr_write_b32 a17, 0
    v_mfma_f32_32x32x16_bf16 v[72:87], v[208:211], a[172:175], v[72:87]
    ds_read_b64_tr_b16 v[198:199], v164 offset:5120
    ds_read_b128 a[156:159], v167 offset:0
    buffer_load_dwordx4 v174, s[16:19], s88 offen offset:2048 lds
    v_accvgpr_write_b32 a18, 0
    v_mfma_f32_32x32x16_bf16 v[88:103], v[208:211], a[176:179], v[88:103]
    ds_read_b128 a[160:163], v167 offset:4096
    ds_read_b128 a[164:167], v167 offset:8192
    v_accvgpr_write_b32 a19, 0
    v_accvgpr_write_b32 a20, 0
    v_mfma_f32_32x32x16_bf16 v[8:23], v[212:215], a[180:183], v[8:23]
    ds_read_b64_tr_b16 v[200:201], v165 offset:4096
    ds_read_b64_tr_b16 v[202:203], v165 offset:5120
    v_accvgpr_write_b32 a21, 0
    v_accvgpr_write_b32 a22, 0
    v_mfma_f32_32x32x16_bf16 v[24:39], v[212:215], a[184:187], v[24:39]
    buffer_load_dwordx4 v175, s[16:19], s88 offen offset:3072 lds
    v_accvgpr_write_b32 a23, 0
    v_accvgpr_write_b32 a24, 0
    v_accvgpr_write_b32 a25, 0
    v_mfma_f32_32x32x16_bf16 v[40:55], v[212:215], a[188:191], v[40:55]
    v_accvgpr_write_b32 a26, 0
    v_accvgpr_write_b32 a27, 0
    v_accvgpr_write_b32 a28, 0
    v_accvgpr_write_b32 a29, 0
    v_mfma_f32_32x32x16_bf16 v[56:71], v[216:219], a[180:183], v[56:71]
    s_add_u32 m0, s27, 114688
    s_add_u32 s49, s90, 0
    buffer_load_dwordx4 v176, s[12:15], s49 offen lds
    v_accvgpr_write_b32 a30, 0
    v_mfma_f32_32x32x16_bf16 v[72:87], v[216:219], a[184:187], v[72:87]
    v_accvgpr_write_b32 a31, 0
    v_accvgpr_write_b32 a32, 0
    v_accvgpr_write_b32 a33, 0
    v_accvgpr_write_b32 a34, 0
    v_mfma_f32_32x32x16_bf16 v[88:103], v[216:219], a[188:191], v[88:103]
    v_accvgpr_write_b32 a35, 0
    v_accvgpr_write_b32 a36, 0
    v_accvgpr_write_b32 a37, 0
    v_accvgpr_write_b32 a38, 0
    s_waitcnt lgkmcnt(0)
    v_mfma_f32_32x32x16_bf16 v[8:23], v[188:191], a[144:147], v[8:23]
    ds_read_b64_tr_b16 v[204:205], v164 offset:8192
    ds_read_b64_tr_b16 v[206:207], v164 offset:9216
    s_add_u32 m0, s27, 115712
    s_add_u32 s49, s90, 10240
    buffer_load_dwordx4 v177, s[12:15], s49 offen lds
    v_mfma_f32_32x32x16_bf16 v[24:39], v[188:191], a[148:151], v[24:39]
    ds_read_b128 a[168:171], v168 offset:0
    ds_read_b128 a[172:175], v168 offset:4096
    v_accvgpr_write_b32 a39, 0
    v_accvgpr_write_b32 a40, 0
    v_mfma_f32_32x32x16_bf16 v[40:55], v[188:191], a[152:155], v[40:55]
    ds_read_b128 a[176:179], v168 offset:8192
    ds_read_b64_tr_b16 v[208:209], v165 offset:8192
    s_add_u32 m0, s27, 116736
    s_add_u32 s49, s90, 20480
    buffer_load_dwordx4 v176, s[12:15], s49 offen lds
    v_mfma_f32_32x32x16_bf16 v[56:71], v[192:195], a[144:147], v[56:71]
    ds_read_b64_tr_b16 v[210:211], v165 offset:9216
    ds_read_b64_tr_b16 v[212:213], v164 offset:12288
    v_accvgpr_write_b32 a41, 0
    v_accvgpr_write_b32 a42, 0
    v_mfma_f32_32x32x16_bf16 v[72:87], v[192:195], a[148:151], v[72:87]
    ds_read_b64_tr_b16 v[214:215], v164 offset:13312
    ds_read_b128 a[180:183], v169 offset:0
    s_add_u32 m0, s27, 117760
    s_add_u32 s49, s90, 30720
    buffer_load_dwordx4 v177, s[12:15], s49 offen lds
    v_mfma_f32_32x32x16_bf16 v[88:103], v[192:195], a[152:155], v[88:103]
    ds_read_b128 a[184:187], v169 offset:4096
    ds_read_b128 a[188:191], v169 offset:8192
    v_accvgpr_write_b32 a43, 0
    v_accvgpr_write_b32 a44, 0
    v_mfma_f32_32x32x16_bf16 v[8:23], v[196:199], a[156:159], v[8:23]
    ds_read_b64_tr_b16 v[216:217], v165 offset:12288
    ds_read_b64_tr_b16 v[218:219], v165 offset:13312
    v_accvgpr_write_b32 a45, 0
    v_accvgpr_write_b32 a46, 0
    v_mfma_f32_32x32x16_bf16 v[24:39], v[196:199], a[160:163], v[24:39]
    s_add_u32 m0, s27, 118784
    s_add_u32 s49, s90, 40960
    buffer_load_dwordx4 v176, s[12:15], s49 offen lds
    v_accvgpr_write_b32 a47, 0
    v_mfma_f32_32x32x16_bf16 v[40:55], v[196:199], a[164:167], v[40:55]
    v_accvgpr_write_b32 a48, 0
    v_accvgpr_write_b32 a49, 0
    v_accvgpr_write_b32 a50, 0
    v_accvgpr_write_b32 a51, 0
    v_mfma_f32_32x32x16_bf16 v[56:71], v[200:203], a[156:159], v[56:71]
    s_add_u32 m0, s27, 119808
    s_add_u32 s49, s90, 51200
    buffer_load_dwordx4 v177, s[12:15], s49 offen lds
    v_accvgpr_write_b32 a52, 0
    v_mfma_f32_32x32x16_bf16 v[72:87], v[200:203], a[160:163], v[72:87]
    v_accvgpr_write_b32 a53, 0
    v_accvgpr_write_b32 a54, 0
    v_accvgpr_write_b32 a55, 0
    v_accvgpr_write_b32 a56, 0
    v_mfma_f32_32x32x16_bf16 v[88:103], v[200:203], a[164:167], v[88:103]
    v_accvgpr_write_b32 a57, 0
    v_accvgpr_write_b32 a58, 0
    v_accvgpr_write_b32 a59, 0
    v_accvgpr_write_b32 a60, 0
    s_waitcnt vmcnt(10) lgkmcnt(0)
    s_barrier
    v_mfma_f32_32x32x16_bf16 v[8:23], v[204:207], a[168:171], v[8:23]
    ds_read_b64_tr_b16 v[188:189], v164 offset:40960
    ds_read_b64_tr_b16 v[190:191], v164 offset:41984
    ds_read_b128 a[144:147], v166 offset:40960
    s_add_u32 s88, s87, 4
    s_sub_u32 s89, s88, 10
    s_cmp_ge_u32 s88, 10
    s_cselect_b32 s88, s89, s88
    s_lshl_b32 s90, s88, 7
    s_add_u32 m0, s26, 57344
    s_lshl_b32 s88, s88, 19
    buffer_load_dwordx4 v172, s[16:19], s88 offen offset:0 lds
    v_mfma_f32_32x32x16_bf16 v[24:39], v[204:207], a[172:175], v[24:39]
    ds_read_b128 a[148:151], v166 offset:45056
    ds_read_b128 a[152:155], v166 offset:49152
    ds_read_b64_tr_b16 v[192:193], v165 offset:40960
    v_accvgpr_write_b32 a61, 0
    v_mfma_f32_32x32x16_bf16 v[40:55], v[204:207], a[176:179], v[40:55]
    ds_read_b64_tr_b16 v[194:195], v165 offset:41984
    ds_read_b64_tr_b16 v[196:197], v164 offset:45056
    ds_read_b64_tr_b16 v[198:199], v164 offset:46080
    buffer_load_dwordx4 v173, s[16:19], s88 offen offset:1024 lds
    v_mfma_f32_32x32x16_bf16 v[56:71], v[208:211], a[168:171], v[56:71]
    ds_read_b128 a[156:159], v167 offset:40960
    ds_read_b128 a[160:163], v167 offset:45056
    ds_read_b128 a[164:167], v167 offset:49152
    v_accvgpr_write_b32 a62, 0
    v_mfma_f32_32x32x16_bf16 v[72:87], v[208:211], a[172:175], v[72:87]
    ds_read_b64_tr_b16 v[200:201], v165 offset:45056
    ds_read_b64_tr_b16 v[202:203], v165 offset:46080
    ds_read_b64_tr_b16 a[192:193], v114 offset:0
    buffer_load_dwordx4 v174, s[16:19], s88 offen offset:2048 lds
    v_mfma_f32_32x32x16_bf16 v[88:103], v[208:211], a[176:179], v[88:103]
    ds_read_b64_tr_b16 a[194:195], v114 offset:10240
    ds_read_b64_tr_b16 a[196:197], v114 offset:32
    ds_read_b64_tr_b16 a[198:199], v114 offset:10272
    v_accvgpr_write_b32 a63, 0
    v_mfma_f32_32x32x16_bf16 v[8:23], v[212:215], a[180:183], v[8:23]
    ds_read_b64_tr_b16 a[200:201], v114 offset:64
    ds_read_b64_tr_b16 a[202:203], v114 offset:10304
    ds_read_b64_tr_b16 a[204:205], v114 offset:96
    v_accvgpr_write_b32 a64, 0
    v_mfma_f32_32x32x16_bf16 v[24:39], v[212:215], a[184:187], v[24:39]
    ds_read_b64_tr_b16 a[206:207], v114 offset:10336
    ds_read_b64_tr_b16 a[208:209], v114 offset:128
    ds_read_b64_tr_b16 a[210:211], v114 offset:10368
    buffer_load_dwordx4 v175, s[16:19], s88 offen offset:3072 lds
    v_mfma_f32_32x32x16_bf16 v[40:55], v[212:215], a[188:191], v[40:55]
    v_accvgpr_write_b32 a65, 0
    v_accvgpr_write_b32 a66, 0
    v_accvgpr_write_b32 a67, 0
    v_accvgpr_write_b32 a68, 0
    v_mfma_f32_32x32x16_bf16 v[56:71], v[216:219], a[180:183], v[56:71]
    s_add_u32 m0, s27, 32768
    s_add_u32 s49, s90, 0
    buffer_load_dwordx4 v176, s[12:15], s49 offen lds
    v_accvgpr_write_b32 a69, 0
    v_mfma_f32_32x32x16_bf16 v[72:87], v[216:219], a[184:187], v[72:87]
    v_accvgpr_write_b32 a70, 0
    v_accvgpr_write_b32 a71, 0
    v_accvgpr_write_b32 a72, 0
    v_accvgpr_write_b32 a73, 0
    v_mfma_f32_32x32x16_bf16 v[88:103], v[216:219], a[188:191], v[88:103]
    v_accvgpr_write_b32 a74, 0
    v_accvgpr_write_b32 a75, 0
    v_accvgpr_write_b32 a76, 0
    v_accvgpr_write_b32 a77, 0
    s_waitcnt lgkmcnt(0)
    v_mfma_f32_32x32x16_bf16 v[8:23], v[188:191], a[144:147], v[8:23]
    ds_read_b64_tr_b16 v[204:205], v164 offset:49152
    ds_read_b64_tr_b16 v[206:207], v164 offset:50176
    s_add_u32 m0, s27, 33792
    s_add_u32 s49, s90, 10240
    buffer_load_dwordx4 v177, s[12:15], s49 offen lds
    v_mfma_f32_32x32x16_bf16 v[24:39], v[188:191], a[148:151], v[24:39]
    ds_read_b128 a[168:171], v168 offset:40960
    ds_read_b128 a[172:175], v168 offset:45056
    v_accvgpr_write_b32 a78, 0
    v_accvgpr_write_b32 a79, 0
    v_mfma_f32_32x32x16_bf16 v[40:55], v[188:191], a[152:155], v[40:55]
    ds_read_b128 a[176:179], v168 offset:49152
    ds_read_b64_tr_b16 v[208:209], v165 offset:49152
    s_add_u32 m0, s27, 34816
    s_add_u32 s49, s90, 20480
    buffer_load_dwordx4 v176, s[12:15], s49 offen lds
    v_mfma_f32_32x32x16_bf16 v[56:71], v[192:195], a[144:147], v[56:71]
    ds_read_b64_tr_b16 v[210:211], v165 offset:50176
    ds_read_b64_tr_b16 v[212:213], v164 offset:53248
    v_accvgpr_write_b32 a80, 0
    v_accvgpr_write_b32 a81, 0
    v_mfma_f32_32x32x16_bf16 v[72:87], v[192:195], a[148:151], v[72:87]
    ds_read_b64_tr_b16 v[214:215], v164 offset:54272
    ds_read_b128 a[180:183], v169 offset:40960
    s_add_u32 m0, s27, 35840
    s_add_u32 s49, s90, 30720
    buffer_load_dwordx4 v177, s[12:15], s49 offen lds
    v_mfma_f32_32x32x16_bf16 v[88:103], v[192:195], a[152:155], v[88:103]
    ds_read_b128 a[184:187], v169 offset:45056
    ds_read_b128 a[188:191], v169 offset:49152
    v_accvgpr_write_b32 a82, 0
    v_accvgpr_write_b32 a83, 0
    v_mfma_f32_32x32x16_bf16 v[8:23], v[196:199], a[156:159], v[8:23]
    ds_read_b64_tr_b16 v[216:217], v165 offset:53248
    ds_read_b64_tr_b16 v[218:219], v165 offset:54272
    v_accvgpr_write_b32 a84, 0
    v_accvgpr_write_b32 a85, 0
    v_mfma_f32_32x32x16_bf16 v[24:39], v[196:199], a[160:163], v[24:39]
    s_add_u32 m0, s27, 36864
    s_add_u32 s49, s90, 40960
    buffer_load_dwordx4 v176, s[12:15], s49 offen lds
    v_accvgpr_write_b32 a86, 0
    v_mfma_f32_32x32x16_bf16 v[40:55], v[196:199], a[164:167], v[40:55]
    v_accvgpr_write_b32 a87, 0
    v_accvgpr_write_b32 a88, 0
    v_accvgpr_write_b32 a89, 0
    v_accvgpr_write_b32 a90, 0
    v_mfma_f32_32x32x16_bf16 v[56:71], v[200:203], a[156:159], v[56:71]
    s_add_u32 m0, s27, 37888
    s_add_u32 s49, s90, 51200
    buffer_load_dwordx4 v177, s[12:15], s49 offen lds
    v_accvgpr_write_b32 a91, 0
    v_mfma_f32_32x32x16_bf16 v[72:87], v[200:203], a[160:163], v[72:87]
    v_accvgpr_write_b32 a92, 0
    v_accvgpr_write_b32 a93, 0
    v_accvgpr_write_b32 a94, 0
    v_accvgpr_write_b32 a95, 0
    v_mfma_f32_32x32x16_bf16 v[88:103], v[200:203], a[164:167], v[88:103]
    v_mov_b32 v152, 0
    v_mov_b32 v153, 0
    v_mov_b32 v154, 0
    s_waitcnt vmcnt(10) lgkmcnt(0)
    s_barrier
    v_mfma_f32_32x32x16_bf16 v[8:23], v[204:207], a[168:171], v[8:23]
    ds_read_b64_tr_b16 v[188:189], v104 offset:0
    ds_read_b64_tr_b16 v[190:191], v104 offset:1024
    s_add_u32 s88, s87, 5
    s_sub_u32 s89, s88, 10
    s_cmp_ge_u32 s88, 10
    s_cselect_b32 s88, s89, s88
    s_lshl_b32 s90, s88, 7
    s_add_u32 m0, s26, 98304
    s_lshl_b32 s88, s88, 19
    buffer_load_dwordx4 v172, s[16:19], s88 offen offset:0 lds
    v_mfma_f32_32x32x16_bf16 v[24:39], v[204:207], a[172:175], v[24:39]
    ds_read_b128 a[144:147], v106 offset:0
    ds_read_b128 a[148:151], v106 offset:4096
    buffer_load_dwordx4 v173, s[16:19], s88 offen offset:1024 lds
    v_mfma_f32_32x32x16_bf16 v[40:55], v[204:207], a[176:179], v[40:55]
    ds_read_b128 a[152:155], v106 offset:8192
    ds_read_b64_tr_b16 v[192:193], v105 offset:0
    v_mfma_f32_32x32x16_bf16 v[56:71], v[208:211], a[168:171], v[56:71]
    ds_read_b64_tr_b16 v[194:195], v105 offset:1024
    ds_read_b64_tr_b16 v[196:197], v104 offset:4096
    buffer_load_dwordx4 v174, s[16:19], s88 offen offset:2048 lds
    v_mfma_f32_32x32x16_bf16 v[72:87], v[208:211], a[172:175], v[72:87]
    ds_read_b64_tr_b16 v[198:199], v104 offset:5120
    ds_read_b128 a[156:159], v107 offset:0
    v_mfma_f32_32x32x16_bf16 v[88:103], v[208:211], a[176:179], v[88:103]
    ds_read_b128 a[160:163], v107 offset:4096
    ds_read_b128 a[164:167], v107 offset:8192
    buffer_load_dwordx4 v175, s[16:19], s88 offen offset:3072 lds
    v_mfma_f32_32x32x16_bf16 v[8:23], v[212:215], a[180:183], v[8:23]
    ds_read_b64_tr_b16 v[200:201], v105 offset:4096
    ds_read_b64_tr_b16 v[202:203], v105 offset:5120
    s_add_u32 m0, s27, 73728
    s_add_u32 s49, s90, 0
    buffer_load_dwordx4 v176, s[12:15], s49 offen lds
    v_mfma_f32_32x32x16_bf16 v[24:39], v[212:215], a[184:187], v[24:39]
    v_mfma_f32_32x32x16_bf16 v[40:55], v[212:215], a[188:191], v[40:55]
    s_add_u32 m0, s27, 74752
    s_add_u32 s49, s90, 10240
    buffer_load_dwordx4 v177, s[12:15], s49 offen lds
    v_mfma_f32_32x32x16_bf16 v[56:71], v[216:219], a[180:183], v[56:71]
    v_mfma_f32_32x32x16_bf16 v[72:87], v[216:219], a[184:187], v[72:87]
    s_add_u32 m0, s27, 75776
    s_add_u32 s49, s90, 20480
    buffer_load_dwordx4 v176, s[12:15], s49 offen lds
    v_mfma_f32_32x32x16_bf16 v[88:103], v[216:219], a[188:191], v[88:103]
    s_waitcnt lgkmcnt(0)
    v_mfma_f32_32x32x16_bf16 v[8:23], v[188:191], a[144:147], v[8:23]
    ds_read_b64_tr_b16 v[204:205], v104 offset:8192
    ds_read_b64_tr_b16 v[206:207], v104 offset:9216
    s_add_u32 m0, s27, 76800
    s_add_u32 s49, s90, 30720
    buffer_load_dwordx4 v177, s[12:15], s49 offen lds
    v_mfma_f32_32x32x16_bf16 v[24:39], v[188:191], a[148:151], v[24:39]
    ds_read_b128 a[168:171], v108 offset:0
    ds_read_b128 a[172:175], v108 offset:4096
    s_add_u32 m0, s27, 77824
    s_add_u32 s49, s90, 40960
    buffer_load_dwordx4 v176, s[12:15], s49 offen lds
    v_mfma_f32_32x32x16_bf16 v[40:55], v[188:191], a[152:155], v[40:55]
    ds_read_b128 a[176:179], v108 offset:8192
    ds_read_b64_tr_b16 v[208:209], v105 offset:8192
    v_mfma_f32_32x32x16_bf16 v[56:71], v[192:195], a[144:147], v[56:71]
    ds_read_b64_tr_b16 v[210:211], v105 offset:9216
    ds_read_b64_tr_b16 v[212:213], v104 offset:12288
    s_add_u32 m0, s27, 78848
    s_add_u32 s49, s90, 51200
    buffer_load_dwordx4 v177, s[12:15], s49 offen lds
    v_mfma_f32_32x32x16_bf16 v[72:87], v[192:195], a[148:151], v[72:87]
    ds_read_b64_tr_b16 v[214:215], v104 offset:13312
    ds_read_b128 a[180:183], v109 offset:0
    v_mfma_f32_32x32x16_bf16 v[88:103], v[192:195], a[152:155], v[88:103]
    ds_read_b128 a[184:187], v109 offset:4096
    ds_read_b128 a[188:191], v109 offset:8192
    s_add_u32 m0, s26, 0
    s_mov_b32 s49, 0
    buffer_load_dwordx4 v144, s[4:7], s49 offen offset:0 nt lds
    v_mfma_f32_32x32x16_bf16 v[8:23], v[196:199], a[156:159], v[8:23]
    ds_read_b64_tr_b16 v[216:217], v105 offset:12288
    ds_read_b64_tr_b16 v[218:219], v105 offset:13312
    buffer_load_dwordx4 v145, s[4:7], s49 offen offset:1024 nt lds
    v_mfma_f32_32x32x16_bf16 v[24:39], v[196:199], a[160:163], v[24:39]
    v_mfma_f32_32x32x16_bf16 v[40:55], v[196:199], a[164:167], v[40:55]
    buffer_load_dwordx4 v146, s[4:7], s49 offen offset:2048 nt lds
    v_mfma_f32_32x32x16_bf16 v[56:71], v[200:203], a[156:159], v[56:71]
    v_mfma_f32_32x32x16_bf16 v[72:87], v[200:203], a[160:163], v[72:87]
    buffer_load_dwordx4 v147, s[4:7], s49 offen offset:3072 nt lds
    v_mfma_f32_32x32x16_bf16 v[88:103], v[200:203], a[164:167], v[88:103]
    s_waitcnt vmcnt(14) lgkmcnt(0)
    s_barrier
    v_mfma_f32_32x32x16_bf16 v[8:23], v[204:207], a[168:171], v[8:23]
    ds_read_b64_tr_b16 v[188:189], v164 offset:0
    ds_read_b64_tr_b16 v[190:191], v164 offset:1024
    s_add_u32 s88, s87, 6
    s_sub_u32 s89, s88, 10
    s_cmp_ge_u32 s88, 10
    s_cselect_b32 s88, s89, s88
    s_lshl_b32 s90, s88, 7
    s_add_u32 m0, s26, 139264
    s_lshl_b32 s88, s88, 19
    buffer_load_dwordx4 v172, s[16:19], s88 offen offset:0 lds
    v_mfma_f32_32x32x16_bf16 v[24:39], v[204:207], a[172:175], v[24:39]
    ds_read_b128 a[144:147], v166 offset:0
    ds_read_b128 a[148:151], v166 offset:4096
    buffer_load_dwordx4 v173, s[16:19], s88 offen offset:1024 lds
    v_mfma_f32_32x32x16_bf16 v[40:55], v[204:207], a[176:179], v[40:55]
    ds_read_b128 a[152:155], v166 offset:8192
    ds_read_b64_tr_b16 v[192:193], v165 offset:0
    v_mfma_f32_32x32x16_bf16 v[56:71], v[208:211], a[168:171], v[56:71]
    ds_read_b64_tr_b16 v[194:195], v165 offset:1024
    ds_read_b64_tr_b16 v[196:197], v164 offset:4096
    buffer_load_dwordx4 v174, s[16:19], s88 offen offset:2048 lds
    v_mfma_f32_32x32x16_bf16 v[72:87], v[208:211], a[172:175], v[72:87]
    ds_read_b64_tr_b16 v[198:199], v164 offset:5120
    ds_read_b128 a[156:159], v167 offset:0
    buffer_load_dwordx4 v175, s[16:19], s88 offen offset:3072 lds
    v_mfma_f32_32x32x16_bf16 v[88:103], v[208:211], a[176:179], v[88:103]
    ds_read_b128 a[160:163], v167 offset:4096
    ds_read_b128 a[164:167], v167 offset:8192
    v_mfma_f32_32x32x16_bf16 v[8:23], v[212:215], a[180:183], v[8:23]
    ds_read_b64_tr_b16 v[200:201], v165 offset:4096
    ds_read_b64_tr_b16 v[202:203], v165 offset:5120
    s_add_u32 m0, s27, 114688
    s_add_u32 s49, s90, 0
    buffer_load_dwordx4 v176, s[12:15], s49 offen lds
    v_mfma_f32_32x32x16_bf16 v[24:39], v[212:215], a[184:187], v[24:39]
    s_add_u32 m0, s27, 115712
    s_add_u32 s49, s90, 10240
    buffer_load_dwordx4 v177, s[12:15], s49 offen lds
    v_mfma_f32_32x32x16_bf16 v[40:55], v[212:215], a[188:191], v[40:55]
    v_mfma_f32_32x32x16_bf16 v[56:71], v[216:219], a[180:183], v[56:71]
    s_add_u32 m0, s27, 116736
    s_add_u32 s49, s90, 20480
    buffer_load_dwordx4 v176, s[12:15], s49 offen lds
    v_mfma_f32_32x32x16_bf16 v[72:87], v[216:219], a[184:187], v[72:87]
    s_add_u32 m0, s27, 117760
    s_add_u32 s49, s90, 30720
    buffer_load_dwordx4 v177, s[12:15], s49 offen lds
    v_mfma_f32_32x32x16_bf16 v[88:103], v[216:219], a[188:191], v[88:103]
    s_waitcnt lgkmcnt(0)
    v_mfma_f32_32x32x16_bf16 v[8:23], v[188:191], a[144:147], v[8:23]
    ds_read_b64_tr_b16 v[204:205], v164 offset:8192
    ds_read_b64_tr_b16 v[206:207], v164 offset:9216
    s_add_u32 m0, s27, 118784
    s_add_u32 s49, s90, 40960
    buffer_load_dwordx4 v176, s[12:15], s49 offen lds
    v_mfma_f32_32x32x16_bf16 v[24:39], v[188:191], a[148:151], v[24:39]
    ds_read_b128 a[168:171], v168 offset:0
    ds_read_b128 a[172:175], v168 offset:4096
    s_add_u32 m0, s27, 119808
    s_add_u32 s49, s90, 51200
    buffer_load_dwordx4 v177, s[12:15], s49 offen lds
    v_mfma_f32_32x32x16_bf16 v[40:55], v[188:191], a[152:155], v[40:55]
    ds_read_b128 a[176:179], v168 offset:8192
    ds_read_b64_tr_b16 v[208:209], v165 offset:8192
    v_mfma_f32_32x32x16_bf16 v[56:71], v[192:195], a[144:147], v[56:71]
    ds_read_b64_tr_b16 v[210:211], v165 offset:9216
    ds_read_b64_tr_b16 v[212:213], v164 offset:12288
    buffer_load_dword v255, off, s[56:59], 0
    v_mfma_f32_32x32x16_bf16 v[72:87], v[192:195], a[148:151], v[72:87]
    ds_read_b64_tr_b16 v[214:215], v164 offset:13312
    ds_read_b128 a[180:183], v169 offset:0
    v_mfma_f32_32x32x16_bf16 v[88:103], v[192:195], a[152:155], v[88:103]
    ds_read_b128 a[184:187], v169 offset:4096
    ds_read_b128 a[188:191], v169 offset:8192
    s_add_u32 m0, s26, 16384
    s_mov_b32 s49, 0
    buffer_load_dwordx4 v148, s[8:11], s49 offen offset:0 nt lds
    v_mfma_f32_32x32x16_bf16 v[8:23], v[196:199], a[156:159], v[8:23]
    ds_read_b64_tr_b16 v[216:217], v165 offset:12288
    ds_read_b64_tr_b16 v[218:219], v165 offset:13312
    buffer_load_dwordx4 v149, s[8:11], s49 offen offset:1024 nt lds
    v_mfma_f32_32x32x16_bf16 v[24:39], v[196:199], a[160:163], v[24:39]
    v_mfma_f32_32x32x16_bf16 v[40:55], v[196:199], a[164:167], v[40:55]
    buffer_load_dwordx4 v148, s[8:11], s49 offen offset:2048 nt lds
    v_mfma_f32_32x32x16_bf16 v[56:71], v[200:203], a[156:159], v[56:71]
    v_mfma_f32_32x32x16_bf16 v[72:87], v[200:203], a[160:163], v[72:87]
    buffer_load_dwordx4 v149, s[8:11], s49 offen offset:3072 nt lds
    v_mfma_f32_32x32x16_bf16 v[88:103], v[200:203], a[164:167], v[88:103]
    s_waitcnt vmcnt(19) lgkmcnt(0)
    s_barrier
    v_mfma_f32_32x32x16_bf16 v[8:23], v[204:207], a[168:171], v[8:23]
    ds_read_b64_tr_b16 v[188:189], v164 offset:40960
    ds_read_b64_tr_b16 v[190:191], v164 offset:41984
    s_add_u32 s88, s87, 7
    s_sub_u32 s89, s88, 10
    s_cmp_ge_u32 s88, 10
    s_cselect_b32 s88, s89, s88
    s_lshl_b32 s90, s88, 7
    s_add_u32 m0, s26, 57344
    s_lshl_b32 s88, s88, 19
    buffer_load_dwordx4 v172, s[16:19], s88 offen offset:0 lds
    v_mfma_f32_32x32x16_bf16 v[24:39], v[204:207], a[172:175], v[24:39]
    ds_read_b128 a[144:147], v166 offset:40960
    ds_read_b128 a[148:151], v166 offset:45056
    buffer_load_dwordx4 v173, s[16:19], s88 offen offset:1024 lds
    v_mfma_f32_32x32x16_bf16 v[40:55], v[204:207], a[176:179], v[40:55]
    ds_read_b128 a[152:155], v166 offset:49152
    ds_read_b64_tr_b16 v[192:193], v165 offset:40960
    v_mfma_f32_32x32x16_bf16 v[56:71], v[208:211], a[168:171], v[56:71]
    ds_read_b64_tr_b16 v[194:195], v165 offset:41984
    ds_read_b64_tr_b16 v[196:197], v164 offset:45056
    buffer_load_dwordx4 v174, s[16:19], s88 offen offset:2048 lds
    v_mfma_f32_32x32x16_bf16 v[72:87], v[208:211], a[172:175], v[72:87]
    ds_read_b64_tr_b16 v[198:199], v164 offset:46080
    ds_read_b128 a[156:159], v167 offset:40960
    buffer_load_dwordx4 v175, s[16:19], s88 offen offset:3072 lds
    v_mfma_f32_32x32x16_bf16 v[88:103], v[208:211], a[176:179], v[88:103]
    ds_read_b128 a[160:163], v167 offset:45056
    ds_read_b128 a[164:167], v167 offset:49152
    v_mfma_f32_32x32x16_bf16 v[8:23], v[212:215], a[180:183], v[8:23]
    ds_read_b64_tr_b16 v[200:201], v165 offset:45056
    ds_read_b64_tr_b16 v[202:203], v165 offset:46080
    s_add_u32 m0, s27, 32768
    s_add_u32 s49, s90, 0
    buffer_load_dwordx4 v176, s[12:15], s49 offen lds
    v_mfma_f32_32x32x16_bf16 v[24:39], v[212:215], a[184:187], v[24:39]
    s_add_u32 m0, s27, 33792
    s_add_u32 s49, s90, 10240
    buffer_load_dwordx4 v177, s[12:15], s49 offen lds
    v_mfma_f32_32x32x16_bf16 v[40:55], v[212:215], a[188:191], v[40:55]
    v_mfma_f32_32x32x16_bf16 v[56:71], v[216:219], a[180:183], v[56:71]
    s_add_u32 m0, s27, 34816
    s_add_u32 s49, s90, 20480
    buffer_load_dwordx4 v176, s[12:15], s49 offen lds
    v_mfma_f32_32x32x16_bf16 v[72:87], v[216:219], a[184:187], v[72:87]
    s_add_u32 m0, s27, 35840
    s_add_u32 s49, s90, 30720
    buffer_load_dwordx4 v177, s[12:15], s49 offen lds
    v_mfma_f32_32x32x16_bf16 v[88:103], v[216:219], a[188:191], v[88:103]
    s_waitcnt lgkmcnt(0)
    v_mfma_f32_32x32x16_bf16 v[8:23], v[188:191], a[144:147], v[8:23]
    ds_read_b64_tr_b16 v[204:205], v164 offset:49152
    ds_read_b64_tr_b16 v[206:207], v164 offset:50176
    s_add_u32 m0, s27, 36864
    s_add_u32 s49, s90, 40960
    buffer_load_dwordx4 v176, s[12:15], s49 offen lds
    v_mfma_f32_32x32x16_bf16 v[24:39], v[188:191], a[148:151], v[24:39]
    ds_read_b128 a[168:171], v168 offset:40960
    ds_read_b128 a[172:175], v168 offset:45056
    s_add_u32 m0, s27, 37888
    s_add_u32 s49, s90, 51200
    buffer_load_dwordx4 v177, s[12:15], s49 offen lds
    v_mfma_f32_32x32x16_bf16 v[40:55], v[188:191], a[152:155], v[40:55]
    ds_read_b128 a[176:179], v168 offset:49152
    ds_read_b64_tr_b16 v[208:209], v165 offset:49152
    v_mfma_f32_32x32x16_bf16 v[56:71], v[192:195], a[144:147], v[56:71]
    ds_read_b64_tr_b16 v[210:211], v165 offset:50176
    ds_read_b64_tr_b16 v[212:213], v164 offset:53248
    buffer_store_dwordx4 a[192:195], v115, s[20:23], 0 offen offset:0 sc1
    v_mfma_f32_32x32x16_bf16 v[72:87], v[192:195], a[148:151], v[72:87]
    ds_read_b64_tr_b16 v[214:215], v164 offset:54272
    ds_read_b128 a[180:183], v169 offset:40960
    v_mfma_f32_32x32x16_bf16 v[88:103], v[192:195], a[152:155], v[88:103]
    ds_read_b128 a[184:187], v169 offset:45056
    ds_read_b128 a[188:191], v169 offset:49152
    buffer_store_dwordx4 a[196:199], v115, s[20:23], 0 offen offset:1024 sc1
    v_mfma_f32_32x32x16_bf16 v[8:23], v[196:199], a[156:159], v[8:23]
    ds_read_b64_tr_b16 v[216:217], v165 offset:53248
    ds_read_b64_tr_b16 v[218:219], v165 offset:54272
    buffer_store_dwordx4 a[200:203], v115, s[20:23], 0 offen offset:2048 sc1
    v_mfma_f32_32x32x16_bf16 v[24:39], v[196:199], a[160:163], v[24:39]
    v_mfma_f32_32x32x16_bf16 v[40:55], v[196:199], a[164:167], v[40:55]
    buffer_store_dwordx4 a[204:207], v115, s[20:23], 0 offen offset:3072 sc1
    v_mfma_f32_32x32x16_bf16 v[56:71], v[200:203], a[156:159], v[56:71]
    v_mfma_f32_32x32x16_bf16 v[72:87], v[200:203], a[160:163], v[72:87]
    buffer_store_dwordx4 a[208:211], v116, s[20:23], 0 offen offset:0 sc1
    v_mfma_f32_32x32x16_bf16 v[88:103], v[200:203], a[164:167], v[88:103]
    s_waitcnt vmcnt(20) lgkmcnt(0)
    s_barrier
    v_mfma_f32_32x32x16_bf16 v[8:23], v[204:207], a[168:171], v[8:23]
    ds_read_b64_tr_b16 v[188:189], v104 offset:0
    ds_read_b64_tr_b16 v[190:191], v104 offset:1024
    s_add_u32 s88, s87, 8
    s_sub_u32 s89, s88, 10
    s_cmp_ge_u32 s88, 10
    s_cselect_b32 s88, s89, s88
    s_lshl_b32 s90, s88, 7
    s_add_u32 m0, s26, 98304
    s_lshl_b32 s88, s88, 19
    buffer_load_dwordx4 v172, s[16:19], s88 offen offset:0 lds
    v_mfma_f32_32x32x16_bf16 v[24:39], v[204:207], a[172:175], v[24:39]
    ds_read_b128 a[144:147], v106 offset:0
    ds_read_b128 a[148:151], v106 offset:4096
    v_mfma_f32_32x32x16_bf16 v[40:55], v[204:207], a[176:179], v[40:55]
    ds_read_b128 a[152:155], v106 offset:8192
    ds_read_b64_tr_b16 v[192:193], v105 offset:0
    buffer_load_dwordx4 v173, s[16:19], s88 offen offset:1024 lds
    v_mfma_f32_32x32x16_bf16 v[56:71], v[208:211], a[168:171], v[56:71]
    ds_read_b64_tr_b16 v[194:195], v105 offset:1024
    ds_read_b64_tr_b16 v[196:197], v104 offset:4096
    v_mfma_f32_32x32x16_bf16 v[72:87], v[208:211], a[172:175], v[72:87]
    ds_read_b64_tr_b16 v[198:199], v104 offset:5120
    ds_read_b128 a[156:159], v107 offset:0
    buffer_load_dwordx4 v174, s[16:19], s88 offen offset:2048 lds
    v_mfma_f32_32x32x16_bf16 v[88:103], v[208:211], a[176:179], v[88:103]
    ds_read_b128 a[160:163], v107 offset:4096
    ds_read_b128 a[164:167], v107 offset:8192
    v_mfma_f32_32x32x16_bf16 v[8:23], v[212:215], a[180:183], v[8:23]
    ds_read_b64_tr_b16 v[200:201], v105 offset:4096
    ds_read_b64_tr_b16 v[202:203], v105 offset:5120
    v_mfma_f32_32x32x16_bf16 v[24:39], v[212:215], a[184:187], v[24:39]
    buffer_load_dwordx4 v175, s[16:19], s88 offen offset:3072 lds
    v_mfma_f32_32x32x16_bf16 v[40:55], v[212:215], a[188:191], v[40:55]
    v_mfma_f32_32x32x16_bf16 v[56:71], v[216:219], a[180:183], v[56:71]
    s_add_u32 m0, s27, 73728
    s_add_u32 s49, s90, 0
    buffer_load_dwordx4 v176, s[12:15], s49 offen lds
    v_mfma_f32_32x32x16_bf16 v[72:87], v[216:219], a[184:187], v[72:87]
    v_mfma_f32_32x32x16_bf16 v[88:103], v[216:219], a[188:191], v[88:103]
    s_waitcnt lgkmcnt(0)
    v_mfma_f32_32x32x16_bf16 v[8:23], v[188:191], a[144:147], v[8:23]
    ds_read_b64_tr_b16 v[204:205], v104 offset:8192
    ds_read_b64_tr_b16 v[206:207], v104 offset:9216
    s_add_u32 m0, s27, 74752
    s_add_u32 s49, s90, 10240
    buffer_load_dwordx4 v177, s[12:15], s49 offen lds
    v_mfma_f32_32x32x16_bf16 v[24:39], v[188:191], a[148:151], v[24:39]
    ds_read_b128 a[168:171], v108 offset:0
    ds_read_b128 a[172:175], v108 offset:4096
    v_mfma_f32_32x32x16_bf16 v[40:55], v[188:191], a[152:155], v[40:55]
    ds_read_b128 a[176:179], v108 offset:8192
    ds_read_b64_tr_b16 v[208:209], v105 offset:8192
    s_add_u32 m0, s27, 75776
    s_add_u32 s49, s90, 20480
    buffer_load_dwordx4 v176, s[12:15], s49 offen lds
    v_mfma_f32_32x32x16_bf16 v[56:71], v[192:195], a[144:147], v[56:71]
    ds_read_b64_tr_b16 v[210:211], v105 offset:9216
    ds_read_b64_tr_b16 v[212:213], v104 offset:12288
    v_mfma_f32_32x32x16_bf16 v[72:87], v[192:195], a[148:151], v[72:87]
    ds_read_b64_tr_b16 v[214:215], v104 offset:13312
    ds_read_b128 a[180:183], v109 offset:0
    s_add_u32 m0, s27, 76800
    s_add_u32 s49, s90, 30720
    buffer_load_dwordx4 v177, s[12:15], s49 offen lds
    v_mfma_f32_32x32x16_bf16 v[88:103], v[192:195], a[152:155], v[88:103]
    ds_read_b128 a[184:187], v109 offset:4096
    ds_read_b128 a[188:191], v109 offset:8192
    v_mfma_f32_32x32x16_bf16 v[8:23], v[196:199], a[156:159], v[8:23]
    ds_read_b64_tr_b16 v[216:217], v105 offset:12288
    ds_read_b64_tr_b16 v[218:219], v105 offset:13312
    v_mfma_f32_32x32x16_bf16 v[24:39], v[196:199], a[160:163], v[24:39]
    s_add_u32 m0, s27, 77824
    s_add_u32 s49, s90, 40960
    buffer_load_dwordx4 v176, s[12:15], s49 offen lds
    v_mfma_f32_32x32x16_bf16 v[40:55], v[196:199], a[164:167], v[40:55]
    v_mfma_f32_32x32x16_bf16 v[56:71], v[200:203], a[156:159], v[56:71]
    s_add_u32 m0, s27, 78848
    s_add_u32 s49, s90, 51200
    buffer_load_dwordx4 v177, s[12:15], s49 offen lds
    v_mfma_f32_32x32x16_bf16 v[72:87], v[200:203], a[160:163], v[72:87]
    v_mfma_f32_32x32x16_bf16 v[88:103], v[200:203], a[164:167], v[88:103]
    s_waitcnt vmcnt(15) lgkmcnt(0)
    s_barrier
    v_mfma_f32_32x32x16_bf16 v[8:23], v[204:207], a[168:171], v[8:23]
    ds_read_b64_tr_b16 v[188:189], v164 offset:0
    ds_read_b64_tr_b16 v[190:191], v164 offset:1024
    s_add_u32 s88, s87, 9
    s_sub_u32 s89, s88, 10
    s_cmp_ge_u32 s88, 10
    s_cselect_b32 s88, s89, s88
    s_lshl_b32 s90, s88, 7
    s_add_u32 m0, s26, 139264
    s_lshl_b32 s88, s88, 19
    buffer_load_dwordx4 v172, s[16:19], s88 offen offset:0 lds
    v_mfma_f32_32x32x16_bf16 v[24:39], v[204:207], a[172:175], v[24:39]
    ds_read_b128 a[144:147], v166 offset:0
    ds_read_b128 a[148:151], v166 offset:4096
    v_mfma_f32_32x32x16_bf16 v[40:55], v[204:207], a[176:179], v[40:55]
    ds_read_b128 a[152:155], v166 offset:8192
    ds_read_b64_tr_b16 v[192:193], v165 offset:0
    buffer_load_dwordx4 v173, s[16:19], s88 offen offset:1024 lds
    v_mfma_f32_32x32x16_bf16 v[56:71], v[208:211], a[168:171], v[56:71]
    ds_read_b64_tr_b16 v[194:195], v165 offset:1024
    ds_read_b64_tr_b16 v[196:197], v164 offset:4096
    v_mfma_f32_32x32x16_bf16 v[72:87], v[208:211], a[172:175], v[72:87]
    ds_read_b64_tr_b16 v[198:199], v164 offset:5120
    ds_read_b128 a[156:159], v167 offset:0
    buffer_load_dwordx4 v174, s[16:19], s88 offen offset:2048 lds
    v_mfma_f32_32x32x16_bf16 v[88:103], v[208:211], a[176:179], v[88:103]
    ds_read_b128 a[160:163], v167 offset:4096
    ds_read_b128 a[164:167], v167 offset:8192
    v_mfma_f32_32x32x16_bf16 v[8:23], v[212:215], a[180:183], v[8:23]
    ds_read_b64_tr_b16 v[200:201], v165 offset:4096
    ds_read_b64_tr_b16 v[202:203], v165 offset:5120
    v_mfma_f32_32x32x16_bf16 v[24:39], v[212:215], a[184:187], v[24:39]
    buffer_load_dwordx4 v175, s[16:19], s88 offen offset:3072 lds
    v_mfma_f32_32x32x16_bf16 v[40:55], v[212:215], a[188:191], v[40:55]
    v_mfma_f32_32x32x16_bf16 v[56:71], v[216:219], a[180:183], v[56:71]
    s_add_u32 m0, s27, 114688
    s_add_u32 s49, s90, 0
    buffer_load_dwordx4 v176, s[12:15], s49 offen lds
    v_mfma_f32_32x32x16_bf16 v[72:87], v[216:219], a[184:187], v[72:87]
    v_mfma_f32_32x32x16_bf16 v[88:103], v[216:219], a[188:191], v[88:103]
    s_waitcnt lgkmcnt(0)
    v_mfma_f32_32x32x16_bf16 v[8:23], v[188:191], a[144:147], v[8:23]
    ds_read_b64_tr_b16 v[204:205], v164 offset:8192
    ds_read_b64_tr_b16 v[206:207], v164 offset:9216
    s_add_u32 m0, s27, 115712
    s_add_u32 s49, s90, 10240
    buffer_load_dwordx4 v177, s[12:15], s49 offen lds
    v_mfma_f32_32x32x16_bf16 v[24:39], v[188:191], a[148:151], v[24:39]
    ds_read_b128 a[168:171], v168 offset:0
    ds_read_b128 a[172:175], v168 offset:4096
    v_mfma_f32_32x32x16_bf16 v[40:55], v[188:191], a[152:155], v[40:55]
    ds_read_b128 a[176:179], v168 offset:8192
    ds_read_b64_tr_b16 v[208:209], v165 offset:8192
    s_add_u32 m0, s27, 116736
    s_add_u32 s49, s90, 20480
    buffer_load_dwordx4 v176, s[12:15], s49 offen lds
    v_mfma_f32_32x32x16_bf16 v[56:71], v[192:195], a[144:147], v[56:71]
    ds_read_b64_tr_b16 v[210:211], v165 offset:9216
    ds_read_b64_tr_b16 v[212:213], v164 offset:12288
    v_mfma_f32_32x32x16_bf16 v[72:87], v[192:195], a[148:151], v[72:87]
    ds_read_b64_tr_b16 v[214:215], v164 offset:13312
    ds_read_b128 a[180:183], v169 offset:0
    s_add_u32 m0, s27, 117760
    s_add_u32 s49, s90, 30720
    buffer_load_dwordx4 v177, s[12:15], s49 offen lds
    v_mfma_f32_32x32x16_bf16 v[88:103], v[192:195], a[152:155], v[88:103]
    ds_read_b128 a[184:187], v169 offset:4096
    ds_read_b128 a[188:191], v169 offset:8192
    v_mfma_f32_32x32x16_bf16 v[8:23], v[196:199], a[156:159], v[8:23]
    ds_read_b64_tr_b16 v[216:217], v165 offset:12288
    ds_read_b64_tr_b16 v[218:219], v165 offset:13312
    v_mfma_f32_32x32x16_bf16 v[24:39], v[196:199], a[160:163], v[24:39]
    s_add_u32 m0, s27, 118784
    s_add_u32 s49, s90, 40960
    buffer_load_dwordx4 v176, s[12:15], s49 offen lds
    v_mfma_f32_32x32x16_bf16 v[40:55], v[196:199], a[164:167], v[40:55]
    v_mfma_f32_32x32x16_bf16 v[56:71], v[200:203], a[156:159], v[56:71]
    s_add_u32 m0, s27, 119808
    s_add_u32 s49, s90, 51200
    buffer_load_dwordx4 v177, s[12:15], s49 offen lds
    v_mfma_f32_32x32x16_bf16 v[72:87], v[200:203], a[160:163], v[72:87]
    v_mfma_f32_32x32x16_bf16 v[88:103], v[200:203], a[164:167], v[88:103]
    s_waitcnt vmcnt(10) lgkmcnt(0)
    s_barrier
    v_mfma_f32_32x32x16_bf16 v[8:23], v[204:207], a[168:171], v[8:23]
    ds_read_b64_tr_b16 v[188:189], v164 offset:40960
    ds_read_b64_tr_b16 v[190:191], v164 offset:41984
    s_add_u32 m0, s26, 32768
    s_mov_b32 s49, 16384
    buffer_load_dwordx4 v144, s[4:7], s49 offen offset:0 nt lds
    v_mfma_f32_32x32x16_bf16 v[24:39], v[204:207], a[172:175], v[24:39]
    ds_read_b128 a[144:147], v166 offset:40960
    ds_read_b128 a[148:151], v166 offset:45056
    v_mfma_f32_32x32x16_bf16 v[40:55], v[204:207], a[176:179], v[40:55]
    ds_read_b128 a[152:155], v166 offset:49152
    ds_read_b64_tr_b16 v[192:193], v165 offset:40960
    v_mfma_f32_32x32x16_bf16 v[56:71], v[208:211], a[168:171], v[56:71]
    ds_read_b64_tr_b16 v[194:195], v165 offset:41984
    ds_read_b64_tr_b16 v[196:197], v164 offset:45056
    buffer_load_dwordx4 v145, s[4:7], s49 offen offset:1024 nt lds
    v_mfma_f32_32x32x16_bf16 v[72:87], v[208:211], a[172:175], v[72:87]
    ds_read_b64_tr_b16 v[198:199], v164 offset:46080
    ds_read_b128 a[156:159], v167 offset:40960
    v_mfma_f32_32x32x16_bf16 v[88:103], v[208:211], a[176:179], v[88:103]
    ds_read_b128 a[160:163], v167 offset:45056
    ds_read_b128 a[164:167], v167 offset:49152
    v_mfma_f32_32x32x16_bf16 v[8:23], v[212:215], a[180:183], v[8:23]
    ds_read_b64_tr_b16 v[200:201], v165 offset:45056
    ds_read_b64_tr_b16 v[202:203], v165 offset:46080
    buffer_load_dwordx4 v146, s[4:7], s49 offen offset:2048 nt lds
    v_mfma_f32_32x32x16_bf16 v[24:39], v[212:215], a[184:187], v[24:39]
    v_mfma_f32_32x32x16_bf16 v[40:55], v[212:215], a[188:191], v[40:55]
    v_mfma_f32_32x32x16_bf16 v[56:71], v[216:219], a[180:183], v[56:71]
    buffer_load_dwordx4 v147, s[4:7], s49 offen offset:3072 nt lds
    v_mfma_f32_32x32x16_bf16 v[72:87], v[216:219], a[184:187], v[72:87]
    v_mfma_f32_32x32x16_bf16 v[88:103], v[216:219], a[188:191], v[88:103]
    s_waitcnt lgkmcnt(0)
    v_mfma_f32_32x32x16_bf16 v[8:23], v[188:191], a[144:147], v[8:23]
    ds_read_b64_tr_b16 v[204:205], v164 offset:49152
    ds_read_b64_tr_b16 v[206:207], v164 offset:50176
    s_add_u32 m0, s26, 49152
    s_mov_b32 s49, 16384
    buffer_load_dwordx4 v148, s[8:11], s49 offen offset:0 nt lds
    v_mfma_f32_32x32x16_bf16 v[24:39], v[188:191], a[148:151], v[24:39]
    ds_read_b128 a[168:171], v168 offset:40960
    ds_read_b128 a[172:175], v168 offset:45056
    v_mfma_f32_32x32x16_bf16 v[40:55], v[188:191], a[152:155], v[40:55]
    ds_read_b128 a[176:179], v168 offset:49152
    ds_read_b64_tr_b16 v[208:209], v165 offset:49152
    v_mfma_f32_32x32x16_bf16 v[56:71], v[192:195], a[144:147], v[56:71]
    ds_read_b64_tr_b16 v[210:211], v165 offset:50176
    ds_read_b64_tr_b16 v[212:213], v164 offset:53248
    buffer_load_dwordx4 v149, s[8:11], s49 offen offset:1024 nt lds
    v_mfma_f32_32x32x16_bf16 v[72:87], v[192:195], a[148:151], v[72:87]
    ds_read_b64_tr_b16 v[214:215], v164 offset:54272
    ds_read_b128 a[180:183], v169 offset:40960
    v_mfma_f32_32x32x16_bf16 v[88:103], v[192:195], a[152:155], v[88:103]
    ds_read_b128 a[184:187], v169 offset:45056
    ds_read_b128 a[188:191], v169 offset:49152
    v_mfma_f32_32x32x16_bf16 v[8:23], v[196:199], a[156:159], v[8:23]
    ds_read_b64_tr_b16 v[216:217], v165 offset:53248
    ds_read_b64_tr_b16 v[218:219], v165 offset:54272
    buffer_load_dwordx4 v148, s[8:11], s49 offen offset:2048 nt lds
    v_mfma_f32_32x32x16_bf16 v[24:39], v[196:199], a[160:163], v[24:39]
    v_mfma_f32_32x32x16_bf16 v[40:55], v[196:199], a[164:167], v[40:55]
    v_mfma_f32_32x32x16_bf16 v[56:71], v[200:203], a[156:159], v[56:71]
    buffer_load_dwordx4 v149, s[8:11], s49 offen offset:3072 nt lds
    v_mfma_f32_32x32x16_bf16 v[72:87], v[200:203], a[160:163], v[72:87]
    v_mfma_f32_32x32x16_bf16 v[88:103], v[200:203], a[164:167], v[88:103]
    s_waitcnt vmcnt(8) lgkmcnt(0)
    s_barrier
    v_mfma_f32_32x32x16_bf16 v[8:23], v[204:207], a[168:171], v[8:23]
    ds_read_b64_tr_b16 v[188:189], v104 offset:0
    ds_read_b64_tr_b16 v[190:191], v104 offset:1024
    s_add_u32 m0, s26, 65536
    s_mov_b32 s49, 32768
    buffer_load_dwordx4 v144, s[4:7], s49 offen offset:0 nt lds
    v_mfma_f32_32x32x16_bf16 v[24:39], v[204:207], a[172:175], v[24:39]
    ds_read_b128 a[144:147], v106 offset:0
    ds_read_b128 a[148:151], v106 offset:4096
    v_mfma_f32_32x32x16_bf16 v[40:55], v[204:207], a[176:179], v[40:55]
    ds_read_b128 a[152:155], v106 offset:8192
    ds_read_b64_tr_b16 v[192:193], v105 offset:0
    v_mfma_f32_32x32x16_bf16 v[56:71], v[208:211], a[168:171], v[56:71]
    ds_read_b64_tr_b16 v[194:195], v105 offset:1024
    ds_read_b64_tr_b16 v[196:197], v104 offset:4096
    buffer_load_dwordx4 v145, s[4:7], s49 offen offset:1024 nt lds
    v_mfma_f32_32x32x16_bf16 v[72:87], v[208:211], a[172:175], v[72:87]
    ds_read_b64_tr_b16 v[198:199], v104 offset:5120
    ds_read_b128 a[156:159], v107 offset:0
    v_mfma_f32_32x32x16_bf16 v[88:103], v[208:211], a[176:179], v[88:103]
    ds_read_b128 a[160:163], v107 offset:4096
    ds_read_b128 a[164:167], v107 offset:8192
    v_mfma_f32_32x32x16_bf16 v[8:23], v[212:215], a[180:183], v[8:23]
    ds_read_b64_tr_b16 v[200:201], v105 offset:4096
    ds_read_b64_tr_b16 v[202:203], v105 offset:5120
    buffer_load_dwordx4 v146, s[4:7], s49 offen offset:2048 nt lds
    v_mfma_f32_32x32x16_bf16 v[24:39], v[212:215], a[184:187], v[24:39]
    v_mfma_f32_32x32x16_bf16 v[40:55], v[212:215], a[188:191], v[40:55]
    v_mfma_f32_32x32x16_bf16 v[56:71], v[216:219], a[180:183], v[56:71]
    buffer_load_dwordx4 v147, s[4:7], s49 offen offset:3072 nt lds
    v_mfma_f32_32x32x16_bf16 v[72:87], v[216:219], a[184:187], v[72:87]
    v_mfma_f32_32x32x16_bf16 v[88:103], v[216:219], a[188:191], v[88:103]
    s_waitcnt lgkmcnt(0)
    v_mfma_f32_32x32x16_bf16 v[8:23], v[188:191], a[144:147], v[8:23]
    ds_read_b64_tr_b16 v[204:205], v104 offset:8192
    ds_read_b64_tr_b16 v[206:207], v104 offset:9216
    s_add_u32 m0, s26, 81920
    s_mov_b32 s49, 32768
    buffer_load_dwordx4 v148, s[8:11], s49 offen offset:0 nt lds
    v_mfma_f32_32x32x16_bf16 v[24:39], v[188:191], a[148:151], v[24:39]
    ds_read_b128 a[168:171], v108 offset:0
    ds_read_b128 a[172:175], v108 offset:4096
    v_mfma_f32_32x32x16_bf16 v[40:55], v[188:191], a[152:155], v[40:55]
    ds_read_b128 a[176:179], v108 offset:8192
    ds_read_b64_tr_b16 v[208:209], v105 offset:8192
    v_mfma_f32_32x32x16_bf16 v[56:71], v[192:195], a[144:147], v[56:71]
    ds_read_b64_tr_b16 v[210:211], v105 offset:9216
    ds_read_b64_tr_b16 v[212:213], v104 offset:12288
    buffer_load_dwordx4 v149, s[8:11], s49 offen offset:1024 nt lds
    v_mfma_f32_32x32x16_bf16 v[72:87], v[192:195], a[148:151], v[72:87]
    ds_read_b64_tr_b16 v[214:215], v104 offset:13312
    ds_read_b128 a[180:183], v109 offset:0
    v_mfma_f32_32x32x16_bf16 v[88:103], v[192:195], a[152:155], v[88:103]
    ds_read_b128 a[184:187], v109 offset:4096
    ds_read_b128 a[188:191], v109 offset:8192
    v_mfma_f32_32x32x16_bf16 v[8:23], v[196:199], a[156:159], v[8:23]
    ds_read_b64_tr_b16 v[216:217], v105 offset:12288
    ds_read_b64_tr_b16 v[218:219], v105 offset:13312
    buffer_load_dwordx4 v148, s[8:11], s49 offen offset:2048 nt lds
    v_mfma_f32_32x32x16_bf16 v[24:39], v[196:199], a[160:163], v[24:39]
    v_mfma_f32_32x32x16_bf16 v[40:55], v[196:199], a[164:167], v[40:55]
    v_mfma_f32_32x32x16_bf16 v[56:71], v[200:203], a[156:159], v[56:71]
    buffer_load_dwordx4 v149, s[8:11], s49 offen offset:3072 nt lds
    v_mfma_f32_32x32x16_bf16 v[72:87], v[200:203], a[160:163], v[72:87]
    v_mfma_f32_32x32x16_bf16 v[88:103], v[200:203], a[164:167], v[88:103]
    s_waitcnt lgkmcnt(0)
    v_mfma_f32_32x32x16_bf16 v[8:23], v[204:207], a[168:171], v[8:23]
    v_and_b32 v4, 31, v1
    s_lshr_b32 s48, s24, 1
    s_mul_i32 s48, s48, 96
    v_add_u32 v4, s48, v4
    v_lshlrev_b32 v4, 8, v4
    v_lshrrev_b32 v5, 5, v1
    v_mfma_f32_32x32x16_bf16 v[24:39], v[204:207], a[172:175], v[24:39]
    v_lshlrev_b32 v5, 3, v5
    v_add_u32 v4, v4, v5
    v_add_u32 v4, 114688, v4
    s_and_b32 s48, s24, 1
    s_lshl_b32 s48, s48, 3
    v_xor_b32 v5, s48, v3
    v_mfma_f32_32x32x16_bf16 v[40:55], v[204:207], a[176:179], v[40:55]
    v_xor_b32 v220, 0, v5
    v_lshlrev_b32 v220, 4, v220
    v_add_u32 v220, v220, v4
    v_xor_b32 v221, 1, v5
    v_lshlrev_b32 v221, 4, v221
    v_add_u32 v221, v221, v4
    v_mfma_f32_32x32x16_bf16 v[56:71], v[208:211], a[168:171], v[56:71]
    v_xor_b32 v222, 2, v5
    v_lshlrev_b32 v222, 4, v222
    v_add_u32 v222, v222, v4
    v_xor_b32 v223, 3, v5
    v_lshlrev_b32 v223, 4, v223
    v_add_u32 v223, v223, v4
    v_mfma_f32_32x32x16_bf16 v[72:87], v[208:211], a[172:175], v[72:87]
    v_xor_b32 v224, 4, v5
    v_lshlrev_b32 v224, 4, v224
    v_add_u32 v224, v224, v4
    v_xor_b32 v225, 5, v5
    v_lshlrev_b32 v225, 4, v225
    v_add_u32 v225, v225, v4
    v_mfma_f32_32x32x16_bf16 v[88:103], v[208:211], a[176:179], v[88:103]
    v_xor_b32 v226, 6, v5
    v_lshlrev_b32 v226, 4, v226
    v_add_u32 v226, v226, v4
    v_xor_b32 v227, 7, v5
    v_lshlrev_b32 v227, 4, v227
    v_add_u32 v227, v227, v4
    v_mfma_f32_32x32x16_bf16 v[8:23], v[212:215], a[180:183], v[8:23]
    v_mfma_f32_32x32x16_bf16 v[24:39], v[212:215], a[184:187], v[24:39]
    v_mfma_f32_32x32x16_bf16 v[40:55], v[212:215], a[188:191], v[40:55]
    v_mfma_f32_32x32x16_bf16 v[56:71], v[216:219], a[180:183], v[56:71]
    s_nop 8
    v_mul_f32 v8, s29, v8
    v_mul_f32 v9, s29, v9
    v_mul_f32 v10, s29, v10
    v_mul_f32 v11, s29, v11
    v_mul_f32 v12, s29, v12
    v_mul_f32 v13, s29, v13
    v_mul_f32 v14, s29, v14
    v_mul_f32 v15, s29, v15
    v_mul_f32 v16, s29, v16
    v_mul_f32 v17, s29, v17
    v_mul_f32 v18, s29, v18
    v_mul_f32 v19, s29, v19
    v_mul_f32 v20, s29, v20
    v_mul_f32 v21, s29, v21
    v_mul_f32 v22, s29, v22
    v_mul_f32 v23, s29, v23
    v_cvt_pk_bf16_f32 v8, v8, v9
    v_cvt_pk_bf16_f32 v9, v10, v11
    v_cvt_pk_bf16_f32 v10, v12, v13
    v_cvt_pk_bf16_f32 v11, v14, v15
    v_cvt_pk_bf16_f32 v12, v16, v17
    v_cvt_pk_bf16_f32 v13, v18, v19
    v_cvt_pk_bf16_f32 v14, v20, v21
    v_cvt_pk_bf16_f32 v15, v22, v23
    v_mfma_f32_32x32x16_bf16 v[72:87], v[216:219], a[184:187], v[72:87]
    v_mul_f32 v24, s29, v24
    v_mul_f32 v25, s29, v25
    v_mul_f32 v26, s29, v26
    v_mul_f32 v27, s29, v27
    v_mul_f32 v28, s29, v28
    v_mul_f32 v29, s29, v29
    v_mul_f32 v30, s29, v30
    v_mul_f32 v31, s29, v31
    v_mul_f32 v32, s29, v32
    v_mul_f32 v33, s29, v33
    v_mul_f32 v34, s29, v34
    v_mul_f32 v35, s29, v35
    v_mul_f32 v36, s29, v36
    v_mul_f32 v37, s29, v37
    v_mul_f32 v38, s29, v38
    v_mul_f32 v39, s29, v39
    v_cvt_pk_bf16_f32 v24, v24, v25
    v_cvt_pk_bf16_f32 v25, v26, v27
    v_cvt_pk_bf16_f32 v26, v28, v29
    v_cvt_pk_bf16_f32 v27, v30, v31
    v_cvt_pk_bf16_f32 v28, v32, v33
    v_cvt_pk_bf16_f32 v29, v34, v35
    v_cvt_pk_bf16_f32 v30, v36, v37
    v_cvt_pk_bf16_f32 v31, v38, v39
    v_mfma_f32_32x32x16_bf16 v[88:103], v[216:219], a[188:191], v[88:103]
    v_mul_f32 v40, s29, v40
    v_mul_f32 v41, s29, v41
    v_mul_f32 v42, s29, v42
    v_mul_f32 v43, s29, v43
    v_mul_f32 v44, s29, v44
    v_mul_f32 v45, s29, v45
    v_mul_f32 v46, s29, v46
    v_mul_f32 v47, s29, v47
    v_mul_f32 v48, s29, v48
    v_mul_f32 v49, s29, v49
    v_mul_f32 v50, s29, v50
    v_mul_f32 v51, s29, v51
    v_mul_f32 v52, s29, v52
    v_mul_f32 v53, s29, v53
    v_mul_f32 v54, s29, v54
    v_mul_f32 v55, s29, v55
    v_cvt_pk_bf16_f32 v40, v40, v41
    v_cvt_pk_bf16_f32 v41, v42, v43
    v_cvt_pk_bf16_f32 v42, v44, v45
    v_cvt_pk_bf16_f32 v43, v46, v47
    v_cvt_pk_bf16_f32 v44, v48, v49
    v_cvt_pk_bf16_f32 v45, v50, v51
    v_cvt_pk_bf16_f32 v46, v52, v53
    v_cvt_pk_bf16_f32 v47, v54, v55
    v_mul_f32 v56, s29, v56
    v_mul_f32 v57, s29, v57
    v_mul_f32 v58, s29, v58
    v_mul_f32 v59, s29, v59
    v_mul_f32 v60, s29, v60
    v_mul_f32 v61, s29, v61
    v_mul_f32 v62, s29, v62
    v_mul_f32 v63, s29, v63
    v_mul_f32 v64, s29, v64
    v_mul_f32 v65, s29, v65
    v_mul_f32 v66, s29, v66
    v_mul_f32 v67, s29, v67
    v_mul_f32 v68, s29, v68
    v_mul_f32 v69, s29, v69
    v_mul_f32 v70, s29, v70
    v_mul_f32 v71, s29, v71
    v_cvt_pk_bf16_f32 v56, v56, v57
    v_cvt_pk_bf16_f32 v57, v58, v59
    v_cvt_pk_bf16_f32 v58, v60, v61
    v_cvt_pk_bf16_f32 v59, v62, v63
    v_cvt_pk_bf16_f32 v60, v64, v65
    v_cvt_pk_bf16_f32 v61, v66, v67
    v_cvt_pk_bf16_f32 v62, v68, v69
    v_cvt_pk_bf16_f32 v63, v70, v71
    s_barrier
    v_mul_f32 v72, s29, v72
    v_mul_f32 v73, s29, v73
    v_mul_f32 v74, s29, v74
    v_mul_f32 v75, s29, v75
    v_mul_f32 v76, s29, v76
    v_mul_f32 v77, s29, v77
    v_mul_f32 v78, s29, v78
    v_mul_f32 v79, s29, v79
    v_mul_f32 v80, s29, v80
    v_mul_f32 v81, s29, v81
    v_mul_f32 v82, s29, v82
    v_mul_f32 v83, s29, v83
    v_mul_f32 v84, s29, v84
    v_mul_f32 v85, s29, v85
    v_mul_f32 v86, s29, v86
    v_mul_f32 v87, s29, v87
    v_cvt_pk_bf16_f32 v72, v72, v73
    v_cvt_pk_bf16_f32 v73, v74, v75
    v_cvt_pk_bf16_f32 v74, v76, v77
    v_cvt_pk_bf16_f32 v75, v78, v79
    v_cvt_pk_bf16_f32 v76, v80, v81
    v_cvt_pk_bf16_f32 v77, v82, v83
    v_cvt_pk_bf16_f32 v78, v84, v85
    v_cvt_pk_bf16_f32 v79, v86, v87
    v_mul_f32 v88, s29, v88
    v_mul_f32 v89, s29, v89
    v_mul_f32 v90, s29, v90
    v_mul_f32 v91, s29, v91
    v_mul_f32 v92, s29, v92
    v_mul_f32 v93, s29, v93
    v_mul_f32 v94, s29, v94
    v_mul_f32 v95, s29, v95
    v_mul_f32 v96, s29, v96
    v_mul_f32 v97, s29, v97
    v_mul_f32 v98, s29, v98
    v_mul_f32 v99, s29, v99
    v_mul_f32 v100, s29, v100
    v_mul_f32 v101, s29, v101
    v_mul_f32 v102, s29, v102
    v_mul_f32 v103, s29, v103
    v_cvt_pk_bf16_f32 v88, v88, v89
    v_cvt_pk_bf16_f32 v89, v90, v91
    v_cvt_pk_bf16_f32 v90, v92, v93
    v_cvt_pk_bf16_f32 v91, v94, v95
    v_cvt_pk_bf16_f32 v92, v96, v97
    v_cvt_pk_bf16_f32 v93, v98, v99
    v_cvt_pk_bf16_f32 v94, v100, v101
    v_cvt_pk_bf16_f32 v95, v102, v103
    ds_write_b64 v220, v[8:9] offset:0
    ds_write_b64 v221, v[10:11] offset:0
    ds_write_b64 v222, v[12:13] offset:0
    ds_write_b64 v223, v[14:15] offset:0
    ds_write_b64 v220, v[24:25] offset:8192
    ds_write_b64 v221, v[26:27] offset:8192
    ds_write_b64 v222, v[28:29] offset:8192
    ds_write_b64 v223, v[30:31] offset:8192
    ds_write_b64 v220, v[40:41] offset:16384
    ds_write_b64 v221, v[42:43] offset:16384
    ds_write_b64 v222, v[44:45] offset:16384
    ds_write_b64 v223, v[46:47] offset:16384
    ds_write_b64 v224, v[56:57] offset:0
    ds_write_b64 v225, v[58:59] offset:0
    ds_write_b64 v226, v[60:61] offset:0
    ds_write_b64 v227, v[62:63] offset:0
    ds_write_b64 v224, v[72:73] offset:8192
    ds_write_b64 v225, v[74:75] offset:8192
    ds_write_b64 v226, v[76:77] offset:8192
    ds_write_b64 v227, v[78:79] offset:8192
    ds_write_b64 v224, v[88:89] offset:16384
    ds_write_b64 v225, v[90:91] offset:16384
    ds_write_b64 v226, v[92:93] offset:16384
    ds_write_b64 v227, v[94:95] offset:16384
L_tok:
    v_readfirstlane_b32 s44, v255
    s_cmp_lg_u32 s44, 0
    s_cbranch_scc1 L_tok_ok
    s_sleep 2
    buffer_load_dword v255, off, s[56:59], 0 sc1
    s_waitcnt vmcnt(0)
    s_branch L_tok
L_tok_ok:
    s_and_b32 s48, s2, 1
    s_lshl_b32 s48, s48, 2
    s_add_u32 s48, s48, s24
    s_lshl_b32 s48, s48, 7
    s_lshr_b32 s49, s2, 1
    s_add_u32 s48, s48, s49
    s_lshl_b32 s48, s48, 2
    s_add_u32 s48, s48, 12587008
    s_mov_b64 exec, 1
    buffer_store_dword v255, off, s[20:23], s48 sc1
    s_mov_b64 exec, -1
    s_mul_i32 s48, s24, 12288
    s_add_u32 s48, s48, 114688
    v_add_u32 v180, s48, v120
    v_add_u32 v181, s48, v121
    v_add_u32 v182, s48, v122
    v_add_u32 v183, s48, v123
    s_waitcnt lgkmcnt(0)
    s_barrier
    ds_read_b128 a[96:99], v180 offset:0
    ds_read_b128 a[100:103], v181 offset:0
    ds_read_b128 a[104:107], v182 offset:0
    ds_read_b128 a[108:111], v183 offset:0
    ds_read_b128 a[112:115], v180 offset:4096
    ds_read_b128 a[116:119], v181 offset:4096
    ds_read_b128 a[120:123], v182 offset:4096
    ds_read_b128 a[124:127], v183 offset:4096
    ds_read_b128 a[128:131], v180 offset:8192
    ds_read_b128 a[132:135], v181 offset:8192
    ds_read_b128 a[136:139], v182 offset:8192
    ds_read_b128 a[140:143], v183 offset:8192
    ds_read_b128 v[56:59], v120 offset:0
    ds_read_b128 v[60:63], v121 offset:0
    ds_read_b128 v[64:67], v122 offset:0
    ds_read_b128 v[68:71], v123 offset:0
    ds_read_b128 v[72:75], v120 offset:4096
    ds_read_b128 v[76:79], v121 offset:4096
    ds_read_b128 v[80:83], v122 offset:4096
    ds_read_b128 v[84:87], v123 offset:4096
    s_mov_b32 s25, 65536
    s_mov_b32 s51, 49152
    s_waitcnt lgkmcnt(0)
    v_mfma_f32_16x16x32_bf16 v[20:23], v[56:59], a[96:99], 0
    v_mfma_f32_16x16x32_bf16 v[20:23], v[60:63], a[100:103], v[20:23]
    v_mfma_f32_16x16x32_bf16 v[20:23], v[64:67], a[104:107], v[20:23]
    v_mfma_f32_16x16x32_bf16 v[20:23], v[68:71], a[108:111], v[20:23]
    v_mfma_f32_16x16x32_bf16 v[28:31], v[56:59], a[112:115], 0
    v_mfma_f32_16x16x32_bf16 v[28:31], v[60:63], a[116:119], v[28:31]
    v_mfma_f32_16x16x32_bf16 v[28:31], v[64:67], a[120:123], v[28:31]
    v_mfma_f32_16x16x32_bf16 v[28:31], v[68:71], a[124:127], v[28:31]
    v_mfma_f32_16x16x32_bf16 v[36:39], v[56:59], a[128:131], 0
    v_mfma_f32_16x16x32_bf16 v[36:39], v[60:63], a[132:135], v[36:39]
    v_mfma_f32_16x16x32_bf16 v[36:39], v[64:67], a[136:139], v[36:39]
    v_mfma_f32_16x16x32_bf16 v[36:39], v[68:71], a[140:143], v[36:39]
    ds_read_b64_tr_b16 v[88:89], v128 offset:0
    ds_read_b64_tr_b16 v[90:91], v128 offset:4096
    ds_read_b64_tr_b16 v[92:93], v129 offset:0
    ds_read_b64_tr_b16 v[94:95], v129 offset:4096
    ds_read_b64_tr_b16 v[96:97], v130 offset:0
    ds_read_b64_tr_b16 v[98:99], v130 offset:4096
    ds_read_b64_tr_b16 v[100:101], v131 offset:0
    ds_read_b64_tr_b16 v[102:103], v131 offset:4096
    ds_read_b64_tr_b16 v[104:105], v132 offset:0
    ds_read_b64_tr_b16 v[106:107], v132 offset:4096
    ds_read_b64_tr_b16 v[108:109], v133 offset:0
    ds_read_b64_tr_b16 v[110:111], v133 offset:4096
    ds_read_b64_tr_b16 v[112:113], v134 offset:0
    ds_read_b64_tr_b16 v[114:115], v134 offset:4096
    ds_read_b64_tr_b16 v[116:117], v135 offset:0
    ds_read_b64_tr_b16 v[118:119], v135 offset:4096
    v_max3_f32 v166, v20, v21, v22
    v_max_f32 v166, v166, v23
    v_mov_b32 v167, v166
    v_max3_f32 v168, v28, v29, v30
    v_max_f32 v168, v168, v31
    v_mov_b32 v169, v168
    v_max3_f32 v170, v36, v37, v38
    v_max_f32 v170, v170, v39
    v_mov_b32 v171, v170
    s_nop 1
    v_permlane32_swap_b32 v166, v167
    v_permlane32_swap_b32 v168, v169
    v_permlane32_swap_b32 v170, v171
    v_max_f32 v166, v166, v167
    v_mov_b32 v167, v166
    v_max_f32 v168, v168, v169
    v_mov_b32 v169, v168
    v_max_f32 v170, v170, v171
    v_mov_b32 v171, v170
    s_nop 1
    v_permlane16_swap_b32 v166, v167
    v_permlane16_swap_b32 v168, v169
    v_permlane16_swap_b32 v170, v171
    v_max_f32 v166, v166, v167
    v_sub_f32 v8, 0, v166
    v_mov_b32 v9, v8
    v_mov_b32 v10, v8
    v_mov_b32 v11, v8
    v_max_f32 v168, v168, v169
    v_sub_f32 v12, 0, v168
    v_mov_b32 v13, v12
    v_mov_b32 v14, v12
    v_mov_b32 v15, v12
    v_max_f32 v170, v170, v171
    v_sub_f32 v16, 0, v170
    v_mov_b32 v17, v16
    v_mov_b32 v18, v16
    v_mov_b32 v19, v16
    s_nop 0
    s_waitcnt lgkmcnt(0)
    v_mfma_f32_16x16x32_bf16 v[20:23], v[56:59], a[96:99], v[8:11]
    v_mfma_f32_16x16x32_bf16 v[20:23], v[60:63], a[100:103], v[20:23]
    s_add_u32 m0, s26, 98304
    s_mov_b32 s49, 49152
    v_mfma_f32_16x16x32_bf16 v[20:23], v[64:67], a[104:107], v[20:23]
    s_waitcnt vmcnt(3)
    buffer_load_dwordx4 v144, s[4:7], s49 offen offset:0 nt lds
    v_mfma_f32_16x16x32_bf16 v[20:23], v[68:71], a[108:111], v[20:23]
    v_mfma_f32_16x16x32_bf16 v[24:27], v[72:75], a[96:99], v[8:11]
    v_mfma_f32_16x16x32_bf16 v[24:27], v[76:79], a[100:103], v[24:27]
    v_mfma_f32_16x16x32_bf16 v[24:27], v[80:83], a[104:107], v[24:27]
    v_mfma_f32_16x16x32_bf16 v[24:27], v[84:87], a[108:111], v[24:27]
    s_nop 7
    v_exp_f32 v158, v20
    v_exp_f32 v159, v21
    v_add_f32 v155, v152, v158
    v_add_f32 v155, v155, v159
    v_exp_f32 v160, v22
    v_mfma_f32_16x16x32_bf16 v[28:31], v[56:59], a[112:115], v[12:15]
    v_cvt_pk_bf16_f32 v44, v158, v159
    v_mfma_f32_16x16x32_bf16 v[28:31], v[60:63], a[116:119], v[28:31]
    v_exp_f32 v161, v23
    v_mfma_f32_16x16x32_bf16 v[28:31], v[64:67], a[120:123], v[28:31]
    v_add_f32 v155, v155, v160
    v_add_f32 v155, v155, v161
    v_mfma_f32_16x16x32_bf16 v[28:31], v[68:71], a[124:127], v[28:31]
    v_exp_f32 v158, v24
    v_mfma_f32_16x16x32_bf16 v[32:35], v[72:75], a[112:115], v[12:15]
    v_cvt_pk_bf16_f32 v45, v160, v161
    v_mfma_f32_16x16x32_bf16 v[32:35], v[76:79], a[116:119], v[32:35]
    v_exp_f32 v159, v25
    s_waitcnt vmcnt(3)
    buffer_load_dwordx4 v145, s[4:7], s49 offen offset:1024 nt lds
    v_mfma_f32_16x16x32_bf16 v[32:35], v[80:83], a[120:123], v[32:35]
    v_add_f32 v155, v155, v158
    v_add_f32 v155, v155, v159
    v_mfma_f32_16x16x32_bf16 v[32:35], v[84:87], a[124:127], v[32:35]
    v_exp_f32 v160, v26
    s_nop 7
    v_cvt_pk_bf16_f32 v46, v158, v159
    v_exp_f32 v161, v27
    v_add_f32 v155, v155, v160
    v_add_f32 v155, v155, v161
    v_cvt_pk_bf16_f32 v47, v160, v161
    v_cmp_nge_f32 vcc, s28, v155
    v_exp_f32 v162, v28
    v_exp_f32 v163, v29
    v_add_f32 v156, v153, v162
    v_add_f32 v156, v156, v163
    v_exp_f32 v164, v30
    v_mfma_f32_16x16x32_bf16 v[36:39], v[56:59], a[128:131], v[16:19]
    s_cbranch_vccnz L_rare_p0_1_0
L_back_p0_1_0:
    v_cvt_pk_bf16_f32 v48, v162, v163
    v_mfma_f32_16x16x32_bf16 v[36:39], v[60:63], a[132:135], v[36:39]
    v_exp_f32 v165, v31
    v_mfma_f32_16x16x32_bf16 v[36:39], v[64:67], a[136:139], v[36:39]
    v_add_f32 v156, v156, v164
    v_add_f32 v156, v156, v165
    v_mfma_f32_16x16x32_bf16 v[36:39], v[68:71], a[140:143], v[36:39]
    v_exp_f32 v162, v32
    v_mfma_f32_16x16x32_bf16 v[40:43], v[72:75], a[128:131], v[16:19]
    ds_read_b128 v[56:59], v120 offset:8192
    v_cvt_pk_bf16_f32 v49, v164, v165
    v_mfma_f32_16x16x32_bf16 v[40:43], v[76:79], a[132:135], v[40:43]
    ds_read_b128 v[60:63], v121 offset:8192
    v_exp_f32 v163, v33
    v_mfma_f32_16x16x32_bf16 v[40:43], v[80:83], a[136:139], v[40:43]
    ds_read_b128 v[64:67], v122 offset:8192
    v_add_f32 v156, v156, v162
    v_add_f32 v156, v156, v163
    v_mfma_f32_16x16x32_bf16 v[40:43], v[84:87], a[140:143], v[40:43]
    s_waitcnt lgkmcnt(3)
    ds_read_b128 v[68:71], v123 offset:8192
    v_exp_f32 v164, v34
    v_mfma_f32_16x16x32_bf16 a[0:3], v[88:91], v[44:47], a[0:3]
    ds_read_b128 v[72:75], v120 offset:12288
    v_cvt_pk_bf16_f32 v50, v162, v163
    v_mfma_f32_16x16x32_bf16 a[4:7], v[92:95], v[44:47], a[4:7]
    ds_read_b128 v[76:79], v121 offset:12288
    v_exp_f32 v165, v35
    s_waitcnt vmcnt(3)
    buffer_load_dwordx4 v146, s[4:7], s49 offen offset:2048 nt lds
    v_mfma_f32_16x16x32_bf16 a[8:11], v[96:99], v[44:47], a[8:11]
    ds_read_b128 v[80:83], v122 offset:12288
    v_add_f32 v156, v156, v164
    v_add_f32 v156, v156, v165
    v_mfma_f32_16x16x32_bf16 a[12:15], v[100:103], v[44:47], a[12:15]
    ds_read_b128 v[84:87], v123 offset:12288
    v_cvt_pk_bf16_f32 v51, v164, v165
    v_cmp_nge_f32 vcc, s28, v156
    v_mfma_f32_16x16x32_bf16 a[16:19], v[104:107], v[44:47], a[16:19]
    v_exp_f32 v158, v36
    v_mfma_f32_16x16x32_bf16 a[20:23], v[108:111], v[44:47], a[20:23]
    v_exp_f32 v159, v37
    v_mfma_f32_16x16x32_bf16 a[24:27], v[112:115], v[44:47], a[24:27]
    v_add_f32 v157, v154, v158
    v_add_f32 v157, v157, v159
    v_mfma_f32_16x16x32_bf16 a[28:31], v[116:119], v[44:47], a[28:31]
    s_waitcnt lgkmcnt(0)
    v_exp_f32 v160, v38
    v_mfma_f32_16x16x32_bf16 v[20:23], v[56:59], a[96:99], v[8:11]
    s_cbranch_vccnz L_rare_p0_1_1
L_back_p0_1_1:
    v_cvt_pk_bf16_f32 v52, v158, v159
    v_mfma_f32_16x16x32_bf16 v[20:23], v[60:63], a[100:103], v[20:23]
    v_exp_f32 v161, v39
    v_mfma_f32_16x16x32_bf16 v[20:23], v[64:67], a[104:107], v[20:23]
    v_add_f32 v157, v157, v160
    v_add_f32 v157, v157, v161
    v_mfma_f32_16x16x32_bf16 v[20:23], v[68:71], a[108:111], v[20:23]
    v_exp_f32 v158, v40
    v_mfma_f32_16x16x32_bf16 v[24:27], v[72:75], a[96:99], v[8:11]
    v_cvt_pk_bf16_f32 v53, v160, v161
    v_mfma_f32_16x16x32_bf16 v[24:27], v[76:79], a[100:103], v[24:27]
    v_exp_f32 v159, v41
    v_mfma_f32_16x16x32_bf16 v[24:27], v[80:83], a[104:107], v[24:27]
    v_add_f32 v157, v157, v158
    v_add_f32 v157, v157, v159
    v_mfma_f32_16x16x32_bf16 v[24:27], v[84:87], a[108:111], v[24:27]
    v_exp_f32 v160, v42
    v_mfma_f32_16x16x32_bf16 a[32:35], v[88:91], v[48:51], a[32:35]
    v_cvt_pk_bf16_f32 v54, v158, v159
    v_mfma_f32_16x16x32_bf16 a[36:39], v[92:95], v[48:51], a[36:39]
    v_exp_f32 v161, v43
    v_mfma_f32_16x16x32_bf16 a[40:43], v[96:99], v[48:51], a[40:43]
    v_add_f32 v157, v157, v160
    v_add_f32 v157, v157, v161
    v_mfma_f32_16x16x32_bf16 a[44:47], v[100:103], v[48:51], a[44:47]
    v_cvt_pk_bf16_f32 v55, v160, v161
    v_cmp_nge_f32 vcc, s28, v157
    v_mfma_f32_16x16x32_bf16 a[48:51], v[104:107], v[48:51], a[48:51]
    v_exp_f32 v162, v20
    s_waitcnt vmcnt(3)
    buffer_load_dwordx4 v147, s[4:7], s49 offen offset:3072 nt lds
    v_mfma_f32_16x16x32_bf16 a[52:55], v[108:111], v[48:51], a[52:55]
    v_exp_f32 v163, v21
    v_mfma_f32_16x16x32_bf16 a[56:59], v[112:115], v[48:51], a[56:59]
    v_add_f32 v152, v155, v162
    v_add_f32 v152, v152, v163
    v_mfma_f32_16x16x32_bf16 a[60:63], v[116:119], v[48:51], a[60:63]
    v_exp_f32 v164, v22
    v_mfma_f32_16x16x32_bf16 v[28:31], v[56:59], a[112:115], v[12:15]
    s_cbranch_vccnz L_rare_p0_1_2
L_back_p0_1_2:
    v_cvt_pk_bf16_f32 v44, v162, v163
    v_mfma_f32_16x16x32_bf16 v[28:31], v[60:63], a[116:119], v[28:31]
    v_exp_f32 v165, v23
    v_mfma_f32_16x16x32_bf16 v[28:31], v[64:67], a[120:123], v[28:31]
    v_add_f32 v152, v152, v164
    v_add_f32 v152, v152, v165
    v_mfma_f32_16x16x32_bf16 v[28:31], v[68:71], a[124:127], v[28:31]
    v_exp_f32 v162, v24
    v_mfma_f32_16x16x32_bf16 v[32:35], v[72:75], a[112:115], v[12:15]
    v_cvt_pk_bf16_f32 v45, v164, v165
    v_mfma_f32_16x16x32_bf16 v[32:35], v[76:79], a[116:119], v[32:35]
    v_exp_f32 v163, v25
    v_mfma_f32_16x16x32_bf16 v[32:35], v[80:83], a[120:123], v[32:35]
    v_add_f32 v152, v152, v162
    v_add_f32 v152, v152, v163
    v_mfma_f32_16x16x32_bf16 v[32:35], v[84:87], a[124:127], v[32:35]
    v_exp_f32 v164, v26
    v_mfma_f32_16x16x32_bf16 a[64:67], v[88:91], v[52:55], a[64:67]
    ds_read_b64_tr_b16 v[88:89], v128 offset:8192
    v_cvt_pk_bf16_f32 v46, v162, v163
    v_mfma_f32_16x16x32_bf16 a[68:71], v[92:95], v[52:55], a[68:71]
    ds_read_b64_tr_b16 v[92:93], v129 offset:8192
    v_exp_f32 v165, v27
    v_mfma_f32_16x16x32_bf16 a[72:75], v[96:99], v[52:55], a[72:75]
    ds_read_b64_tr_b16 v[96:97], v130 offset:8192
    v_add_f32 v152, v152, v164
    v_add_f32 v152, v152, v165
    v_mfma_f32_16x16x32_bf16 a[76:79], v[100:103], v[52:55], a[76:79]
    ds_read_b64_tr_b16 v[100:101], v131 offset:8192
    v_cvt_pk_bf16_f32 v47, v164, v165
    v_cmp_nge_f32 vcc, s28, v152
    v_mfma_f32_16x16x32_bf16 a[80:83], v[104:107], v[52:55], a[80:83]
    ds_read_b64_tr_b16 v[104:105], v132 offset:8192
    v_exp_f32 v158, v28
    v_mfma_f32_16x16x32_bf16 a[84:87], v[108:111], v[52:55], a[84:87]
    ds_read_b64_tr_b16 v[108:109], v133 offset:8192
    v_exp_f32 v159, v29
    v_mfma_f32_16x16x32_bf16 a[88:91], v[112:115], v[52:55], a[88:91]
    ds_read_b64_tr_b16 v[112:113], v134 offset:8192
    v_add_f32 v153, v156, v158
    v_add_f32 v153, v153, v159
    v_mfma_f32_16x16x32_bf16 a[92:95], v[116:119], v[52:55], a[92:95]
    ds_read_b64_tr_b16 v[116:117], v135 offset:8192
    v_exp_f32 v160, v30
    v_mfma_f32_16x16x32_bf16 v[36:39], v[56:59], a[128:131], v[16:19]
    s_cbranch_vccnz L_rare_p0_2_0
L_back_p0_2_0:
    ds_read_b64_tr_b16 v[94:95], v129 offset:12288
    ds_read_b64_tr_b16 v[90:91], v128 offset:12288
    v_cvt_pk_bf16_f32 v48, v158, v159
    v_mfma_f32_16x16x32_bf16 v[36:39], v[60:63], a[132:135], v[36:39]
    ds_read_b64_tr_b16 v[102:103], v131 offset:12288
    ds_read_b64_tr_b16 v[98:99], v130 offset:12288
    v_exp_f32 v161, v31
    v_mfma_f32_16x16x32_bf16 v[36:39], v[64:67], a[136:139], v[36:39]
    s_waitcnt vmcnt(13)
    ds_read_b64_tr_b16 v[110:111], v133 offset:12288
    ds_read_b64_tr_b16 v[106:107], v132 offset:12288
    v_add_f32 v153, v153, v160
    v_add_f32 v153, v153, v161
    v_mfma_f32_16x16x32_bf16 v[36:39], v[68:71], a[140:143], v[36:39]
    s_barrier
    ds_read_b64_tr_b16 v[118:119], v135 offset:12288
    ds_read_b64_tr_b16 v[114:115], v134 offset:12288
    v_exp_f32 v158, v32
    v_mfma_f32_16x16x32_bf16 v[40:43], v[72:75], a[128:131], v[16:19]
    ds_read_b128 v[56:59], v120 offset:32768
    v_cvt_pk_bf16_f32 v49, v160, v161
    v_mfma_f32_16x16x32_bf16 v[40:43], v[76:79], a[132:135], v[40:43]
    ds_read_b128 v[60:63], v121 offset:32768
    v_exp_f32 v159, v33
    v_mfma_f32_16x16x32_bf16 v[40:43], v[80:83], a[136:139], v[40:43]
    ds_read_b128 v[64:67], v122 offset:32768
    v_add_f32 v153, v153, v158
    v_add_f32 v153, v153, v159
    v_mfma_f32_16x16x32_bf16 v[40:43], v[84:87], a[140:143], v[40:43]
    s_waitcnt lgkmcnt(3)
    ds_read_b128 v[68:71], v123 offset:32768
    v_exp_f32 v160, v34
    v_mfma_f32_16x16x32_bf16 a[0:3], v[88:91], v[44:47], a[0:3]
    ds_read_b128 v[72:75], v120 offset:36864
    v_cvt_pk_bf16_f32 v50, v158, v159
    v_mfma_f32_16x16x32_bf16 a[4:7], v[92:95], v[44:47], a[4:7]
    s_add_u32 m0, s26, 0
    ds_read_b128 v[76:79], v121 offset:36864
    v_exp_f32 v161, v35
    v_mfma_f32_16x16x32_bf16 a[8:11], v[96:99], v[44:47], a[8:11]
    ds_read_b128 v[80:83], v122 offset:36864
    v_add_f32 v153, v153, v160
    v_add_f32 v153, v153, v161
    v_mfma_f32_16x16x32_bf16 a[12:15], v[100:103], v[44:47], a[12:15]
    ds_read_b128 v[84:87], v123 offset:36864
    v_cvt_pk_bf16_f32 v51, v160, v161
    v_cmp_nge_f32 vcc, s28, v153
    v_mfma_f32_16x16x32_bf16 a[16:19], v[104:107], v[44:47], a[16:19]
    v_exp_f32 v162, v36
    s_waitcnt vmcnt(3)
    buffer_load_dwordx4 v144, s[4:7], s25 offen offset:0 nt lds
    v_mfma_f32_16x16x32_bf16 a[20:23], v[108:111], v[44:47], a[20:23]
    v_exp_f32 v163, v37
    v_mfma_f32_16x16x32_bf16 a[24:27], v[112:115], v[44:47], a[24:27]
    v_add_f32 v154, v157, v162
    v_add_f32 v154, v154, v163
    v_mfma_f32_16x16x32_bf16 a[28:31], v[116:119], v[44:47], a[28:31]
    s_waitcnt lgkmcnt(0)
    v_exp_f32 v164, v38
    s_waitcnt vmcnt(3)
    buffer_load_dwordx4 v145, s[4:7], s25 offen offset:1024 nt lds
    s_and_b32 s32, s2, 3
    s_lshl_b32 s32, s32, 1
    s_lshr_b32 s48, s2, 3
    s_and_b32 s49, s48, 1
    s_add_u32 s32, s32, s49
    s_lshr_b32 s33, s48, 1
    s_and_b32 s33, s33, 1
    s_lshr_b32 s34, s48, 2
    s_lshr_b32 s37, s2, 2
    s_and_b32 s37, s37, 1
    s_lshl_b32 s38, s37, 6
    s_lshl_b32 s49, s24, 4
    s_add_u32 s38, s38, s49
    s_lshl_b32 s39, s34, 7
    s_add_u32 s39, s39, s38
    s_lshl_b32 s48, s39, 2
    s_add_u32 s48, s48, 12587008
    v_and_b32 v254, 15, v1
    v_lshlrev_b32 v254, 2, v254
    v_add_u32 v254, s48, v254
    s_mul_i32 s48, s39, 5120
    s_add_u32 s48, s48, 13631488
    s_add_u32 s16, s40, s48
    s_addc_u32 s17, s41, 0
    s_mov_b32 s18, 81920
    s_mov_b32 s19, 0x20000
    v_lshlrev_b32 v252, 4, v1
    v_add_u32 v253, 4096, v252
    s_lshl_b32 s91, s34, 1
    s_lshr_b32 s48, s2, 3
    s_and_b32 s48, s48, 3
    s_lshl_b32 s48, s48, 2
    s_add_u32 s91, s91, s48
    s_mov_b32 s27, 7
L_loop:
    s_cmp_lg_u32 s27, 1
    s_cbranch_scc1 L_nocl
    buffer_load_dword v255, v254, s[20:23], 0 offen sc1
L_nocl:
    v_mfma_f32_16x16x32_bf16 v[20:23], v[56:59], a[96:99], v[8:11]
    s_cbranch_vccnz L_rare_l1_0_1
L_back_l1_0_1:
    v_cvt_pk_bf16_f32 v52, v162, v163
    v_mfma_f32_16x16x32_bf16 v[20:23], v[60:63], a[100:103], v[20:23]
    v_exp_f32 v165, v39
    v_mfma_f32_16x16x32_bf16 v[20:23], v[64:67], a[104:107], v[20:23]
    v_add_f32 v154, v154, v164
    v_add_f32 v154, v154, v165
    v_mfma_f32_16x16x32_bf16 v[20:23], v[68:71], a[108:111], v[20:23]
    v_exp_f32 v162, v40
    v_mfma_f32_16x16x32_bf16 v[24:27], v[72:75], a[96:99], v[8:11]
    v_cvt_pk_bf16_f32 v53, v164, v165
    v_mfma_f32_16x16x32_bf16 v[24:27], v[76:79], a[100:103], v[24:27]
    v_exp_f32 v163, v41
    v_mfma_f32_16x16x32_bf16 v[24:27], v[80:83], a[104:107], v[24:27]
    v_add_f32 v154, v154, v162
    v_add_f32 v154, v154, v163
    v_mfma_f32_16x16x32_bf16 v[24:27], v[84:87], a[108:111], v[24:27]
    v_exp_f32 v164, v42
    v_mfma_f32_16x16x32_bf16 a[32:35], v[88:91], v[48:51], a[32:35]
    v_cvt_pk_bf16_f32 v54, v162, v163
    s_waitcnt vmcnt(4)
    buffer_load_dwordx4 v146, s[4:7], s25 offen offset:2048 nt lds
    v_mfma_f32_16x16x32_bf16 a[36:39], v[92:95], v[48:51], a[36:39]
    v_exp_f32 v165, v43
    v_mfma_f32_16x16x32_bf16 a[40:43], v[96:99], v[48:51], a[40:43]
    v_add_f32 v154, v154, v164
    v_add_f32 v154, v154, v165
    v_mfma_f32_16x16x32_bf16 a[44:47], v[100:103], v[48:51], a[44:47]
    v_cvt_pk_bf16_f32 v55, v164, v165
    v_cmp_nge_f32 vcc, s28, v154
    v_mfma_f32_16x16x32_bf16 a[48:51], v[104:107], v[48:51], a[48:51]
    v_exp_f32 v158, v20
    v_mfma_f32_16x16x32_bf16 a[52:55], v[108:111], v[48:51], a[52:55]
    v_exp_f32 v159, v21
    v_mfma_f32_16x16x32_bf16 a[56:59], v[112:115], v[48:51], a[56:59]
    v_add_f32 v155, v152, v158
    v_add_f32 v155, v155, v159
    v_mfma_f32_16x16x32_bf16 a[60:63], v[116:119], v[48:51], a[60:63]
    v_exp_f32 v160, v22
    v_mfma_f32_16x16x32_bf16 v[28:31], v[56:59], a[112:115], v[12:15]
    s_cbranch_vccnz L_rare_l1_0_2
L_back_l1_0_2:
    v_cvt_pk_bf16_f32 v44, v158, v159
    v_mfma_f32_16x16x32_bf16 v[28:31], v[60:63], a[116:119], v[28:31]
    v_exp_f32 v161, v23
    v_mfma_f32_16x16x32_bf16 v[28:31], v[64:67], a[120:123], v[28:31]
    v_add_f32 v155, v155, v160
    v_add_f32 v155, v155, v161
    v_mfma_f32_16x16x32_bf16 v[28:31], v[68:71], a[124:127], v[28:31]
    v_exp_f32 v158, v24
    v_mfma_f32_16x16x32_bf16 v[32:35], v[72:75], a[112:115], v[12:15]
    v_cvt_pk_bf16_f32 v45, v160, v161
    s_waitcnt vmcnt(4)
    buffer_load_dwordx4 v147, s[4:7], s25 offen offset:3072 nt lds
    v_mfma_f32_16x16x32_bf16 v[32:35], v[76:79], a[116:119], v[32:35]
    s_add_u32 s25, s25, 16384
    v_exp_f32 v159, v25
    v_mfma_f32_16x16x32_bf16 v[32:35], v[80:83], a[120:123], v[32:35]
    v_add_f32 v155, v155, v158
    v_add_f32 v155, v155, v159
    v_mfma_f32_16x16x32_bf16 v[32:35], v[84:87], a[124:127], v[32:35]
    v_exp_f32 v160, v26
    v_mfma_f32_16x16x32_bf16 a[64:67], v[88:91], v[52:55], a[64:67]
    ds_read_b64_tr_b16 v[88:89], v128 offset:32768
    v_cvt_pk_bf16_f32 v46, v158, v159
    v_mfma_f32_16x16x32_bf16 a[68:71], v[92:95], v[52:55], a[68:71]
    ds_read_b64_tr_b16 v[92:93], v129 offset:32768
    v_exp_f32 v161, v27
    v_mfma_f32_16x16x32_bf16 a[72:75], v[96:99], v[52:55], a[72:75]
    ds_read_b64_tr_b16 v[96:97], v130 offset:32768
    v_add_f32 v155, v155, v160
    v_add_f32 v155, v155, v161
    v_mfma_f32_16x16x32_bf16 a[76:79], v[100:103], v[52:55], a[76:79]
    ds_read_b64_tr_b16 v[100:101], v131 offset:32768
    v_cvt_pk_bf16_f32 v47, v160, v161
    v_cmp_nge_f32 vcc, s28, v155
    v_mfma_f32_16x16x32_bf16 a[80:83], v[104:107], v[52:55], a[80:83]
    ds_read_b64_tr_b16 v[104:105], v132 offset:32768
    v_exp_f32 v162, v28
    v_mfma_f32_16x16x32_bf16 a[84:87], v[108:111], v[52:55], a[84:87]
    ds_read_b64_tr_b16 v[108:109], v133 offset:32768
    v_exp_f32 v163, v29
    v_mfma_f32_16x16x32_bf16 a[88:91], v[112:115], v[52:55], a[88:91]
    ds_read_b64_tr_b16 v[112:113], v134 offset:32768
    v_add_f32 v156, v153, v162
    v_add_f32 v156, v156, v163
    v_mfma_f32_16x16x32_bf16 a[92:95], v[116:119], v[52:55], a[92:95]
    ds_read_b64_tr_b16 v[116:117], v135 offset:32768
    v_exp_f32 v164, v30
    v_mfma_f32_16x16x32_bf16 v[36:39], v[56:59], a[128:131], v[16:19]
    s_cbranch_vccnz L_rare_l1_1_0
L_back_l1_1_0:
    ds_read_b64_tr_b16 v[94:95], v129 offset:36864
    ds_read_b64_tr_b16 v[90:91], v128 offset:36864
    v_cvt_pk_bf16_f32 v48, v162, v163
    v_mfma_f32_16x16x32_bf16 v[36:39], v[60:63], a[132:135], v[36:39]
    ds_read_b64_tr_b16 v[102:103], v131 offset:36864
    ds_read_b64_tr_b16 v[98:99], v130 offset:36864
    v_exp_f32 v165, v31
    v_mfma_f32_16x16x32_bf16 v[36:39], v[64:67], a[136:139], v[36:39]
    ds_read_b64_tr_b16 v[110:111], v133 offset:36864
    ds_read_b64_tr_b16 v[106:107], v132 offset:36864
    v_add_f32 v156, v156, v164
    v_add_f32 v156, v156, v165
    v_mfma_f32_16x16x32_bf16 v[36:39], v[68:71], a[140:143], v[36:39]
    ds_read_b64_tr_b16 v[118:119], v135 offset:36864
    ds_read_b64_tr_b16 v[114:115], v134 offset:36864
    v_exp_f32 v162, v32
    v_mfma_f32_16x16x32_bf16 v[40:43], v[72:75], a[128:131], v[16:19]
    ds_read_b128 v[56:59], v120 offset:40960
    v_cvt_pk_bf16_f32 v49, v164, v165
    v_mfma_f32_16x16x32_bf16 v[40:43], v[76:79], a[132:135], v[40:43]
    ds_read_b128 v[60:63], v121 offset:40960
    v_exp_f32 v163, v33
    v_mfma_f32_16x16x32_bf16 v[40:43], v[80:83], a[136:139], v[40:43]
    s_add_u32 m0, s26, 114688
    ds_read_b128 v[64:67], v122 offset:40960
    v_add_f32 v156, v156, v162
    v_add_f32 v156, v156, v163
    v_mfma_f32_16x16x32_bf16 v[40:43], v[84:87], a[140:143], v[40:43]
    s_waitcnt lgkmcnt(3)
    ds_read_b128 v[68:71], v123 offset:40960
    v_exp_f32 v164, v34
    v_mfma_f32_16x16x32_bf16 a[0:3], v[88:91], v[44:47], a[0:3]
    ds_read_b128 v[72:75], v120 offset:45056
    v_cvt_pk_bf16_f32 v50, v162, v163
    s_waitcnt vmcnt(4)
    buffer_load_dwordx4 v148, s[8:11], s51 offen offset:0 nt lds
    v_mfma_f32_16x16x32_bf16 a[4:7], v[92:95], v[44:47], a[4:7]
    ds_read_b128 v[76:79], v121 offset:45056
    v_exp_f32 v165, v35
    v_mfma_f32_16x16x32_bf16 a[8:11], v[96:99], v[44:47], a[8:11]
    ds_read_b128 v[80:83], v122 offset:45056
    v_add_f32 v156, v156, v164
    v_add_f32 v156, v156, v165
    v_mfma_f32_16x16x32_bf16 a[12:15], v[100:103], v[44:47], a[12:15]
    ds_read_b128 v[84:87], v123 offset:45056
    v_cvt_pk_bf16_f32 v51, v164, v165
    v_cmp_nge_f32 vcc, s28, v156
    v_mfma_f32_16x16x32_bf16 a[16:19], v[104:107], v[44:47], a[16:19]
    v_exp_f32 v158, v36
    v_mfma_f32_16x16x32_bf16 a[20:23], v[108:111], v[44:47], a[20:23]
    v_exp_f32 v159, v37
    v_mfma_f32_16x16x32_bf16 a[24:27], v[112:115], v[44:47], a[24:27]
    v_add_f32 v157, v154, v158
    v_add_f32 v157, v157, v159
    v_mfma_f32_16x16x32_bf16 a[28:31], v[116:119], v[44:47], a[28:31]
    s_waitcnt lgkmcnt(0)
    v_exp_f32 v160, v38
    v_mfma_f32_16x16x32_bf16 v[20:23], v[56:59], a[96:99], v[8:11]
    s_cbranch_vccnz L_rare_l1_1_1
L_back_l1_1_1:
    v_cvt_pk_bf16_f32 v52, v158, v159
    v_mfma_f32_16x16x32_bf16 v[20:23], v[60:63], a[100:103], v[20:23]
    v_exp_f32 v161, v39
    v_mfma_f32_16x16x32_bf16 v[20:23], v[64:67], a[104:107], v[20:23]
    v_add_f32 v157, v157, v160
    v_add_f32 v157, v157, v161
    v_mfma_f32_16x16x32_bf16 v[20:23], v[68:71], a[108:111], v[20:23]
    v_exp_f32 v158, v40
    v_mfma_f32_16x16x32_bf16 v[24:27], v[72:75], a[96:99], v[8:11]
    v_cvt_pk_bf16_f32 v53, v160, v161
    s_waitcnt vmcnt(4)
    buffer_load_dwordx4 v149, s[8:11], s51 offen offset:1024 nt lds
    v_mfma_f32_16x16x32_bf16 v[24:27], v[76:79], a[100:103], v[24:27]
    v_exp_f32 v159, v41
    v_mfma_f32_16x16x32_bf16 v[24:27], v[80:83], a[104:107], v[24:27]
    v_add_f32 v157, v157, v158
    v_add_f32 v157, v157, v159
    v_mfma_f32_16x16x32_bf16 v[24:27], v[84:87], a[108:111], v[24:27]
    v_exp_f32 v160, v42
    v_mfma_f32_16x16x32_bf16 a[32:35], v[88:91], v[48:51], a[32:35]
    v_cvt_pk_bf16_f32 v54, v158, v159
    v_mfma_f32_16x16x32_bf16 a[36:39], v[92:95], v[48:51], a[36:39]
    v_exp_f32 v161, v43
    v_mfma_f32_16x16x32_bf16 a[40:43], v[96:99], v[48:51], a[40:43]
    v_add_f32 v157, v157, v160
    v_add_f32 v157, v157, v161
    v_mfma_f32_16x16x32_bf16 a[44:47], v[100:103], v[48:51], a[44:47]
    v_cvt_pk_bf16_f32 v55, v160, v161
    v_cmp_nge_f32 vcc, s28, v157
    v_mfma_f32_16x16x32_bf16 a[48:51], v[104:107], v[48:51], a[48:51]
    v_exp_f32 v162, v20
    v_mfma_f32_16x16x32_bf16 a[52:55], v[108:111], v[48:51], a[52:55]
    v_exp_f32 v163, v21
    v_mfma_f32_16x16x32_bf16 a[56:59], v[112:115], v[48:51], a[56:59]
    v_add_f32 v152, v155, v162
    v_add_f32 v152, v152, v163
    v_mfma_f32_16x16x32_bf16 a[60:63], v[116:119], v[48:51], a[60:63]
    v_exp_f32 v164, v22
    v_mfma_f32_16x16x32_bf16 v[28:31], v[56:59], a[112:115], v[12:15]
    s_cbranch_vccnz L_rare_l1_1_2
L_back_l1_1_2:
    v_cvt_pk_bf16_f32 v44, v162, v163
    s_waitcnt vmcnt(3)
    buffer_load_dwordx4 v148, s[8:11], s51 offen offset:2048 nt lds
    v_mfma_f32_16x16x32_bf16 v[28:31], v[60:63], a[116:119], v[28:31]
    v_exp_f32 v165, v23
    v_mfma_f32_16x16x32_bf16 v[28:31], v[64:67], a[120:123], v[28:31]
    v_add_f32 v152, v152, v164
    v_add_f32 v152, v152, v165
    v_mfma_f32_16x16x32_bf16 v[28:31], v[68:71], a[124:127], v[28:31]
    v_exp_f32 v162, v24
    v_mfma_f32_16x16x32_bf16 v[32:35], v[72:75], a[112:115], v[12:15]
    v_cvt_pk_bf16_f32 v45, v164, v165
    v_mfma_f32_16x16x32_bf16 v[32:35], v[76:79], a[116:119], v[32:35]
    v_exp_f32 v163, v25
    v_mfma_f32_16x16x32_bf16 v[32:35], v[80:83], a[120:123], v[32:35]
    v_add_f32 v152, v152, v162
    v_add_f32 v152, v152, v163
    v_mfma_f32_16x16x32_bf16 v[32:35], v[84:87], a[124:127], v[32:35]
    v_exp_f32 v164, v26
    v_mfma_f32_16x16x32_bf16 a[64:67], v[88:91], v[52:55], a[64:67]
    ds_read_b64_tr_b16 v[88:89], v128 offset:40960
    v_cvt_pk_bf16_f32 v46, v162, v163
    v_mfma_f32_16x16x32_bf16 a[68:71], v[92:95], v[52:55], a[68:71]
    ds_read_b64_tr_b16 v[92:93], v129 offset:40960
    v_exp_f32 v165, v27
    v_mfma_f32_16x16x32_bf16 a[72:75], v[96:99], v[52:55], a[72:75]
    ds_read_b64_tr_b16 v[96:97], v130 offset:40960
    v_add_f32 v152, v152, v164
    v_add_f32 v152, v152, v165
    v_mfma_f32_16x16x32_bf16 a[76:79], v[100:103], v[52:55], a[76:79]
    ds_read_b64_tr_b16 v[100:101], v131 offset:40960
    v_cvt_pk_bf16_f32 v47, v164, v165
    v_cmp_nge_f32 vcc, s28, v152
    v_mfma_f32_16x16x32_bf16 a[80:83], v[104:107], v[52:55], a[80:83]
    ds_read_b64_tr_b16 v[104:105], v132 offset:40960
    v_exp_f32 v158, v28
    s_waitcnt vmcnt(3)
    buffer_load_dwordx4 v149, s[8:11], s51 offen offset:3072 nt lds
    v_mfma_f32_16x16x32_bf16 a[84:87], v[108:111], v[52:55], a[84:87]
    s_add_u32 s51, s51, 16384
    ds_read_b64_tr_b16 v[108:109], v133 offset:40960
    v_exp_f32 v159, v29
    v_mfma_f32_16x16x32_bf16 a[88:91], v[112:115], v[52:55], a[88:91]
    ds_read_b64_tr_b16 v[112:113], v134 offset:40960
    v_add_f32 v153, v156, v158
    v_add_f32 v153, v153, v159
    v_mfma_f32_16x16x32_bf16 a[92:95], v[116:119], v[52:55], a[92:95]
    ds_read_b64_tr_b16 v[116:117], v135 offset:40960
    v_exp_f32 v160, v30
    v_mfma_f32_16x16x32_bf16 v[36:39], v[56:59], a[128:131], v[16:19]
    s_cbranch_vccnz L_rare_l1_2_0
L_back_l1_2_0:
    ds_read_b64_tr_b16 v[94:95], v129 offset:45056
    ds_read_b64_tr_b16 v[90:91], v128 offset:45056
    v_cvt_pk_bf16_f32 v48, v158, v159
    v_mfma_f32_16x16x32_bf16 v[36:39], v[60:63], a[132:135], v[36:39]
    ds_read_b64_tr_b16 v[102:103], v131 offset:45056
    ds_read_b64_tr_b16 v[98:99], v130 offset:45056
    v_exp_f32 v161, v31
    v_mfma_f32_16x16x32_bf16 v[36:39], v[64:67], a[136:139], v[36:39]
    s_waitcnt vmcnt(8)
    ds_read_b64_tr_b16 v[110:111], v133 offset:45056
    ds_read_b64_tr_b16 v[106:107], v132 offset:45056
    v_add_f32 v153, v153, v160
    v_add_f32 v153, v153, v161
    v_mfma_f32_16x16x32_bf16 v[36:39], v[68:71], a[140:143], v[36:39]
    s_barrier
    ds_read_b64_tr_b16 v[118:119], v135 offset:45056
    ds_read_b64_tr_b16 v[114:115], v134 offset:45056
    v_exp_f32 v158, v32
    v_mfma_f32_16x16x32_bf16 v[40:43], v[72:75], a[128:131], v[16:19]
    ds_read_b128 v[56:59], v124 offset:0
    v_cvt_pk_bf16_f32 v49, v160, v161
    v_mfma_f32_16x16x32_bf16 v[40:43], v[76:79], a[132:135], v[40:43]
    ds_read_b128 v[60:63], v125 offset:0
    v_exp_f32 v159, v33
    v_mfma_f32_16x16x32_bf16 v[40:43], v[80:83], a[136:139], v[40:43]
    ds_read_b128 v[64:67], v126 offset:0
    v_add_f32 v153, v153, v158
    v_add_f32 v153, v153, v159
    v_mfma_f32_16x16x32_bf16 v[40:43], v[84:87], a[140:143], v[40:43]
    s_waitcnt lgkmcnt(3)
    ds_read_b128 v[68:71], v127 offset:0
    v_exp_f32 v160, v34
    v_mfma_f32_16x16x32_bf16 a[0:3], v[88:91], v[44:47], a[0:3]
    ds_read_b128 v[72:75], v124 offset:4096
    v_cvt_pk_bf16_f32 v50, v158, v159
    v_mfma_f32_16x16x32_bf16 a[4:7], v[92:95], v[44:47], a[4:7]
    s_add_u32 m0, s26, 32768
    ds_read_b128 v[76:79], v125 offset:4096
    v_exp_f32 v161, v35
    v_mfma_f32_16x16x32_bf16 a[8:11], v[96:99], v[44:47], a[8:11]
    ds_read_b128 v[80:83], v126 offset:4096
    v_add_f32 v153, v153, v160
    v_add_f32 v153, v153, v161
    v_mfma_f32_16x16x32_bf16 a[12:15], v[100:103], v[44:47], a[12:15]
    ds_read_b128 v[84:87], v127 offset:4096
    v_cvt_pk_bf16_f32 v51, v160, v161
    v_cmp_nge_f32 vcc, s28, v153
    v_mfma_f32_16x16x32_bf16 a[16:19], v[104:107], v[44:47], a[16:19]
    v_exp_f32 v162, v36
    s_waitcnt vmcnt(3)
    buffer_load_dwordx4 v144, s[4:7], s25 offen offset:0 nt lds
    v_mfma_f32_16x16x32_bf16 a[20:23], v[108:111], v[44:47], a[20:23]
    v_exp_f32 v163, v37
    v_mfma_f32_16x16x32_bf16 a[24:27], v[112:115], v[44:47], a[24:27]
    v_add_f32 v154, v157, v162
    v_add_f32 v154, v154, v163
    v_mfma_f32_16x16x32_bf16 a[28:31], v[116:119], v[44:47], a[28:31]
    s_waitcnt lgkmcnt(0)
    v_exp_f32 v164, v38
    s_waitcnt vmcnt(3)
    buffer_load_dwordx4 v145, s[4:7], s25 offen offset:1024 nt lds
    v_mfma_f32_16x16x32_bf16 v[20:23], v[56:59], a[96:99], v[8:11]
    s_cbranch_vccnz L_rare_l2_0_1
L_back_l2_0_1:
    v_cvt_pk_bf16_f32 v52, v162, v163
    v_mfma_f32_16x16x32_bf16 v[20:23], v[60:63], a[100:103], v[20:23]
    v_exp_f32 v165, v39
    v_mfma_f32_16x16x32_bf16 v[20:23], v[64:67], a[104:107], v[20:23]
    v_add_f32 v154, v154, v164
    v_add_f32 v154, v154, v165
    v_mfma_f32_16x16x32_bf16 v[20:23], v[68:71], a[108:111], v[20:23]
    v_exp_f32 v162, v40
    v_mfma_f32_16x16x32_bf16 v[24:27], v[72:75], a[96:99], v[8:11]
    v_cvt_pk_bf16_f32 v53, v164, v165
    v_mfma_f32_16x16x32_bf16 v[24:27], v[76:79], a[100:103], v[24:27]
    v_exp_f32 v163, v41
    v_mfma_f32_16x16x32_bf16 v[24:27], v[80:83], a[104:107], v[24:27]
    v_add_f32 v154, v154, v162
    v_add_f32 v154, v154, v163
    v_mfma_f32_16x16x32_bf16 v[24:27], v[84:87], a[108:111], v[24:27]
    v_exp_f32 v164, v42
    v_mfma_f32_16x16x32_bf16 a[32:35], v[88:91], v[48:51], a[32:35]
    v_cvt_pk_bf16_f32 v54, v162, v163
    s_waitcnt vmcnt(3)
    buffer_load_dwordx4 v146, s[4:7], s25 offen offset:2048 nt lds
    v_mfma_f32_16x16x32_bf16 a[36:39], v[92:95], v[48:51], a[36:39]
    v_exp_f32 v165, v43
    v_mfma_f32_16x16x32_bf16 a[40:43], v[96:99], v[48:51], a[40:43]
    v_add_f32 v154, v154, v164
    v_add_f32 v154, v154, v165
    v_mfma_f32_16x16x32_bf16 a[44:47], v[100:103], v[48:51], a[44:47]
    v_cvt_pk_bf16_f32 v55, v164, v165
    v_cmp_nge_f32 vcc, s28, v154
    v_mfma_f32_16x16x32_bf16 a[48:51], v[104:107], v[48:51], a[48:51]
    v_exp_f32 v158, v20
    v_mfma_f32_16x16x32_bf16 a[52:55], v[108:111], v[48:51], a[52:55]
    v_exp_f32 v159, v21
    v_mfma_f32_16x16x32_bf16 a[56:59], v[112:115], v[48:51], a[56:59]
    v_add_f32 v155, v152, v158
    v_add_f32 v155, v155, v159
    v_mfma_f32_16x16x32_bf16 a[60:63], v[116:119], v[48:51], a[60:63]
    v_exp_f32 v160, v22
    v_mfma_f32_16x16x32_bf16 v[28:31], v[56:59], a[112:115], v[12:15]
    s_cbranch_vccnz L_rare_l2_0_2
L_back_l2_0_2:
    v_cvt_pk_bf16_f32 v44, v158, v159
    v_mfma_f32_16x16x32_bf16 v[28:31], v[60:63], a[116:119], v[28:31]
    v_exp_f32 v161, v23
    v_mfma_f32_16x16x32_bf16 v[28:31], v[64:67], a[120:123], v[28:31]
    v_add_f32 v155, v155, v160
    v_add_f32 v155, v155, v161
    v_mfma_f32_16x16x32_bf16 v[28:31], v[68:71], a[124:127], v[28:31]
    v_exp_f32 v158, v24
    v_mfma_f32_16x16x32_bf16 v[32:35], v[72:75], a[112:115], v[12:15]
    v_cvt_pk_bf16_f32 v45, v160, v161
    s_waitcnt vmcnt(3)
    buffer_load_dwordx4 v147, s[4:7], s25 offen offset:3072 nt lds
    v_mfma_f32_16x16x32_bf16 v[32:35], v[76:79], a[116:119], v[32:35]
    s_add_u32 s25, s25, 16384
    v_exp_f32 v159, v25
    v_mfma_f32_16x16x32_bf16 v[32:35], v[80:83], a[120:123], v[32:35]
    v_add_f32 v155, v155, v158
    v_add_f32 v155, v155, v159
    v_mfma_f32_16x16x32_bf16 v[32:35], v[84:87], a[124:127], v[32:35]
    v_exp_f32 v160, v26
    v_mfma_f32_16x16x32_bf16 a[64:67], v[88:91], v[52:55], a[64:67]
    ds_read_b64_tr_b16 v[88:89], v136 offset:0
    v_cvt_pk_bf16_f32 v46, v158, v159
    v_mfma_f32_16x16x32_bf16 a[68:71], v[92:95], v[52:55], a[68:71]
    ds_read_b64_tr_b16 v[92:93], v137 offset:0
    v_exp_f32 v161, v27
    v_mfma_f32_16x16x32_bf16 a[72:75], v[96:99], v[52:55], a[72:75]
    ds_read_b64_tr_b16 v[96:97], v138 offset:0
    v_add_f32 v155, v155, v160
    v_add_f32 v155, v155, v161
    v_mfma_f32_16x16x32_bf16 a[76:79], v[100:103], v[52:55], a[76:79]
    ds_read_b64_tr_b16 v[100:101], v139 offset:0
    v_cvt_pk_bf16_f32 v47, v160, v161
    v_cmp_nge_f32 vcc, s28, v155
    v_mfma_f32_16x16x32_bf16 a[80:83], v[104:107], v[52:55], a[80:83]
    ds_read_b64_tr_b16 v[104:105], v140 offset:0
    v_exp_f32 v162, v28
    v_mfma_f32_16x16x32_bf16 a[84:87], v[108:111], v[52:55], a[84:87]
    ds_read_b64_tr_b16 v[108:109], v141 offset:0
    v_exp_f32 v163, v29
    v_mfma_f32_16x16x32_bf16 a[88:91], v[112:115], v[52:55], a[88:91]
    ds_read_b64_tr_b16 v[112:113], v142 offset:0
    v_add_f32 v156, v153, v162
    v_add_f32 v156, v156, v163
    v_mfma_f32_16x16x32_bf16 a[92:95], v[116:119], v[52:55], a[92:95]
    ds_read_b64_tr_b16 v[116:117], v143 offset:0
    v_exp_f32 v164, v30
    v_mfma_f32_16x16x32_bf16 v[36:39], v[56:59], a[128:131], v[16:19]
    s_cbranch_vccnz L_rare_l2_1_0
L_back_l2_1_0:
    ds_read_b64_tr_b16 v[94:95], v137 offset:4096
    ds_read_b64_tr_b16 v[90:91], v136 offset:4096
    v_cvt_pk_bf16_f32 v48, v162, v163
    v_mfma_f32_16x16x32_bf16 v[36:39], v[60:63], a[132:135], v[36:39]
    ds_read_b64_tr_b16 v[102:103], v139 offset:4096
    ds_read_b64_tr_b16 v[98:99], v138 offset:4096
    v_exp_f32 v165, v31
    v_mfma_f32_16x16x32_bf16 v[36:39], v[64:67], a[136:139], v[36:39]
    ds_read_b64_tr_b16 v[110:111], v141 offset:4096
    ds_read_b64_tr_b16 v[106:107], v140 offset:4096
    v_add_f32 v156, v156, v164
    v_add_f32 v156, v156, v165
    v_mfma_f32_16x16x32_bf16 v[36:39], v[68:71], a[140:143], v[36:39]
    ds_read_b64_tr_b16 v[118:119], v143 offset:4096
    ds_read_b64_tr_b16 v[114:115], v142 offset:4096
    v_exp_f32 v162, v32
    v_mfma_f32_16x16x32_bf16 v[40:43], v[72:75], a[128:131], v[16:19]
    ds_read_b128 v[56:59], v124 offset:8192
    v_cvt_pk_bf16_f32 v49, v164, v165
    v_mfma_f32_16x16x32_bf16 v[40:43], v[76:79], a[132:135], v[40:43]
    ds_read_b128 v[60:63], v125 offset:8192
    v_exp_f32 v163, v33
    v_mfma_f32_16x16x32_bf16 v[40:43], v[80:83], a[136:139], v[40:43]
    s_add_u32 m0, s26, 16384
    ds_read_b128 v[64:67], v126 offset:8192
    v_add_f32 v156, v156, v162
    v_add_f32 v156, v156, v163
    v_mfma_f32_16x16x32_bf16 v[40:43], v[84:87], a[140:143], v[40:43]
    s_waitcnt lgkmcnt(3)
    ds_read_b128 v[68:71], v127 offset:8192
    v_exp_f32 v164, v34
    v_mfma_f32_16x16x32_bf16 a[0:3], v[88:91], v[44:47], a[0:3]
    ds_read_b128 v[72:75], v124 offset:12288
    v_cvt_pk_bf16_f32 v50, v162, v163
    s_waitcnt vmcnt(3)
    buffer_load_dwordx4 v148, s[8:11], s51 offen offset:0 nt lds
    v_mfma_f32_16x16x32_bf16 a[4:7], v[92:95], v[44:47], a[4:7]
    ds_read_b128 v[76:79], v125 offset:12288
    v_exp_f32 v165, v35
    v_mfma_f32_16x16x32_bf16 a[8:11], v[96:99], v[44:47], a[8:11]
    ds_read_b128 v[80:83], v126 offset:12288
    v_add_f32 v156, v156, v164
    v_add_f32 v156, v156, v165
    v_mfma_f32_16x16x32_bf16 a[12:15], v[100:103], v[44:47], a[12:15]
    ds_read_b128 v[84:87], v127 offset:12288
    v_cvt_pk_bf16_f32 v51, v164, v165
    v_cmp_nge_f32 vcc, s28, v156
    v_mfma_f32_16x16x32_bf16 a[16:19], v[104:107], v[44:47], a[16:19]
    v_exp_f32 v158, v36
    v_mfma_f32_16x16x32_bf16 a[20:23], v[108:111], v[44:47], a[20:23]
    v_exp_f32 v159, v37
    v_mfma_f32_16x16x32_bf16 a[24:27], v[112:115], v[44:47], a[24:27]
    v_add_f32 v157, v154, v158
    v_add_f32 v157, v157, v159
    v_mfma_f32_16x16x32_bf16 a[28:31], v[116:119], v[44:47], a[28:31]
    s_waitcnt lgkmcnt(0)
    v_exp_f32 v160, v38
    v_mfma_f32_16x16x32_bf16 v[20:23], v[56:59], a[96:99], v[8:11]
    s_cbranch_vccnz L_rare_l2_1_1
L_back_l2_1_1:
    v_cvt_pk_bf16_f32 v52, v158, v159
    v_mfma_f32_16x16x32_bf16 v[20:23], v[60:63], a[100:103], v[20:23]
    v_exp_f32 v161, v39
    v_mfma_f32_16x16x32_bf16 v[20:23], v[64:67], a[104:107], v[20:23]
    v_add_f32 v157, v157, v160
    v_add_f32 v157, v157, v161
    v_mfma_f32_16x16x32_bf16 v[20:23], v[68:71], a[108:111], v[20:23]
    v_exp_f32 v158, v40
    v_mfma_f32_16x16x32_bf16 v[24:27], v[72:75], a[96:99], v[8:11]
    v_cvt_pk_bf16_f32 v53, v160, v161
    s_waitcnt vmcnt(4)
    buffer_load_dwordx4 v149, s[8:11], s51 offen offset:1024 nt lds
    v_mfma_f32_16x16x32_bf16 v[24:27], v[76:79], a[100:103], v[24:27]
    v_exp_f32 v159, v41
    v_mfma_f32_16x16x32_bf16 v[24:27], v[80:83], a[104:107], v[24:27]
    v_add_f32 v157, v157, v158
    v_add_f32 v157, v157, v159
    v_mfma_f32_16x16x32_bf16 v[24:27], v[84:87], a[108:111], v[24:27]
    v_exp_f32 v160, v42
    v_mfma_f32_16x16x32_bf16 a[32:35], v[88:91], v[48:51], a[32:35]
    v_cvt_pk_bf16_f32 v54, v158, v159
    v_mfma_f32_16x16x32_bf16 a[36:39], v[92:95], v[48:51], a[36:39]
    v_exp_f32 v161, v43
    v_mfma_f32_16x16x32_bf16 a[40:43], v[96:99], v[48:51], a[40:43]
    v_add_f32 v157, v157, v160
    v_add_f32 v157, v157, v161
    v_mfma_f32_16x16x32_bf16 a[44:47], v[100:103], v[48:51], a[44:47]
    v_cvt_pk_bf16_f32 v55, v160, v161
    v_cmp_nge_f32 vcc, s28, v157
    v_mfma_f32_16x16x32_bf16 a[48:51], v[104:107], v[48:51], a[48:51]
    v_exp_f32 v162, v20
    v_mfma_f32_16x16x32_bf16 a[52:55], v[108:111], v[48:51], a[52:55]
    v_exp_f32 v163, v21
    v_mfma_f32_16x16x32_bf16 a[56:59], v[112:115], v[48:51], a[56:59]
    v_add_f32 v152, v155, v162
    v_add_f32 v152, v152, v163
    v_mfma_f32_16x16x32_bf16 a[60:63], v[116:119], v[48:51], a[60:63]
    v_exp_f32 v164, v22
    v_mfma_f32_16x16x32_bf16 v[28:31], v[56:59], a[112:115], v[12:15]
    s_cbranch_vccnz L_rare_l2_1_2
L_back_l2_1_2:
    v_cvt_pk_bf16_f32 v44, v162, v163
    s_waitcnt vmcnt(4)
    buffer_load_dwordx4 v148, s[8:11], s51 offen offset:2048 nt lds
    v_mfma_f32_16x16x32_bf16 v[28:31], v[60:63], a[116:119], v[28:31]
    v_exp_f32 v165, v23
    v_mfma_f32_16x16x32_bf16 v[28:31], v[64:67], a[120:123], v[28:31]
    v_add_f32 v152, v152, v164
    v_add_f32 v152, v152, v165
    v_mfma_f32_16x16x32_bf16 v[28:31], v[68:71], a[124:127], v[28:31]
    v_exp_f32 v162, v24
    v_mfma_f32_16x16x32_bf16 v[32:35], v[72:75], a[112:115], v[12:15]
    v_cvt_pk_bf16_f32 v45, v164, v165
    v_mfma_f32_16x16x32_bf16 v[32:35], v[76:79], a[116:119], v[32:35]
    v_exp_f32 v163, v25
    v_mfma_f32_16x16x32_bf16 v[32:35], v[80:83], a[120:123], v[32:35]
    v_add_f32 v152, v152, v162
    v_add_f32 v152, v152, v163
    v_mfma_f32_16x16x32_bf16 v[32:35], v[84:87], a[124:127], v[32:35]
    v_exp_f32 v164, v26
    v_mfma_f32_16x16x32_bf16 a[64:67], v[88:91], v[52:55], a[64:67]
    ds_read_b64_tr_b16 v[88:89], v136 offset:8192
    v_cvt_pk_bf16_f32 v46, v162, v163
    v_mfma_f32_16x16x32_bf16 a[68:71], v[92:95], v[52:55], a[68:71]
    ds_read_b64_tr_b16 v[92:93], v137 offset:8192
    v_exp_f32 v165, v27
    v_mfma_f32_16x16x32_bf16 a[72:75], v[96:99], v[52:55], a[72:75]
    ds_read_b64_tr_b16 v[96:97], v138 offset:8192
    v_add_f32 v152, v152, v164
    v_add_f32 v152, v152, v165
    v_mfma_f32_16x16x32_bf16 a[76:79], v[100:103], v[52:55], a[76:79]
    ds_read_b64_tr_b16 v[100:101], v139 offset:8192
    v_cvt_pk_bf16_f32 v47, v164, v165
    v_cmp_nge_f32 vcc, s28, v152
    v_mfma_f32_16x16x32_bf16 a[80:83], v[104:107], v[52:55], a[80:83]
    ds_read_b64_tr_b16 v[104:105], v140 offset:8192
    v_exp_f32 v158, v28
    s_waitcnt vmcnt(4)
    buffer_load_dwordx4 v149, s[8:11], s51 offen offset:3072 nt lds
    v_mfma_f32_16x16x32_bf16 a[84:87], v[108:111], v[52:55], a[84:87]
    s_add_u32 s51, s51, 16384
    ds_read_b64_tr_b16 v[108:109], v141 offset:8192
    v_exp_f32 v159, v29
    v_mfma_f32_16x16x32_bf16 a[88:91], v[112:115], v[52:55], a[88:91]
    ds_read_b64_tr_b16 v[112:113], v142 offset:8192
    v_add_f32 v153, v156, v158
    v_add_f32 v153, v153, v159
    v_mfma_f32_16x16x32_bf16 a[92:95], v[116:119], v[52:55], a[92:95]
    ds_read_b64_tr_b16 v[116:117], v143 offset:8192
    v_exp_f32 v160, v30
    v_mfma_f32_16x16x32_bf16 v[36:39], v[56:59], a[128:131], v[16:19]
    s_cbranch_vccnz L_rare_l2_2_0
L_back_l2_2_0:
    ds_read_b64_tr_b16 v[94:95], v137 offset:12288
    ds_read_b64_tr_b16 v[90:91], v136 offset:12288
    v_cvt_pk_bf16_f32 v48, v158, v159
    v_mfma_f32_16x16x32_bf16 v[36:39], v[60:63], a[132:135], v[36:39]
    ds_read_b64_tr_b16 v[102:103], v139 offset:12288
    ds_read_b64_tr_b16 v[98:99], v138 offset:12288
    v_exp_f32 v161, v31
    v_mfma_f32_16x16x32_bf16 v[36:39], v[64:67], a[136:139], v[36:39]
    s_waitcnt vmcnt(8)
    ds_read_b64_tr_b16 v[110:111], v141 offset:12288
    ds_read_b64_tr_b16 v[106:107], v140 offset:12288
    v_add_f32 v153, v153, v160
    v_add_f32 v153, v153, v161
    v_mfma_f32_16x16x32_bf16 v[36:39], v[68:71], a[140:143], v[36:39]
    s_barrier
    ds_read_b64_tr_b16 v[118:119], v143 offset:12288
    ds_read_b64_tr_b16 v[114:115], v142 offset:12288
    v_exp_f32 v158, v32
    v_mfma_f32_16x16x32_bf16 v[40:43], v[72:75], a[128:131], v[16:19]
    ds_read_b128 v[56:59], v124 offset:32768
    v_cvt_pk_bf16_f32 v49, v160, v161
    v_mfma_f32_16x16x32_bf16 v[40:43], v[76:79], a[132:135], v[40:43]
    ds_read_b128 v[60:63], v125 offset:32768
    v_exp_f32 v159, v33
    v_mfma_f32_16x16x32_bf16 v[40:43], v[80:83], a[136:139], v[40:43]
    ds_read_b128 v[64:67], v126 offset:32768
    v_add_f32 v153, v153, v158
    v_add_f32 v153, v153, v159
    v_mfma_f32_16x16x32_bf16 v[40:43], v[84:87], a[140:143], v[40:43]
    s_waitcnt lgkmcnt(3)
    ds_read_b128 v[68:71], v127 offset:32768
    v_exp_f32 v160, v34
    v_mfma_f32_16x16x32_bf16 a[0:3], v[88:91], v[44:47], a[0:3]
    ds_read_b128 v[72:75], v124 offset:36864
    v_cvt_pk_bf16_f32 v50, v158, v159
    v_mfma_f32_16x16x32_bf16 a[4:7], v[92:95], v[44:47], a[4:7]
    s_add_u32 m0, s26, 65536
    ds_read_b128 v[76:79], v125 offset:36864
    v_exp_f32 v161, v35
    v_mfma_f32_16x16x32_bf16 a[8:11], v[96:99], v[44:47], a[8:11]
    ds_read_b128 v[80:83], v126 offset:36864
    v_add_f32 v153, v153, v160
    v_add_f32 v153, v153, v161
    v_mfma_f32_16x16x32_bf16 a[12:15], v[100:103], v[44:47], a[12:15]
    ds_read_b128 v[84:87], v127 offset:36864
    v_cvt_pk_bf16_f32 v51, v160, v161
    v_cmp_nge_f32 vcc, s28, v153
    v_mfma_f32_16x16x32_bf16 a[16:19], v[104:107], v[44:47], a[16:19]
    v_exp_f32 v162, v36
    s_waitcnt vmcnt(4)
    buffer_load_dwordx4 v144, s[4:7], s25 offen offset:0 nt lds
    v_mfma_f32_16x16x32_bf16 a[20:23], v[108:111], v[44:47], a[20:23]
    v_exp_f32 v163, v37
    v_mfma_f32_16x16x32_bf16 a[24:27], v[112:115], v[44:47], a[24:27]
    v_add_f32 v154, v157, v162
    v_add_f32 v154, v154, v163
    v_mfma_f32_16x16x32_bf16 a[28:31], v[116:119], v[44:47], a[28:31]
    s_waitcnt lgkmcnt(0)
    v_exp_f32 v164, v38
    s_waitcnt vmcnt(3)
    buffer_load_dwordx4 v145, s[4:7], s25 offen offset:1024 nt lds
    v_mfma_f32_16x16x32_bf16 v[20:23], v[56:59], a[96:99], v[8:11]
    s_cbranch_vccnz L_rare_l3_0_1
L_back_l3_0_1:
    v_cvt_pk_bf16_f32 v52, v162, v163
    v_mfma_f32_16x16x32_bf16 v[20:23], v[60:63], a[100:103], v[20:23]
    v_exp_f32 v165, v39
    v_mfma_f32_16x16x32_bf16 v[20:23], v[64:67], a[104:107], v[20:23]
    v_add_f32 v154, v154, v164
    v_add_f32 v154, v154, v165
    v_mfma_f32_16x16x32_bf16 v[20:23], v[68:71], a[108:111], v[20:23]
    v_exp_f32 v162, v40
    v_mfma_f32_16x16x32_bf16 v[24:27], v[72:75], a[96:99], v[8:11]
    v_cvt_pk_bf16_f32 v53, v164, v165
    v_mfma_f32_16x16x32_bf16 v[24:27], v[76:79], a[100:103], v[24:27]
    v_exp_f32 v163, v41
    v_mfma_f32_16x16x32_bf16 v[24:27], v[80:83], a[104:107], v[24:27]
    v_add_f32 v154, v154, v162
    v_add_f32 v154, v154, v163
    v_mfma_f32_16x16x32_bf16 v[24:27], v[84:87], a[108:111], v[24:27]
    v_exp_f32 v164, v42
    v_mfma_f32_16x16x32_bf16 a[32:35], v[88:91], v[48:51], a[32:35]
    v_cvt_pk_bf16_f32 v54, v162, v163
    s_waitcnt vmcnt(3)
    buffer_load_dwordx4 v146, s[4:7], s25 offen offset:2048 nt lds
    v_mfma_f32_16x16x32_bf16 a[36:39], v[92:95], v[48:51], a[36:39]
    v_exp_f32 v165, v43
    v_mfma_f32_16x16x32_bf16 a[40:43], v[96:99], v[48:51], a[40:43]
    v_add_f32 v154, v154, v164
    v_add_f32 v154, v154, v165
    v_mfma_f32_16x16x32_bf16 a[44:47], v[100:103], v[48:51], a[44:47]
    v_cvt_pk_bf16_f32 v55, v164, v165
    v_cmp_nge_f32 vcc, s28, v154
    v_mfma_f32_16x16x32_bf16 a[48:51], v[104:107], v[48:51], a[48:51]
    v_exp_f32 v158, v20
    v_mfma_f32_16x16x32_bf16 a[52:55], v[108:111], v[48:51], a[52:55]
    v_exp_f32 v159, v21
    v_mfma_f32_16x16x32_bf16 a[56:59], v[112:115], v[48:51], a[56:59]
    v_add_f32 v155, v152, v158
    v_add_f32 v155, v155, v159
    v_mfma_f32_16x16x32_bf16 a[60:63], v[116:119], v[48:51], a[60:63]
    v_exp_f32 v160, v22
    v_mfma_f32_16x16x32_bf16 v[28:31], v[56:59], a[112:115], v[12:15]
    s_cbranch_vccnz L_rare_l3_0_2
L_back_l3_0_2:
    v_cvt_pk_bf16_f32 v44, v158, v159
    v_mfma_f32_16x16x32_bf16 v[28:31], v[60:63], a[116:119], v[28:31]
    v_exp_f32 v161, v23
    v_mfma_f32_16x16x32_bf16 v[28:31], v[64:67], a[120:123], v[28:31]
    v_add_f32 v155, v155, v160
    v_add_f32 v155, v155, v161
    v_mfma_f32_16x16x32_bf16 v[28:31], v[68:71], a[124:127], v[28:31]
    v_exp_f32 v158, v24
    v_mfma_f32_16x16x32_bf16 v[32:35], v[72:75], a[112:115], v[12:15]
    v_cvt_pk_bf16_f32 v45, v160, v161
    s_waitcnt vmcnt(3)
    buffer_load_dwordx4 v147, s[4:7], s25 offen offset:3072 nt lds
    v_mfma_f32_16x16x32_bf16 v[32:35], v[76:79], a[116:119], v[32:35]
    s_add_u32 s25, s25, 16384
    v_exp_f32 v159, v25
    v_mfma_f32_16x16x32_bf16 v[32:35], v[80:83], a[120:123], v[32:35]
    v_add_f32 v155, v155, v158
    v_add_f32 v155, v155, v159
    v_mfma_f32_16x16x32_bf16 v[32:35], v[84:87], a[124:127], v[32:35]
    v_exp_f32 v160, v26
    v_mfma_f32_16x16x32_bf16 a[64:67], v[88:91], v[52:55], a[64:67]
    ds_read_b64_tr_b16 v[88:89], v136 offset:32768
    v_cvt_pk_bf16_f32 v46, v158, v159
    v_mfma_f32_16x16x32_bf16 a[68:71], v[92:95], v[52:55], a[68:71]
    ds_read_b64_tr_b16 v[92:93], v137 offset:32768
    v_exp_f32 v161, v27
    v_mfma_f32_16x16x32_bf16 a[72:75], v[96:99], v[52:55], a[72:75]
    ds_read_b64_tr_b16 v[96:97], v138 offset:32768
    v_add_f32 v155, v155, v160
    v_add_f32 v155, v155, v161
    v_mfma_f32_16x16x32_bf16 a[76:79], v[100:103], v[52:55], a[76:79]
    ds_read_b64_tr_b16 v[100:101], v139 offset:32768
    v_cvt_pk_bf16_f32 v47, v160, v161
    v_cmp_nge_f32 vcc, s28, v155
    v_mfma_f32_16x16x32_bf16 a[80:83], v[104:107], v[52:55], a[80:83]
    ds_read_b64_tr_b16 v[104:105], v140 offset:32768
    v_exp_f32 v162, v28
    v_mfma_f32_16x16x32_bf16 a[84:87], v[108:111], v[52:55], a[84:87]
    ds_read_b64_tr_b16 v[108:109], v141 offset:32768
    v_exp_f32 v163, v29
    v_mfma_f32_16x16x32_bf16 a[88:91], v[112:115], v[52:55], a[88:91]
    ds_read_b64_tr_b16 v[112:113], v142 offset:32768
    v_add_f32 v156, v153, v162
    v_add_f32 v156, v156, v163
    v_mfma_f32_16x16x32_bf16 a[92:95], v[116:119], v[52:55], a[92:95]
    ds_read_b64_tr_b16 v[116:117], v143 offset:32768
    v_exp_f32 v164, v30
    v_mfma_f32_16x16x32_bf16 v[36:39], v[56:59], a[128:131], v[16:19]
    s_cbranch_vccnz L_rare_l3_1_0
L_back_l3_1_0:
    ds_read_b64_tr_b16 v[94:95], v137 offset:36864
    ds_read_b64_tr_b16 v[90:91], v136 offset:36864
    v_cvt_pk_bf16_f32 v48, v162, v163
    v_mfma_f32_16x16x32_bf16 v[36:39], v[60:63], a[132:135], v[36:39]
    ds_read_b64_tr_b16 v[102:103], v139 offset:36864
    ds_read_b64_tr_b16 v[98:99], v138 offset:36864
    v_exp_f32 v165, v31
    v_mfma_f32_16x16x32_bf16 v[36:39], v[64:67], a[136:139], v[36:39]
    ds_read_b64_tr_b16 v[110:111], v141 offset:36864
    ds_read_b64_tr_b16 v[106:107], v140 offset:36864
    v_add_f32 v156, v156, v164
    v_add_f32 v156, v156, v165
    v_mfma_f32_16x16x32_bf16 v[36:39], v[68:71], a[140:143], v[36:39]
    ds_read_b64_tr_b16 v[118:119], v143 offset:36864
    ds_read_b64_tr_b16 v[114:115], v142 offset:36864
    v_exp_f32 v162, v32
    v_mfma_f32_16x16x32_bf16 v[40:43], v[72:75], a[128:131], v[16:19]
    ds_read_b128 v[56:59], v124 offset:40960
    v_cvt_pk_bf16_f32 v49, v164, v165
    v_mfma_f32_16x16x32_bf16 v[40:43], v[76:79], a[132:135], v[40:43]
    ds_read_b128 v[60:63], v125 offset:40960
    v_exp_f32 v163, v33
    v_mfma_f32_16x16x32_bf16 v[40:43], v[80:83], a[136:139], v[40:43]
    s_add_u32 m0, s26, 49152
    ds_read_b128 v[64:67], v126 offset:40960
    v_add_f32 v156, v156, v162
    v_add_f32 v156, v156, v163
    v_mfma_f32_16x16x32_bf16 v[40:43], v[84:87], a[140:143], v[40:43]
    s_waitcnt lgkmcnt(3)
    ds_read_b128 v[68:71], v127 offset:40960
    v_exp_f32 v164, v34
    v_mfma_f32_16x16x32_bf16 a[0:3], v[88:91], v[44:47], a[0:3]
    ds_read_b128 v[72:75], v124 offset:45056
    v_cvt_pk_bf16_f32 v50, v162, v163
    s_waitcnt vmcnt(3)
    buffer_load_dwordx4 v148, s[8:11], s51 offen offset:0 nt lds
    v_mfma_f32_16x16x32_bf16 a[4:7], v[92:95], v[44:47], a[4:7]
    ds_read_b128 v[76:79], v125 offset:45056
    v_exp_f32 v165, v35
    v_mfma_f32_16x16x32_bf16 a[8:11], v[96:99], v[44:47], a[8:11]
    ds_read_b128 v[80:83], v126 offset:45056
    v_add_f32 v156, v156, v164
    v_add_f32 v156, v156, v165
    v_mfma_f32_16x16x32_bf16 a[12:15], v[100:103], v[44:47], a[12:15]
    ds_read_b128 v[84:87], v127 offset:45056
    v_cvt_pk_bf16_f32 v51, v164, v165
    v_cmp_nge_f32 vcc, s28, v156
    v_mfma_f32_16x16x32_bf16 a[16:19], v[104:107], v[44:47], a[16:19]
    v_exp_f32 v158, v36
    v_mfma_f32_16x16x32_bf16 a[20:23], v[108:111], v[44:47], a[20:23]
    v_exp_f32 v159, v37
    v_mfma_f32_16x16x32_bf16 a[24:27], v[112:115], v[44:47], a[24:27]
    v_add_f32 v157, v154, v158
    v_add_f32 v157, v157, v159
    v_mfma_f32_16x16x32_bf16 a[28:31], v[116:119], v[44:47], a[28:31]
    s_waitcnt lgkmcnt(0)
    v_exp_f32 v160, v38
    v_mfma_f32_16x16x32_bf16 v[20:23], v[56:59], a[96:99], v[8:11]
    s_cbranch_vccnz L_rare_l3_1_1
L_back_l3_1_1:
    v_cvt_pk_bf16_f32 v52, v158, v159
    v_mfma_f32_16x16x32_bf16 v[20:23], v[60:63], a[100:103], v[20:23]
    v_exp_f32 v161, v39
    v_mfma_f32_16x16x32_bf16 v[20:23], v[64:67], a[104:107], v[20:23]
    v_add_f32 v157, v157, v160
    v_add_f32 v157, v157, v161
    v_mfma_f32_16x16x32_bf16 v[20:23], v[68:71], a[108:111], v[20:23]
    v_exp_f32 v158, v40
    v_mfma_f32_16x16x32_bf16 v[24:27], v[72:75], a[96:99], v[8:11]
    v_cvt_pk_bf16_f32 v53, v160, v161
    s_waitcnt vmcnt(3)
    buffer_load_dwordx4 v149, s[8:11], s51 offen offset:1024 nt lds
    v_mfma_f32_16x16x32_bf16 v[24:27], v[76:79], a[100:103], v[24:27]
    v_exp_f32 v159, v41
    v_mfma_f32_16x16x32_bf16 v[24:27], v[80:83], a[104:107], v[24:27]
    v_add_f32 v157, v157, v158
    v_add_f32 v157, v157, v159
    v_mfma_f32_16x16x32_bf16 v[24:27], v[84:87], a[108:111], v[24:27]
    v_exp_f32 v160, v42
    v_mfma_f32_16x16x32_bf16 a[32:35], v[88:91], v[48:51], a[32:35]
    v_cvt_pk_bf16_f32 v54, v158, v159
    v_mfma_f32_16x16x32_bf16 a[36:39], v[92:95], v[48:51], a[36:39]
    v_exp_f32 v161, v43
    v_mfma_f32_16x16x32_bf16 a[40:43], v[96:99], v[48:51], a[40:43]
    v_add_f32 v157, v157, v160
    v_add_f32 v157, v157, v161
    v_mfma_f32_16x16x32_bf16 a[44:47], v[100:103], v[48:51], a[44:47]
    v_cvt_pk_bf16_f32 v55, v160, v161
    v_cmp_nge_f32 vcc, s28, v157
    v_mfma_f32_16x16x32_bf16 a[48:51], v[104:107], v[48:51], a[48:51]
    v_exp_f32 v162, v20
    v_mfma_f32_16x16x32_bf16 a[52:55], v[108:111], v[48:51], a[52:55]
    v_exp_f32 v163, v21
    v_mfma_f32_16x16x32_bf16 a[56:59], v[112:115], v[48:51], a[56:59]
    v_add_f32 v152, v155, v162
    v_add_f32 v152, v152, v163
    v_mfma_f32_16x16x32_bf16 a[60:63], v[116:119], v[48:51], a[60:63]
    v_exp_f32 v164, v22
    v_mfma_f32_16x16x32_bf16 v[28:31], v[56:59], a[112:115], v[12:15]
    s_cbranch_vccnz L_rare_l3_1_2
L_back_l3_1_2:
    v_cvt_pk_bf16_f32 v44, v162, v163
    s_waitcnt vmcnt(3)
    buffer_load_dwordx4 v148, s[8:11], s51 offen offset:2048 nt lds
    v_mfma_f32_16x16x32_bf16 v[28:31], v[60:63], a[116:119], v[28:31]
    v_exp_f32 v165, v23
    v_mfma_f32_16x16x32_bf16 v[28:31], v[64:67], a[120:123], v[28:31]
    v_add_f32 v152, v152, v164
    v_add_f32 v152, v152, v165
    v_mfma_f32_16x16x32_bf16 v[28:31], v[68:71], a[124:127], v[28:31]
    v_exp_f32 v162, v24
    v_mfma_f32_16x16x32_bf16 v[32:35], v[72:75], a[112:115], v[12:15]
    v_cvt_pk_bf16_f32 v45, v164, v165
    v_mfma_f32_16x16x32_bf16 v[32:35], v[76:79], a[116:119], v[32:35]
    v_exp_f32 v163, v25
    v_mfma_f32_16x16x32_bf16 v[32:35], v[80:83], a[120:123], v[32:35]
    v_add_f32 v152, v152, v162
    v_add_f32 v152, v152, v163
    v_mfma_f32_16x16x32_bf16 v[32:35], v[84:87], a[124:127], v[32:35]
    v_exp_f32 v164, v26
    v_mfma_f32_16x16x32_bf16 a[64:67], v[88:91], v[52:55], a[64:67]
    ds_read_b64_tr_b16 v[88:89], v136 offset:40960
    v_cvt_pk_bf16_f32 v46, v162, v163
    v_mfma_f32_16x16x32_bf16 a[68:71], v[92:95], v[52:55], a[68:71]
    ds_read_b64_tr_b16 v[92:93], v137 offset:40960
    v_exp_f32 v165, v27
    v_mfma_f32_16x16x32_bf16 a[72:75], v[96:99], v[52:55], a[72:75]
    ds_read_b64_tr_b16 v[96:97], v138 offset:40960
    v_add_f32 v152, v152, v164
    v_add_f32 v152, v152, v165
    v_mfma_f32_16x16x32_bf16 a[76:79], v[100:103], v[52:55], a[76:79]
    ds_read_b64_tr_b16 v[100:101], v139 offset:40960
    v_cvt_pk_bf16_f32 v47, v164, v165
    v_cmp_nge_f32 vcc, s28, v152
    v_mfma_f32_16x16x32_bf16 a[80:83], v[104:107], v[52:55], a[80:83]
    ds_read_b64_tr_b16 v[104:105], v140 offset:40960
    v_exp_f32 v158, v28
    s_waitcnt vmcnt(3)
    buffer_load_dwordx4 v149, s[8:11], s51 offen offset:3072 nt lds
    v_mfma_f32_16x16x32_bf16 a[84:87], v[108:111], v[52:55], a[84:87]
    s_add_u32 s51, s51, 16384
    ds_read_b64_tr_b16 v[108:109], v141 offset:40960
    v_exp_f32 v159, v29
    v_mfma_f32_16x16x32_bf16 a[88:91], v[112:115], v[52:55], a[88:91]
    ds_read_b64_tr_b16 v[112:113], v142 offset:40960
    v_add_f32 v153, v156, v158
    v_add_f32 v153, v153, v159
    v_mfma_f32_16x16x32_bf16 a[92:95], v[116:119], v[52:55], a[92:95]
    ds_read_b64_tr_b16 v[116:117], v143 offset:40960
    v_exp_f32 v160, v30
    v_mfma_f32_16x16x32_bf16 v[36:39], v[56:59], a[128:131], v[16:19]
    s_cbranch_vccnz L_rare_l3_2_0
L_back_l3_2_0:
    ds_read_b64_tr_b16 v[94:95], v137 offset:45056
    ds_read_b64_tr_b16 v[90:91], v136 offset:45056
    v_cvt_pk_bf16_f32 v48, v158, v159
    v_mfma_f32_16x16x32_bf16 v[36:39], v[60:63], a[132:135], v[36:39]
    ds_read_b64_tr_b16 v[102:103], v139 offset:45056
    ds_read_b64_tr_b16 v[98:99], v138 offset:45056
    v_exp_f32 v161, v31
    v_mfma_f32_16x16x32_bf16 v[36:39], v[64:67], a[136:139], v[36:39]
    s_waitcnt vmcnt(8)
    ds_read_b64_tr_b16 v[110:111], v141 offset:45056
    ds_read_b64_tr_b16 v[106:107], v140 offset:45056
    v_add_f32 v153, v153, v160
    v_add_f32 v153, v153, v161
    v_mfma_f32_16x16x32_bf16 v[36:39], v[68:71], a[140:143], v[36:39]
    s_barrier
    ds_read_b64_tr_b16 v[118:119], v143 offset:45056
    ds_read_b64_tr_b16 v[114:115], v142 offset:45056
    v_exp_f32 v158, v32
    v_mfma_f32_16x16x32_bf16 v[40:43], v[72:75], a[128:131], v[16:19]
    ds_read_b128 v[56:59], v120 offset:0
    v_cvt_pk_bf16_f32 v49, v160, v161
    v_mfma_f32_16x16x32_bf16 v[40:43], v[76:79], a[132:135], v[40:43]
    ds_read_b128 v[60:63], v121 offset:0
    v_exp_f32 v159, v33
    v_mfma_f32_16x16x32_bf16 v[40:43], v[80:83], a[136:139], v[40:43]
    ds_read_b128 v[64:67], v122 offset:0
    v_add_f32 v153, v153, v158
    v_add_f32 v153, v153, v159
    v_mfma_f32_16x16x32_bf16 v[40:43], v[84:87], a[140:143], v[40:43]
    s_waitcnt lgkmcnt(3)
    ds_read_b128 v[68:71], v123 offset:0
    v_exp_f32 v160, v34
    v_mfma_f32_16x16x32_bf16 a[0:3], v[88:91], v[44:47], a[0:3]
    ds_read_b128 v[72:75], v120 offset:4096
    v_cvt_pk_bf16_f32 v50, v158, v159
    v_mfma_f32_16x16x32_bf16 a[4:7], v[92:95], v[44:47], a[4:7]
    s_add_u32 m0, s26, 98304
    ds_read_b128 v[76:79], v121 offset:4096
    v_exp_f32 v161, v35
    v_mfma_f32_16x16x32_bf16 a[8:11], v[96:99], v[44:47], a[8:11]
    ds_read_b128 v[80:83], v122 offset:4096
    v_add_f32 v153, v153, v160
    v_add_f32 v153, v153, v161
    v_mfma_f32_16x16x32_bf16 a[12:15], v[100:103], v[44:47], a[12:15]
    ds_read_b128 v[84:87], v123 offset:4096
    v_cvt_pk_bf16_f32 v51, v160, v161
    v_cmp_nge_f32 vcc, s28, v153
    v_mfma_f32_16x16x32_bf16 a[16:19], v[104:107], v[44:47], a[16:19]
    v_exp_f32 v162, v36
    s_waitcnt vmcnt(4)
    buffer_load_dwordx4 v144, s[4:7], s25 offen offset:0 nt lds
    v_mfma_f32_16x16x32_bf16 a[20:23], v[108:111], v[44:47], a[20:23]
    v_exp_f32 v163, v37
    v_mfma_f32_16x16x32_bf16 a[24:27], v[112:115], v[44:47], a[24:27]
    v_add_f32 v154, v157, v162
    v_add_f32 v154, v154, v163
    v_mfma_f32_16x16x32_bf16 a[28:31], v[116:119], v[44:47], a[28:31]
    s_waitcnt lgkmcnt(0)
    v_exp_f32 v164, v38
    s_waitcnt vmcnt(4)
    buffer_load_dwordx4 v145, s[4:7], s25 offen offset:1024 nt lds
    v_mfma_f32_16x16x32_bf16 v[20:23], v[56:59], a[96:99], v[8:11]
    s_cbranch_vccnz L_rare_l4_0_1
L_back_l4_0_1:
    v_cvt_pk_bf16_f32 v52, v162, v163
    v_mfma_f32_16x16x32_bf16 v[20:23], v[60:63], a[100:103], v[20:23]
    v_exp_f32 v165, v39
    v_mfma_f32_16x16x32_bf16 v[20:23], v[64:67], a[104:107], v[20:23]
    v_add_f32 v154, v154, v164
    v_add_f32 v154, v154, v165
    v_mfma_f32_16x16x32_bf16 v[20:23], v[68:71], a[108:111], v[20:23]
    v_exp_f32 v162, v40
    v_mfma_f32_16x16x32_bf16 v[24:27], v[72:75], a[96:99], v[8:11]
    v_cvt_pk_bf16_f32 v53, v164, v165
    v_mfma_f32_16x16x32_bf16 v[24:27], v[76:79], a[100:103], v[24:27]
    v_exp_f32 v163, v41
    v_mfma_f32_16x16x32_bf16 v[24:27], v[80:83], a[104:107], v[24:27]
    v_add_f32 v154, v154, v162
    v_add_f32 v154, v154, v163
    v_mfma_f32_16x16x32_bf16 v[24:27], v[84:87], a[108:111], v[24:27]
    v_exp_f32 v164, v42
    v_mfma_f32_16x16x32_bf16 a[32:35], v[88:91], v[48:51], a[32:35]
    v_cvt_pk_bf16_f32 v54, v162, v163
    s_waitcnt vmcnt(4)
    buffer_load_dwordx4 v146, s[4:7], s25 offen offset:2048 nt lds
    v_mfma_f32_16x16x32_bf16 a[36:39], v[92:95], v[48:51], a[36:39]
    v_exp_f32 v165, v43
    v_mfma_f32_16x16x32_bf16 a[40:43], v[96:99], v[48:51], a[40:43]
    v_add_f32 v154, v154, v164
    v_add_f32 v154, v154, v165
    v_mfma_f32_16x16x32_bf16 a[44:47], v[100:103], v[48:51], a[44:47]
    v_cvt_pk_bf16_f32 v55, v164, v165
    v_cmp_nge_f32 vcc, s28, v154
    v_mfma_f32_16x16x32_bf16 a[48:51], v[104:107], v[48:51], a[48:51]
    v_exp_f32 v158, v20
    v_mfma_f32_16x16x32_bf16 a[52:55], v[108:111], v[48:51], a[52:55]
    v_exp_f32 v159, v21
    v_mfma_f32_16x16x32_bf16 a[56:59], v[112:115], v[48:51], a[56:59]
    v_add_f32 v155, v152, v158
    v_add_f32 v155, v155, v159
    v_mfma_f32_16x16x32_bf16 a[60:63], v[116:119], v[48:51], a[60:63]
    v_exp_f32 v160, v22
    v_mfma_f32_16x16x32_bf16 v[28:31], v[56:59], a[112:115], v[12:15]
    s_cbranch_vccnz L_rare_l4_0_2
L_back_l4_0_2:
    v_cvt_pk_bf16_f32 v44, v158, v159
    v_mfma_f32_16x16x32_bf16 v[28:31], v[60:63], a[116:119], v[28:31]
    v_exp_f32 v161, v23
    v_mfma_f32_16x16x32_bf16 v[28:31], v[64:67], a[120:123], v[28:31]
    v_add_f32 v155, v155, v160
    v_add_f32 v155, v155, v161
    v_mfma_f32_16x16x32_bf16 v[28:31], v[68:71], a[124:127], v[28:31]
    v_exp_f32 v158, v24
    v_mfma_f32_16x16x32_bf16 v[32:35], v[72:75], a[112:115], v[12:15]
    v_cvt_pk_bf16_f32 v45, v160, v161
    s_waitcnt vmcnt(4)
    buffer_load_dwordx4 v147, s[4:7], s25 offen offset:3072 nt lds
    v_mfma_f32_16x16x32_bf16 v[32:35], v[76:79], a[116:119], v[32:35]
    s_add_u32 s25, s25, 16384
    v_exp_f32 v159, v25
    v_mfma_f32_16x16x32_bf16 v[32:35], v[80:83], a[120:123], v[32:35]
    v_add_f32 v155, v155, v158
    v_add_f32 v155, v155, v159
    v_mfma_f32_16x16x32_bf16 v[32:35], v[84:87], a[124:127], v[32:35]
    v_exp_f32 v160, v26
    v_mfma_f32_16x16x32_bf16 a[64:67], v[88:91], v[52:55], a[64:67]
    ds_read_b64_tr_b16 v[88:89], v128 offset:0
    v_cvt_pk_bf16_f32 v46, v158, v159
    v_mfma_f32_16x16x32_bf16 a[68:71], v[92:95], v[52:55], a[68:71]
    ds_read_b64_tr_b16 v[92:93], v129 offset:0
    v_exp_f32 v161, v27
    v_mfma_f32_16x16x32_bf16 a[72:75], v[96:99], v[52:55], a[72:75]
    ds_read_b64_tr_b16 v[96:97], v130 offset:0
    v_add_f32 v155, v155, v160
    v_add_f32 v155, v155, v161
    v_mfma_f32_16x16x32_bf16 a[76:79], v[100:103], v[52:55], a[76:79]
    ds_read_b64_tr_b16 v[100:101], v131 offset:0
    v_cvt_pk_bf16_f32 v47, v160, v161
    v_cmp_nge_f32 vcc, s28, v155
    v_mfma_f32_16x16x32_bf16 a[80:83], v[104:107], v[52:55], a[80:83]
    ds_read_b64_tr_b16 v[104:105], v132 offset:0
    v_exp_f32 v162, v28
    v_mfma_f32_16x16x32_bf16 a[84:87], v[108:111], v[52:55], a[84:87]
    ds_read_b64_tr_b16 v[108:109], v133 offset:0
    v_exp_f32 v163, v29
    v_mfma_f32_16x16x32_bf16 a[88:91], v[112:115], v[52:55], a[88:91]
    ds_read_b64_tr_b16 v[112:113], v134 offset:0
    v_add_f32 v156, v153, v162
    v_add_f32 v156, v156, v163
    v_mfma_f32_16x16x32_bf16 a[92:95], v[116:119], v[52:55], a[92:95]
    ds_read_b64_tr_b16 v[116:117], v135 offset:0
    v_exp_f32 v164, v30
    v_mfma_f32_16x16x32_bf16 v[36:39], v[56:59], a[128:131], v[16:19]
    s_cbranch_vccnz L_rare_l4_1_0
L_back_l4_1_0:
    ds_read_b64_tr_b16 v[94:95], v129 offset:4096
    ds_read_b64_tr_b16 v[90:91], v128 offset:4096
    v_cvt_pk_bf16_f32 v48, v162, v163
    v_mfma_f32_16x16x32_bf16 v[36:39], v[60:63], a[132:135], v[36:39]
    ds_read_b64_tr_b16 v[102:103], v131 offset:4096
    ds_read_b64_tr_b16 v[98:99], v130 offset:4096
    v_exp_f32 v165, v31
    v_mfma_f32_16x16x32_bf16 v[36:39], v[64:67], a[136:139], v[36:39]
    ds_read_b64_tr_b16 v[110:111], v133 offset:4096
    ds_read_b64_tr_b16 v[106:107], v132 offset:4096
    v_add_f32 v156, v156, v164
    v_add_f32 v156, v156, v165
    v_mfma_f32_16x16x32_bf16 v[36:39], v[68:71], a[140:143], v[36:39]
    ds_read_b64_tr_b16 v[118:119], v135 offset:4096
    ds_read_b64_tr_b16 v[114:115], v134 offset:4096
    v_exp_f32 v162, v32
    v_mfma_f32_16x16x32_bf16 v[40:43], v[72:75], a[128:131], v[16:19]
    ds_read_b128 v[56:59], v120 offset:8192
    v_cvt_pk_bf16_f32 v49, v164, v165
    v_mfma_f32_16x16x32_bf16 v[40:43], v[76:79], a[132:135], v[40:43]
    ds_read_b128 v[60:63], v121 offset:8192
    v_exp_f32 v163, v33
    v_mfma_f32_16x16x32_bf16 v[40:43], v[80:83], a[136:139], v[40:43]
    s_add_u32 m0, s26, 81920
    ds_read_b128 v[64:67], v122 offset:8192
    v_add_f32 v156, v156, v162
    v_add_f32 v156, v156, v163
    v_mfma_f32_16x16x32_bf16 v[40:43], v[84:87], a[140:143], v[40:43]
    s_waitcnt lgkmcnt(3)
    ds_read_b128 v[68:71], v123 offset:8192
    v_exp_f32 v164, v34
    v_mfma_f32_16x16x32_bf16 a[0:3], v[88:91], v[44:47], a[0:3]
    ds_read_b128 v[72:75], v120 offset:12288
    v_cvt_pk_bf16_f32 v50, v162, v163
    s_waitcnt vmcnt(3)
    buffer_load_dwordx4 v148, s[8:11], s51 offen offset:0 nt lds
    v_mfma_f32_16x16x32_bf16 a[4:7], v[92:95], v[44:47], a[4:7]
    ds_read_b128 v[76:79], v121 offset:12288
    v_exp_f32 v165, v35
    v_mfma_f32_16x16x32_bf16 a[8:11], v[96:99], v[44:47], a[8:11]
    ds_read_b128 v[80:83], v122 offset:12288
    v_add_f32 v156, v156, v164
    v_add_f32 v156, v156, v165
    v_mfma_f32_16x16x32_bf16 a[12:15], v[100:103], v[44:47], a[12:15]
    ds_read_b128 v[84:87], v123 offset:12288
    v_cvt_pk_bf16_f32 v51, v164, v165
    v_cmp_nge_f32 vcc, s28, v156
    v_mfma_f32_16x16x32_bf16 a[16:19], v[104:107], v[44:47], a[16:19]
    v_exp_f32 v158, v36
    v_mfma_f32_16x16x32_bf16 a[20:23], v[108:111], v[44:47], a[20:23]
    v_exp_f32 v159, v37
    v_mfma_f32_16x16x32_bf16 a[24:27], v[112:115], v[44:47], a[24:27]
    v_add_f32 v157, v154, v158
    v_add_f32 v157, v157, v159
    v_mfma_f32_16x16x32_bf16 a[28:31], v[116:119], v[44:47], a[28:31]
    s_waitcnt lgkmcnt(0)
    v_exp_f32 v160, v38
    v_mfma_f32_16x16x32_bf16 v[20:23], v[56:59], a[96:99], v[8:11]
    s_cbranch_vccnz L_rare_l4_1_1
L_back_l4_1_1:
    v_cvt_pk_bf16_f32 v52, v158, v159
    v_mfma_f32_16x16x32_bf16 v[20:23], v[60:63], a[100:103], v[20:23]
    v_exp_f32 v161, v39
    v_mfma_f32_16x16x32_bf16 v[20:23], v[64:67], a[104:107], v[20:23]
    v_add_f32 v157, v157, v160
    v_add_f32 v157, v157, v161
    v_mfma_f32_16x16x32_bf16 v[20:23], v[68:71], a[108:111], v[20:23]
    v_exp_f32 v158, v40
    v_mfma_f32_16x16x32_bf16 v[24:27], v[72:75], a[96:99], v[8:11]
    v_cvt_pk_bf16_f32 v53, v160, v161
    s_waitcnt vmcnt(3)
    buffer_load_dwordx4 v149, s[8:11], s51 offen offset:1024 nt lds
    v_mfma_f32_16x16x32_bf16 v[24:27], v[76:79], a[100:103], v[24:27]
    v_exp_f32 v159, v41
    v_mfma_f32_16x16x32_bf16 v[24:27], v[80:83], a[104:107], v[24:27]
    v_add_f32 v157, v157, v158
    v_add_f32 v157, v157, v159
    v_mfma_f32_16x16x32_bf16 v[24:27], v[84:87], a[108:111], v[24:27]
    v_exp_f32 v160, v42
    v_mfma_f32_16x16x32_bf16 a[32:35], v[88:91], v[48:51], a[32:35]
    v_cvt_pk_bf16_f32 v54, v158, v159
    v_mfma_f32_16x16x32_bf16 a[36:39], v[92:95], v[48:51], a[36:39]
    v_exp_f32 v161, v43
    v_mfma_f32_16x16x32_bf16 a[40:43], v[96:99], v[48:51], a[40:43]
    v_add_f32 v157, v157, v160
    v_add_f32 v157, v157, v161
    v_mfma_f32_16x16x32_bf16 a[44:47], v[100:103], v[48:51], a[44:47]
    v_cvt_pk_bf16_f32 v55, v160, v161
    v_cmp_nge_f32 vcc, s28, v157
    v_mfma_f32_16x16x32_bf16 a[48:51], v[104:107], v[48:51], a[48:51]
    v_exp_f32 v162, v20
    v_mfma_f32_16x16x32_bf16 a[52:55], v[108:111], v[48:51], a[52:55]
    v_exp_f32 v163, v21
    v_mfma_f32_16x16x32_bf16 a[56:59], v[112:115], v[48:51], a[56:59]
    v_add_f32 v152, v155, v162
    v_add_f32 v152, v152, v163
    v_mfma_f32_16x16x32_bf16 a[60:63], v[116:119], v[48:51], a[60:63]
    v_exp_f32 v164, v22
    v_mfma_f32_16x16x32_bf16 v[28:31], v[56:59], a[112:115], v[12:15]
    s_cbranch_vccnz L_rare_l4_1_2
L_back_l4_1_2:
    v_cvt_pk_bf16_f32 v44, v162, v163
    s_waitcnt vmcnt(3)
    buffer_load_dwordx4 v148, s[8:11], s51 offen offset:2048 nt lds
    v_mfma_f32_16x16x32_bf16 v[28:31], v[60:63], a[116:119], v[28:31]
    v_exp_f32 v165, v23
    v_mfma_f32_16x16x32_bf16 v[28:31], v[64:67], a[120:123], v[28:31]
    v_add_f32 v152, v152, v164
    v_add_f32 v152, v152, v165
    v_mfma_f32_16x16x32_bf16 v[28:31], v[68:71], a[124:127], v[28:31]
    v_exp_f32 v162, v24
    v_mfma_f32_16x16x32_bf16 v[32:35], v[72:75], a[112:115], v[12:15]
    v_cvt_pk_bf16_f32 v45, v164, v165
    v_mfma_f32_16x16x32_bf16 v[32:35], v[76:79], a[116:119], v[32:35]
    v_exp_f32 v163, v25
    v_mfma_f32_16x16x32_bf16 v[32:35], v[80:83], a[120:123], v[32:35]
    v_add_f32 v152, v152, v162
    v_add_f32 v152, v152, v163
    v_mfma_f32_16x16x32_bf16 v[32:35], v[84:87], a[124:127], v[32:35]
    v_exp_f32 v164, v26
    v_mfma_f32_16x16x32_bf16 a[64:67], v[88:91], v[52:55], a[64:67]
    ds_read_b64_tr_b16 v[88:89], v128 offset:8192
    v_cvt_pk_bf16_f32 v46, v162, v163
    v_mfma_f32_16x16x32_bf16 a[68:71], v[92:95], v[52:55], a[68:71]
    ds_read_b64_tr_b16 v[92:93], v129 offset:8192
    v_exp_f32 v165, v27
    v_mfma_f32_16x16x32_bf16 a[72:75], v[96:99], v[52:55], a[72:75]
    ds_read_b64_tr_b16 v[96:97], v130 offset:8192
    v_add_f32 v152, v152, v164
    v_add_f32 v152, v152, v165
    v_mfma_f32_16x16x32_bf16 a[76:79], v[100:103], v[52:55], a[76:79]
    ds_read_b64_tr_b16 v[100:101], v131 offset:8192
    v_cvt_pk_bf16_f32 v47, v164, v165
    v_cmp_nge_f32 vcc, s28, v152
    v_mfma_f32_16x16x32_bf16 a[80:83], v[104:107], v[52:55], a[80:83]
    ds_read_b64_tr_b16 v[104:105], v132 offset:8192
    v_exp_f32 v158, v28
    s_waitcnt vmcnt(3)
    buffer_load_dwordx4 v149, s[8:11], s51 offen offset:3072 nt lds
    v_mfma_f32_16x16x32_bf16 a[84:87], v[108:111], v[52:55], a[84:87]
    s_add_u32 s51, s51, 16384
    ds_read_b64_tr_b16 v[108:109], v133 offset:8192
    v_exp_f32 v159, v29
    v_mfma_f32_16x16x32_bf16 a[88:91], v[112:115], v[52:55], a[88:91]
    ds_read_b64_tr_b16 v[112:113], v134 offset:8192
    v_add_f32 v153, v156, v158
    v_add_f32 v153, v153, v159
    v_mfma_f32_16x16x32_bf16 a[92:95], v[116:119], v[52:55], a[92:95]
    ds_read_b64_tr_b16 v[116:117], v135 offset:8192
    v_exp_f32 v160, v30
    v_mfma_f32_16x16x32_bf16 v[36:39], v[56:59], a[128:131], v[16:19]
    s_cbranch_vccnz L_rare_l4_2_0
L_back_l4_2_0:
    ds_read_b64_tr_b16 v[94:95], v129 offset:12288
    ds_read_b64_tr_b16 v[90:91], v128 offset:12288
    v_cvt_pk_bf16_f32 v48, v158, v159
    v_mfma_f32_16x16x32_bf16 v[36:39], v[60:63], a[132:135], v[36:39]
    ds_read_b64_tr_b16 v[102:103], v131 offset:12288
    ds_read_b64_tr_b16 v[98:99], v130 offset:12288
    v_exp_f32 v161, v31
    v_mfma_f32_16x16x32_bf16 v[36:39], v[64:67], a[136:139], v[36:39]
    s_waitcnt vmcnt(8)
    ds_read_b64_tr_b16 v[110:111], v133 offset:12288
    ds_read_b64_tr_b16 v[106:107], v132 offset:12288
    v_add_f32 v153, v153, v160
    v_add_f32 v153, v153, v161
    v_mfma_f32_16x16x32_bf16 v[36:39], v[68:71], a[140:143], v[36:39]
    s_barrier
    ds_read_b64_tr_b16 v[118:119], v135 offset:12288
    ds_read_b64_tr_b16 v[114:115], v134 offset:12288
    v_exp_f32 v158, v32
    v_mfma_f32_16x16x32_bf16 v[40:43], v[72:75], a[128:131], v[16:19]
    ds_read_b128 v[56:59], v120 offset:32768
    v_cvt_pk_bf16_f32 v49, v160, v161
    v_mfma_f32_16x16x32_bf16 v[40:43], v[76:79], a[132:135], v[40:43]
    ds_read_b128 v[60:63], v121 offset:32768
    v_exp_f32 v159, v33
    v_mfma_f32_16x16x32_bf16 v[40:43], v[80:83], a[136:139], v[40:43]
    ds_read_b128 v[64:67], v122 offset:32768
    v_add_f32 v153, v153, v158
    v_add_f32 v153, v153, v159
    v_mfma_f32_16x16x32_bf16 v[40:43], v[84:87], a[140:143], v[40:43]
    s_waitcnt lgkmcnt(3)
    ds_read_b128 v[68:71], v123 offset:32768
    v_exp_f32 v160, v34
    v_mfma_f32_16x16x32_bf16 a[0:3], v[88:91], v[44:47], a[0:3]
    ds_read_b128 v[72:75], v120 offset:36864
    v_cvt_pk_bf16_f32 v50, v158, v159
    v_mfma_f32_16x16x32_bf16 a[4:7], v[92:95], v[44:47], a[4:7]
    s_add_u32 m0, s26, 0
    ds_read_b128 v[76:79], v121 offset:36864
    v_exp_f32 v161, v35
    v_mfma_f32_16x16x32_bf16 a[8:11], v[96:99], v[44:47], a[8:11]
    ds_read_b128 v[80:83], v122 offset:36864
    v_add_f32 v153, v153, v160
    v_add_f32 v153, v153, v161
    v_mfma_f32_16x16x32_bf16 a[12:15], v[100:103], v[44:47], a[12:15]
    ds_read_b128 v[84:87], v123 offset:36864
    v_cvt_pk_bf16_f32 v51, v160, v161
    v_cmp_nge_f32 vcc, s28, v153
    v_mfma_f32_16x16x32_bf16 a[16:19], v[104:107], v[44:47], a[16:19]
    v_exp_f32 v162, v36
    s_waitcnt vmcnt(3)
    buffer_load_dwordx4 v144, s[4:7], s25 offen offset:0 nt lds
    v_mfma_f32_16x16x32_bf16 a[20:23], v[108:111], v[44:47], a[20:23]
    v_exp_f32 v163, v37
    v_mfma_f32_16x16x32_bf16 a[24:27], v[112:115], v[44:47], a[24:27]
    v_add_f32 v154, v157, v162
    v_add_f32 v154, v154, v163
    v_mfma_f32_16x16x32_bf16 a[28:31], v[116:119], v[44:47], a[28:31]
    s_waitcnt lgkmcnt(0)
    v_exp_f32 v164, v38
    s_waitcnt vmcnt(3)
    buffer_load_dwordx4 v145, s[4:7], s25 offen offset:1024 nt lds
    s_sub_u32 s27, s27, 1
    s_cmp_lg_u32 s27, 0
    s_cbranch_scc1 L_loop
L_cnt:
    v_cmp_ne_u32 s[98:99], s44, v255
    s_nop 3
    s_cmp_eq_u64 s[98:99], 0
    s_cbranch_scc1 L_cnt_ok
    s_sleep 2
    buffer_load_dword v255, v254, s[20:23], 0 offen sc1
    s_waitcnt vmcnt(0)
    s_branch L_cnt
L_cnt_ok:
    v_mfma_f32_16x16x32_bf16 v[20:23], v[56:59], a[96:99], v[8:11]
    s_cbranch_vccnz L_rare_t29_0_1
L_back_t29_0_1:
    v_cvt_pk_bf16_f32 v52, v162, v163
    v_mfma_f32_16x16x32_bf16 v[20:23], v[60:63], a[100:103], v[20:23]
    v_exp_f32 v165, v39
    v_mfma_f32_16x16x32_bf16 v[20:23], v[64:67], a[104:107], v[20:23]
    s_add_u32 m0, s26, 114688
    v_add_f32 v154, v154, v164
    v_add_f32 v154, v154, v165
    v_mfma_f32_16x16x32_bf16 v[20:23], v[68:71], a[108:111], v[20:23]
    v_exp_f32 v162, v40
    v_mfma_f32_16x16x32_bf16 v[24:27], v[72:75], a[96:99], v[8:11]
    v_cvt_pk_bf16_f32 v53, v164, v165
    s_waitcnt vmcnt(3)
    buffer_load_dwordx4 v148, s[8:11], s51 offen offset:0 nt lds
    v_mfma_f32_16x16x32_bf16 v[24:27], v[76:79], a[100:103], v[24:27]
    v_exp_f32 v163, v41
    v_mfma_f32_16x16x32_bf16 v[24:27], v[80:83], a[104:107], v[24:27]
    v_add_f32 v154, v154, v162
    v_add_f32 v154, v154, v163
    v_mfma_f32_16x16x32_bf16 v[24:27], v[84:87], a[108:111], v[24:27]
    v_exp_f32 v164, v42
    v_mfma_f32_16x16x32_bf16 a[32:35], v[88:91], v[48:51], a[32:35]
    v_cvt_pk_bf16_f32 v54, v162, v163
    s_waitcnt vmcnt(3)
    buffer_load_dwordx4 v149, s[8:11], s51 offen offset:1024 nt lds
    v_mfma_f32_16x16x32_bf16 a[36:39], v[92:95], v[48:51], a[36:39]
    v_exp_f32 v165, v43
    v_mfma_f32_16x16x32_bf16 a[40:43], v[96:99], v[48:51], a[40:43]
    v_add_f32 v154, v154, v164
    v_add_f32 v154, v154, v165
    v_mfma_f32_16x16x32_bf16 a[44:47], v[100:103], v[48:51], a[44:47]
    v_cvt_pk_bf16_f32 v55, v164, v165
    v_cmp_nge_f32 vcc, s28, v154
    v_mfma_f32_16x16x32_bf16 a[48:51], v[104:107], v[48:51], a[48:51]
    v_exp_f32 v158, v20
    s_waitcnt vmcnt(3)
    buffer_load_dwordx4 v148, s[8:11], s51 offen offset:2048 nt lds
    v_mfma_f32_16x16x32_bf16 a[52:55], v[108:111], v[48:51], a[52:55]
    v_exp_f32 v159, v21
    v_mfma_f32_16x16x32_bf16 a[56:59], v[112:115], v[48:51], a[56:59]
    v_add_f32 v155, v152, v158
    v_add_f32 v155, v155, v159
    v_mfma_f32_16x16x32_bf16 a[60:63], v[116:119], v[48:51], a[60:63]
    v_exp_f32 v160, v22
    v_mfma_f32_16x16x32_bf16 v[28:31], v[56:59], a[112:115], v[12:15]
    s_cbranch_vccnz L_rare_t29_0_2
L_back_t29_0_2:
    v_cvt_pk_bf16_f32 v44, v158, v159
    v_mfma_f32_16x16x32_bf16 v[28:31], v[60:63], a[116:119], v[28:31]
    v_exp_f32 v161, v23
    v_mfma_f32_16x16x32_bf16 v[28:31], v[64:67], a[120:123], v[28:31]
    v_add_f32 v155, v155, v160
    v_add_f32 v155, v155, v161
    v_mfma_f32_16x16x32_bf16 v[28:31], v[68:71], a[124:127], v[28:31]
    v_exp_f32 v158, v24
    v_mfma_f32_16x16x32_bf16 v[32:35], v[72:75], a[112:115], v[12:15]
    v_cvt_pk_bf16_f32 v45, v160, v161
    s_waitcnt vmcnt(3)
    buffer_load_dwordx4 v149, s[8:11], s51 offen offset:3072 nt lds
    v_mfma_f32_16x16x32_bf16 v[32:35], v[76:79], a[116:119], v[32:35]
    v_exp_f32 v159, v25
    v_mfma_f32_16x16x32_bf16 v[32:35], v[80:83], a[120:123], v[32:35]
    v_add_f32 v155, v155, v158
    v_add_f32 v155, v155, v159
    v_mfma_f32_16x16x32_bf16 v[32:35], v[84:87], a[124:127], v[32:35]
    s_add_u32 s35, s91, 0
    s_and_b32 s35, s35, 15
    s_mul_i32 s35, s35, 5120
    v_exp_f32 v160, v26
    v_mfma_f32_16x16x32_bf16 a[64:67], v[88:91], v[52:55], a[64:67]
    ds_read_b64_tr_b16 v[88:89], v128 offset:32768
    v_cvt_pk_bf16_f32 v46, v158, v159
    buffer_load_dwordx4 a[144:147], v252, s[16:19], s35 offen offset:0 sc1
    v_mfma_f32_16x16x32_bf16 a[68:71], v[92:95], v[52:55], a[68:71]
    ds_read_b64_tr_b16 v[92:93], v129 offset:32768
    v_exp_f32 v161, v27
    v_mfma_f32_16x16x32_bf16 a[72:75], v[96:99], v[52:55], a[72:75]
    ds_read_b64_tr_b16 v[96:97], v130 offset:32768
    v_add_f32 v155, v155, v160
    v_add_f32 v155, v155, v161
    v_mfma_f32_16x16x32_bf16 a[76:79], v[100:103], v[52:55], a[76:79]
    ds_read_b64_tr_b16 v[100:101], v131 offset:32768
    v_cvt_pk_bf16_f32 v47, v160, v161
    v_cmp_nge_f32 vcc, s28, v155
    v_mfma_f32_16x16x32_bf16 a[80:83], v[104:107], v[52:55], a[80:83]
    ds_read_b64_tr_b16 v[104:105], v132 offset:32768
    v_exp_f32 v162, v28
    v_mfma_f32_16x16x32_bf16 a[84:87], v[108:111], v[52:55], a[84:87]
    ds_read_b64_tr_b16 v[108:109], v133 offset:32768
    v_exp_f32 v163, v29
    v_mfma_f32_16x16x32_bf16 a[88:91], v[112:115], v[52:55], a[88:91]
    ds_read_b64_tr_b16 v[112:113], v134 offset:32768
    v_add_f32 v156, v153, v162
    v_add_f32 v156, v156, v163
    v_mfma_f32_16x16x32_bf16 a[92:95], v[116:119], v[52:55], a[92:95]
    ds_read_b64_tr_b16 v[116:117], v135 offset:32768
    v_exp_f32 v164, v30
    v_mfma_f32_16x16x32_bf16 v[36:39], v[56:59], a[128:131], v[16:19]
    s_cbranch_vccnz L_rare_t29_1_0
L_back_t29_1_0:
    ds_read_b64_tr_b16 v[94:95], v129 offset:36864
    ds_read_b64_tr_b16 v[90:91], v128 offset:36864
    v_cvt_pk_bf16_f32 v48, v162, v163
    v_mfma_f32_16x16x32_bf16 v[36:39], v[60:63], a[132:135], v[36:39]
    ds_read_b64_tr_b16 v[102:103], v131 offset:36864
    ds_read_b64_tr_b16 v[98:99], v130 offset:36864
    v_exp_f32 v165, v31
    v_mfma_f32_16x16x32_bf16 v[36:39], v[64:67], a[136:139], v[36:39]
    ds_read_b64_tr_b16 v[110:111], v133 offset:36864
    ds_read_b64_tr_b16 v[106:107], v132 offset:36864
    v_add_f32 v156, v156, v164
    v_add_f32 v156, v156, v165
    v_mfma_f32_16x16x32_bf16 v[36:39], v[68:71], a[140:143], v[36:39]
    ds_read_b64_tr_b16 v[118:119], v135 offset:36864
    ds_read_b64_tr_b16 v[114:115], v134 offset:36864
    v_exp_f32 v162, v32
    v_mfma_f32_16x16x32_bf16 v[40:43], v[72:75], a[128:131], v[16:19]
    ds_read_b128 v[56:59], v120 offset:40960
    v_cvt_pk_bf16_f32 v49, v164, v165
    v_mfma_f32_16x16x32_bf16 v[40:43], v[76:79], a[132:135], v[40:43]
    ds_read_b128 v[60:63], v121 offset:40960
    v_exp_f32 v163, v33
    v_mfma_f32_16x16x32_bf16 v[40:43], v[80:83], a[136:139], v[40:43]
    ds_read_b128 v[64:67], v122 offset:40960
    v_add_f32 v156, v156, v162
    v_add_f32 v156, v156, v163
    buffer_load_dwordx4 a[148:151], v252, s[16:19], s35 offen offset:1024 sc1
    v_mfma_f32_16x16x32_bf16 v[40:43], v[84:87], a[140:143], v[40:43]
    s_waitcnt lgkmcnt(3)
    ds_read_b128 v[68:71], v123 offset:40960
    v_exp_f32 v164, v34
    v_mfma_f32_16x16x32_bf16 a[0:3], v[88:91], v[44:47], a[0:3]
    ds_read_b128 v[72:75], v120 offset:45056
    v_cvt_pk_bf16_f32 v50, v162, v163
    v_mfma_f32_16x16x32_bf16 a[4:7], v[92:95], v[44:47], a[4:7]
    ds_read_b128 v[76:79], v121 offset:45056
    v_exp_f32 v165, v35
    v_mfma_f32_16x16x32_bf16 a[8:11], v[96:99], v[44:47], a[8:11]
    ds_read_b128 v[80:83], v122 offset:45056
    v_add_f32 v156, v156, v164
    v_add_f32 v156, v156, v165
    v_mfma_f32_16x16x32_bf16 a[12:15], v[100:103], v[44:47], a[12:15]
    ds_read_b128 v[84:87], v123 offset:45056
    v_cvt_pk_bf16_f32 v51, v164, v165
    v_cmp_nge_f32 vcc, s28, v156
    v_mfma_f32_16x16x32_bf16 a[16:19], v[104:107], v[44:47], a[16:19]
    v_exp_f32 v158, v36
    v_mfma_f32_16x16x32_bf16 a[20:23], v[108:111], v[44:47], a[20:23]
    v_exp_f32 v159, v37
    v_mfma_f32_16x16x32_bf16 a[24:27], v[112:115], v[44:47], a[24:27]
    v_add_f32 v157, v154, v158
    v_add_f32 v157, v157, v159
    v_mfma_f32_16x16x32_bf16 a[28:31], v[116:119], v[44:47], a[28:31]
    s_waitcnt lgkmcnt(0)
    v_exp_f32 v160, v38
    v_mfma_f32_16x16x32_bf16 v[20:23], v[56:59], a[96:99], v[8:11]
    s_cbranch_vccnz L_rare_t29_1_1
L_back_t29_1_1:
    v_cvt_pk_bf16_f32 v52, v158, v159
    v_mfma_f32_16x16x32_bf16 v[20:23], v[60:63], a[100:103], v[20:23]
    v_exp_f32 v161, v39
    v_mfma_f32_16x16x32_bf16 v[20:23], v[64:67], a[104:107], v[20:23]
    v_add_f32 v157, v157, v160
    v_add_f32 v157, v157, v161
    v_mfma_f32_16x16x32_bf16 v[20:23], v[68:71], a[108:111], v[20:23]
    v_exp_f32 v158, v40
    v_mfma_f32_16x16x32_bf16 v[24:27], v[72:75], a[96:99], v[8:11]
    v_cvt_pk_bf16_f32 v53, v160, v161
    buffer_load_dwordx4 a[152:155], v252, s[16:19], s35 offen offset:2048 sc1
    v_mfma_f32_16x16x32_bf16 v[24:27], v[76:79], a[100:103], v[24:27]
    v_exp_f32 v159, v41
    v_mfma_f32_16x16x32_bf16 v[24:27], v[80:83], a[104:107], v[24:27]
    v_add_f32 v157, v157, v158
    v_add_f32 v157, v157, v159
    v_mfma_f32_16x16x32_bf16 v[24:27], v[84:87], a[108:111], v[24:27]
    v_exp_f32 v160, v42
    v_mfma_f32_16x16x32_bf16 a[32:35], v[88:91], v[48:51], a[32:35]
    v_cvt_pk_bf16_f32 v54, v158, v159
    v_mfma_f32_16x16x32_bf16 a[36:39], v[92:95], v[48:51], a[36:39]
    v_exp_f32 v161, v43
    v_mfma_f32_16x16x32_bf16 a[40:43], v[96:99], v[48:51], a[40:43]
    v_add_f32 v157, v157, v160
    v_add_f32 v157, v157, v161
    v_mfma_f32_16x16x32_bf16 a[44:47], v[100:103], v[48:51], a[44:47]
    v_cvt_pk_bf16_f32 v55, v160, v161
    v_cmp_nge_f32 vcc, s28, v157
    v_mfma_f32_16x16x32_bf16 a[48:51], v[104:107], v[48:51], a[48:51]
    v_exp_f32 v162, v20
    v_mfma_f32_16x16x32_bf16 a[52:55], v[108:111], v[48:51], a[52:55]
    v_exp_f32 v163, v21
    v_mfma_f32_16x16x32_bf16 a[56:59], v[112:115], v[48:51], a[56:59]
    v_add_f32 v152, v155, v162
    v_add_f32 v152, v152, v163
    v_mfma_f32_16x16x32_bf16 a[60:63], v[116:119], v[48:51], a[60:63]
    v_exp_f32 v164, v22
    v_mfma_f32_16x16x32_bf16 v[28:31], v[56:59], a[112:115], v[12:15]
    s_cbranch_vccnz L_rare_t29_1_2
L_back_t29_1_2:
    v_cvt_pk_bf16_f32 v44, v162, v163
    v_mfma_f32_16x16x32_bf16 v[28:31], v[60:63], a[116:119], v[28:31]
    v_exp_f32 v165, v23
    v_mfma_f32_16x16x32_bf16 v[28:31], v[64:67], a[120:123], v[28:31]
    v_add_f32 v152, v152, v164
    v_add_f32 v152, v152, v165
    buffer_load_dwordx4 a[156:159], v252, s[16:19], s35 offen offset:3072 sc1
    v_mfma_f32_16x16x32_bf16 v[28:31], v[68:71], a[124:127], v[28:31]
    v_exp_f32 v162, v24
    v_mfma_f32_16x16x32_bf16 v[32:35], v[72:75], a[112:115], v[12:15]
    v_cvt_pk_bf16_f32 v45, v164, v165
    v_mfma_f32_16x16x32_bf16 v[32:35], v[76:79], a[116:119], v[32:35]
    v_exp_f32 v163, v25
    v_mfma_f32_16x16x32_bf16 v[32:35], v[80:83], a[120:123], v[32:35]
    v_add_f32 v152, v152, v162
    v_add_f32 v152, v152, v163
    v_mfma_f32_16x16x32_bf16 v[32:35], v[84:87], a[124:127], v[32:35]
    v_exp_f32 v164, v26
    v_mfma_f32_16x16x32_bf16 a[64:67], v[88:91], v[52:55], a[64:67]
    ds_read_b64_tr_b16 v[88:89], v128 offset:40960
    v_cvt_pk_bf16_f32 v46, v162, v163
    v_mfma_f32_16x16x32_bf16 a[68:71], v[92:95], v[52:55], a[68:71]
    ds_read_b64_tr_b16 v[92:93], v129 offset:40960
    v_exp_f32 v165, v27
    v_mfma_f32_16x16x32_bf16 a[72:75], v[96:99], v[52:55], a[72:75]
    ds_read_b64_tr_b16 v[96:97], v130 offset:40960
    v_add_f32 v152, v152, v164
    v_add_f32 v152, v152, v165
    v_mfma_f32_16x16x32_bf16 a[76:79], v[100:103], v[52:55], a[76:79]
    ds_read_b64_tr_b16 v[100:101], v131 offset:40960
    v_cvt_pk_bf16_f32 v47, v164, v165
    v_cmp_nge_f32 vcc, s28, v152
    v_mfma_f32_16x16x32_bf16 a[80:83], v[104:107], v[52:55], a[80:83]
    ds_read_b64_tr_b16 v[104:105], v132 offset:40960
    v_exp_f32 v158, v28
    v_mfma_f32_16x16x32_bf16 a[84:87], v[108:111], v[52:55], a[84:87]
    s_add_u32 s51, s51, 16384
    ds_read_b64_tr_b16 v[108:109], v133 offset:40960
    v_exp_f32 v159, v29
    v_mfma_f32_16x16x32_bf16 a[88:91], v[112:115], v[52:55], a[88:91]
    ds_read_b64_tr_b16 v[112:113], v134 offset:40960
    v_add_f32 v153, v156, v158
    v_add_f32 v153, v153, v159
    v_mfma_f32_16x16x32_bf16 a[92:95], v[116:119], v[52:55], a[92:95]
    ds_read_b64_tr_b16 v[116:117], v135 offset:40960
    v_exp_f32 v160, v30
    v_mfma_f32_16x16x32_bf16 v[36:39], v[56:59], a[128:131], v[16:19]
    s_cbranch_vccnz L_rare_t29_2_0
L_back_t29_2_0:
    ds_read_b64_tr_b16 v[94:95], v129 offset:45056
    ds_read_b64_tr_b16 v[90:91], v128 offset:45056
    v_cvt_pk_bf16_f32 v48, v158, v159
    buffer_load_dwordx4 a[160:163], v253, s[16:19], s35 offen offset:0 sc1
    v_mfma_f32_16x16x32_bf16 v[36:39], v[60:63], a[132:135], v[36:39]
    ds_read_b64_tr_b16 v[102:103], v131 offset:45056
    ds_read_b64_tr_b16 v[98:99], v130 offset:45056
    v_exp_f32 v161, v31
    v_mfma_f32_16x16x32_bf16 v[36:39], v[64:67], a[136:139], v[36:39]
    s_waitcnt vmcnt(11)
    ds_read_b64_tr_b16 v[110:111], v133 offset:45056
    ds_read_b64_tr_b16 v[106:107], v132 offset:45056
    v_add_f32 v153, v153, v160
    v_add_f32 v153, v153, v161
    v_mfma_f32_16x16x32_bf16 v[36:39], v[68:71], a[140:143], v[36:39]
    s_barrier
    ds_read_b64_tr_b16 v[118:119], v135 offset:45056
    ds_read_b64_tr_b16 v[114:115], v134 offset:45056
    v_exp_f32 v158, v32
    v_mfma_f32_16x16x32_bf16 v[40:43], v[72:75], a[128:131], v[16:19]
    ds_read_b128 v[56:59], v124 offset:0
    v_cvt_pk_bf16_f32 v49, v160, v161
    v_mfma_f32_16x16x32_bf16 v[40:43], v[76:79], a[132:135], v[40:43]
    ds_read_b128 v[60:63], v125 offset:0
    v_exp_f32 v159, v33
    v_mfma_f32_16x16x32_bf16 v[40:43], v[80:83], a[136:139], v[40:43]
    ds_read_b128 v[64:67], v126 offset:0
    v_add_f32 v153, v153, v158
    v_add_f32 v153, v153, v159
    v_mfma_f32_16x16x32_bf16 v[40:43], v[84:87], a[140:143], v[40:43]
    s_waitcnt lgkmcnt(3)
    ds_read_b128 v[68:71], v127 offset:0
    v_exp_f32 v160, v34
    v_mfma_f32_16x16x32_bf16 a[0:3], v[88:91], v[44:47], a[0:3]
    ds_read_b128 v[72:75], v124 offset:4096
    v_cvt_pk_bf16_f32 v50, v158, v159
    v_mfma_f32_16x16x32_bf16 a[4:7], v[92:95], v[44:47], a[4:7]
    ds_read_b128 v[76:79], v125 offset:4096
    v_exp_f32 v161, v35
    v_mfma_f32_16x16x32_bf16 a[8:11], v[96:99], v[44:47], a[8:11]
    ds_read_b128 v[80:83], v126 offset:4096
    v_add_f32 v153, v153, v160
    v_add_f32 v153, v153, v161
    v_mfma_f32_16x16x32_bf16 a[12:15], v[100:103], v[44:47], a[12:15]
    ds_read_b128 v[84:87], v127 offset:4096
    v_cvt_pk_bf16_f32 v51, v160, v161
    v_cmp_nge_f32 vcc, s28, v153
    v_mfma_f32_16x16x32_bf16 a[16:19], v[104:107], v[44:47], a[16:19]
    v_exp_f32 v162, v36
    v_mfma_f32_16x16x32_bf16 a[20:23], v[108:111], v[44:47], a[20:23]
    v_exp_f32 v163, v37
    v_mfma_f32_16x16x32_bf16 a[24:27], v[112:115], v[44:47], a[24:27]
    v_add_f32 v154, v157, v162
    v_add_f32 v154, v154, v163
    v_mfma_f32_16x16x32_bf16 a[28:31], v[116:119], v[44:47], a[28:31]
    s_waitcnt lgkmcnt(0)
    v_exp_f32 v164, v38
    v_mfma_f32_16x16x32_bf16 v[20:23], v[56:59], a[96:99], v[8:11]
    s_cbranch_vccnz L_rare_t30_0_1
L_back_t30_0_1:
    v_cvt_pk_bf16_f32 v52, v162, v163
    v_mfma_f32_16x16x32_bf16 v[20:23], v[60:63], a[100:103], v[20:23]
    s_add_u32 s35, s91, 1
    s_and_b32 s35, s35, 15
    s_mul_i32 s35, s35, 5120
    v_exp_f32 v165, v39
    v_mfma_f32_16x16x32_bf16 v[20:23], v[64:67], a[104:107], v[20:23]
    v_add_f32 v154, v154, v164
    v_add_f32 v154, v154, v165
    buffer_load_dwordx4 a[164:167], v252, s[16:19], s35 offen offset:0 sc1
    v_mfma_f32_16x16x32_bf16 v[20:23], v[68:71], a[108:111], v[20:23]
    v_exp_f32 v162, v40
    v_mfma_f32_16x16x32_bf16 v[24:27], v[72:75], a[96:99], v[8:11]
    v_cvt_pk_bf16_f32 v53, v164, v165
    v_mfma_f32_16x16x32_bf16 v[24:27], v[76:79], a[100:103], v[24:27]
    v_exp_f32 v163, v41
    v_mfma_f32_16x16x32_bf16 v[24:27], v[80:83], a[104:107], v[24:27]
    v_add_f32 v154, v154, v162
    v_add_f32 v154, v154, v163
    v_mfma_f32_16x16x32_bf16 v[24:27], v[84:87], a[108:111], v[24:27]
    v_exp_f32 v164, v42
    v_mfma_f32_16x16x32_bf16 a[32:35], v[88:91], v[48:51], a[32:35]
    v_cvt_pk_bf16_f32 v54, v162, v163
    v_mfma_f32_16x16x32_bf16 a[36:39], v[92:95], v[48:51], a[36:39]
    v_exp_f32 v165, v43
    v_mfma_f32_16x16x32_bf16 a[40:43], v[96:99], v[48:51], a[40:43]
    v_add_f32 v154, v154, v164
    v_add_f32 v154, v154, v165
    v_mfma_f32_16x16x32_bf16 a[44:47], v[100:103], v[48:51], a[44:47]
    v_cvt_pk_bf16_f32 v55, v164, v165
    v_cmp_nge_f32 vcc, s28, v154
    v_mfma_f32_16x16x32_bf16 a[48:51], v[104:107], v[48:51], a[48:51]
    v_exp_f32 v158, v20
    v_mfma_f32_16x16x32_bf16 a[52:55], v[108:111], v[48:51], a[52:55]
    v_exp_f32 v159, v21
    v_mfma_f32_16x16x32_bf16 a[56:59], v[112:115], v[48:51], a[56:59]
    v_add_f32 v155, v152, v158
    v_add_f32 v155, v155, v159
    v_mfma_f32_16x16x32_bf16 a[60:63], v[116:119], v[48:51], a[60:63]
    v_exp_f32 v160, v22
    v_mfma_f32_16x16x32_bf16 v[28:31], v[56:59], a[112:115], v[12:15]
    s_cbranch_vccnz L_rare_t30_0_2
L_back_t30_0_2:
    v_cvt_pk_bf16_f32 v44, v158, v159
    v_mfma_f32_16x16x32_bf16 v[28:31], v[60:63], a[116:119], v[28:31]
    v_exp_f32 v161, v23
    v_mfma_f32_16x16x32_bf16 v[28:31], v[64:67], a[120:123], v[28:31]
    v_add_f32 v155, v155, v160
    v_add_f32 v155, v155, v161
    v_mfma_f32_16x16x32_bf16 v[28:31], v[68:71], a[124:127], v[28:31]
    v_exp_f32 v158, v24
    v_mfma_f32_16x16x32_bf16 v[32:35], v[72:75], a[112:115], v[12:15]
    v_cvt_pk_bf16_f32 v45, v160, v161
    buffer_load_dwordx4 a[168:171], v252, s[16:19], s35 offen offset:1024 sc1
    v_mfma_f32_16x16x32_bf16 v[32:35], v[76:79], a[116:119], v[32:35]
    v_exp_f32 v159, v25
    v_mfma_f32_16x16x32_bf16 v[32:35], v[80:83], a[120:123], v[32:35]
    v_add_f32 v155, v155, v158
    v_add_f32 v155, v155, v159
    v_mfma_f32_16x16x32_bf16 v[32:35], v[84:87], a[124:127], v[32:35]
    v_exp_f32 v160, v26
    v_mfma_f32_16x16x32_bf16 a[64:67], v[88:91], v[52:55], a[64:67]
    ds_read_b64_tr_b16 v[88:89], v136 offset:0
    v_cvt_pk_bf16_f32 v46, v158, v159
    v_mfma_f32_16x16x32_bf16 a[68:71], v[92:95], v[52:55], a[68:71]
    ds_read_b64_tr_b16 v[92:93], v137 offset:0
    v_exp_f32 v161, v27
    v_mfma_f32_16x16x32_bf16 a[72:75], v[96:99], v[52:55], a[72:75]
    ds_read_b64_tr_b16 v[96:97], v138 offset:0
    v_add_f32 v155, v155, v160
    v_add_f32 v155, v155, v161
    v_mfma_f32_16x16x32_bf16 a[76:79], v[100:103], v[52:55], a[76:79]
    ds_read_b64_tr_b16 v[100:101], v139 offset:0
    v_cvt_pk_bf16_f32 v47, v160, v161
    v_cmp_nge_f32 vcc, s28, v155
    v_mfma_f32_16x16x32_bf16 a[80:83], v[104:107], v[52:55], a[80:83]
    ds_read_b64_tr_b16 v[104:105], v140 offset:0
    v_exp_f32 v162, v28
    v_mfma_f32_16x16x32_bf16 a[84:87], v[108:111], v[52:55], a[84:87]
    ds_read_b64_tr_b16 v[108:109], v141 offset:0
    v_exp_f32 v163, v29
    v_mfma_f32_16x16x32_bf16 a[88:91], v[112:115], v[52:55], a[88:91]
    ds_read_b64_tr_b16 v[112:113], v142 offset:0
    v_add_f32 v156, v153, v162
    v_add_f32 v156, v156, v163
    v_mfma_f32_16x16x32_bf16 a[92:95], v[116:119], v[52:55], a[92:95]
    ds_read_b64_tr_b16 v[116:117], v143 offset:0
    v_exp_f32 v164, v30
    v_mfma_f32_16x16x32_bf16 v[36:39], v[56:59], a[128:131], v[16:19]
    s_cbranch_vccnz L_rare_t30_1_0
L_back_t30_1_0:
    ds_read_b64_tr_b16 v[94:95], v137 offset:4096
    ds_read_b64_tr_b16 v[90:91], v136 offset:4096
    v_cvt_pk_bf16_f32 v48, v162, v163
    v_mfma_f32_16x16x32_bf16 v[36:39], v[60:63], a[132:135], v[36:39]
    ds_read_b64_tr_b16 v[102:103], v139 offset:4096
    ds_read_b64_tr_b16 v[98:99], v138 offset:4096
    v_exp_f32 v165, v31
    v_mfma_f32_16x16x32_bf16 v[36:39], v[64:67], a[136:139], v[36:39]
    ds_read_b64_tr_b16 v[110:111], v141 offset:4096
    ds_read_b64_tr_b16 v[106:107], v140 offset:4096
    v_add_f32 v156, v156, v164
    v_add_f32 v156, v156, v165
    v_mfma_f32_16x16x32_bf16 v[36:39], v[68:71], a[140:143], v[36:39]
    ds_read_b64_tr_b16 v[118:119], v143 offset:4096
    ds_read_b64_tr_b16 v[114:115], v142 offset:4096
    v_exp_f32 v162, v32
    v_mfma_f32_16x16x32_bf16 v[40:43], v[72:75], a[128:131], v[16:19]
    ds_read_b128 v[56:59], v124 offset:8192
    v_cvt_pk_bf16_f32 v49, v164, v165
    v_mfma_f32_16x16x32_bf16 v[40:43], v[76:79], a[132:135], v[40:43]
    ds_read_b128 v[60:63], v125 offset:8192
    v_exp_f32 v163, v33
    v_mfma_f32_16x16x32_bf16 v[40:43], v[80:83], a[136:139], v[40:43]
    ds_read_b128 v[64:67], v126 offset:8192
    v_add_f32 v156, v156, v162
    v_add_f32 v156, v156, v163
    buffer_load_dwordx4 a[172:175], v252, s[16:19], s35 offen offset:2048 sc1
    v_mfma_f32_16x16x32_bf16 v[40:43], v[84:87], a[140:143], v[40:43]
    s_waitcnt lgkmcnt(3)
    ds_read_b128 v[68:71], v127 offset:8192
    v_exp_f32 v164, v34
    v_mfma_f32_16x16x32_bf16 a[0:3], v[88:91], v[44:47], a[0:3]
    ds_read_b128 v[72:75], v124 offset:12288
    v_cvt_pk_bf16_f32 v50, v162, v163
    v_mfma_f32_16x16x32_bf16 a[4:7], v[92:95], v[44:47], a[4:7]
    ds_read_b128 v[76:79], v125 offset:12288
    v_exp_f32 v165, v35
    v_mfma_f32_16x16x32_bf16 a[8:11], v[96:99], v[44:47], a[8:11]
    ds_read_b128 v[80:83], v126 offset:12288
    v_add_f32 v156, v156, v164
    v_add_f32 v156, v156, v165
    v_mfma_f32_16x16x32_bf16 a[12:15], v[100:103], v[44:47], a[12:15]
    ds_read_b128 v[84:87], v127 offset:12288
    v_cvt_pk_bf16_f32 v51, v164, v165
    v_cmp_nge_f32 vcc, s28, v156
    v_mfma_f32_16x16x32_bf16 a[16:19], v[104:107], v[44:47], a[16:19]
    v_exp_f32 v158, v36
    v_mfma_f32_16x16x32_bf16 a[20:23], v[108:111], v[44:47], a[20:23]
    v_exp_f32 v159, v37
    v_mfma_f32_16x16x32_bf16 a[24:27], v[112:115], v[44:47], a[24:27]
    v_add_f32 v157, v154, v158
    v_add_f32 v157, v157, v159
    v_mfma_f32_16x16x32_bf16 a[28:31], v[116:119], v[44:47], a[28:31]
    s_waitcnt lgkmcnt(0)
    v_exp_f32 v160, v38
    v_mfma_f32_16x16x32_bf16 v[20:23], v[56:59], a[96:99], v[8:11]
    s_cbranch_vccnz L_rare_t30_1_1
L_back_t30_1_1:
    v_cvt_pk_bf16_f32 v52, v158, v159
    v_mfma_f32_16x16x32_bf16 v[20:23], v[60:63], a[100:103], v[20:23]
    v_exp_f32 v161, v39
    v_mfma_f32_16x16x32_bf16 v[20:23], v[64:67], a[104:107], v[20:23]
    v_add_f32 v157, v157, v160
    v_add_f32 v157, v157, v161
    v_mfma_f32_16x16x32_bf16 v[20:23], v[68:71], a[108:111], v[20:23]
    v_exp_f32 v158, v40
    v_mfma_f32_16x16x32_bf16 v[24:27], v[72:75], a[96:99], v[8:11]
    v_cvt_pk_bf16_f32 v53, v160, v161
    v_mfma_f32_16x16x32_bf16 v[24:27], v[76:79], a[100:103], v[24:27]
    v_exp_f32 v159, v41
    v_mfma_f32_16x16x32_bf16 v[24:27], v[80:83], a[104:107], v[24:27]
    v_add_f32 v157, v157, v158
    v_add_f32 v157, v157, v159
    v_mfma_f32_16x16x32_bf16 v[24:27], v[84:87], a[108:111], v[24:27]
    v_exp_f32 v160, v42
    v_mfma_f32_16x16x32_bf16 a[32:35], v[88:91], v[48:51], a[32:35]
    v_cvt_pk_bf16_f32 v54, v158, v159
    v_mfma_f32_16x16x32_bf16 a[36:39], v[92:95], v[48:51], a[36:39]
    v_exp_f32 v161, v43
    buffer_load_dwordx4 a[176:179], v252, s[16:19], s35 offen offset:3072 sc1
    v_mfma_f32_16x16x32_bf16 a[40:43], v[96:99], v[48:51], a[40:43]
    v_add_f32 v157, v157, v160
    v_add_f32 v157, v157, v161
    v_mfma_f32_16x16x32_bf16 a[44:47], v[100:103], v[48:51], a[44:47]
    v_cvt_pk_bf16_f32 v55, v160, v161
    v_cmp_nge_f32 vcc, s28, v157
    v_mfma_f32_16x16x32_bf16 a[48:51], v[104:107], v[48:51], a[48:51]
    v_exp_f32 v162, v20
    v_mfma_f32_16x16x32_bf16 a[52:55], v[108:111], v[48:51], a[52:55]
    v_exp_f32 v163, v21
    v_mfma_f32_16x16x32_bf16 a[56:59], v[112:115], v[48:51], a[56:59]
    v_add_f32 v152, v155, v162
    v_add_f32 v152, v152, v163
    v_mfma_f32_16x16x32_bf16 a[60:63], v[116:119], v[48:51], a[60:63]
    v_exp_f32 v164, v22
    v_mfma_f32_16x16x32_bf16 v[28:31], v[56:59], a[112:115], v[12:15]
    s_cbranch_vccnz L_rare_t30_1_2
L_back_t30_1_2:
    v_cvt_pk_bf16_f32 v44, v162, v163
    v_mfma_f32_16x16x32_bf16 v[28:31], v[60:63], a[116:119], v[28:31]
    v_exp_f32 v165, v23
    v_mfma_f32_16x16x32_bf16 v[28:31], v[64:67], a[120:123], v[28:31]
    v_add_f32 v152, v152, v164
    v_add_f32 v152, v152, v165
    v_mfma_f32_16x16x32_bf16 v[28:31], v[68:71], a[124:127], v[28:31]
    v_exp_f32 v162, v24
    v_mfma_f32_16x16x32_bf16 v[32:35], v[72:75], a[112:115], v[12:15]
    v_cvt_pk_bf16_f32 v45, v164, v165
    v_mfma_f32_16x16x32_bf16 v[32:35], v[76:79], a[116:119], v[32:35]
    v_exp_f32 v163, v25
    v_mfma_f32_16x16x32_bf16 v[32:35], v[80:83], a[120:123], v[32:35]
    v_add_f32 v152, v152, v162
    v_add_f32 v152, v152, v163
    v_mfma_f32_16x16x32_bf16 v[32:35], v[84:87], a[124:127], v[32:35]
    v_exp_f32 v164, v26
    v_mfma_f32_16x16x32_bf16 a[64:67], v[88:91], v[52:55], a[64:67]
    ds_read_b64_tr_b16 v[88:89], v136 offset:8192
    v_cvt_pk_bf16_f32 v46, v162, v163
    v_mfma_f32_16x16x32_bf16 a[68:71], v[92:95], v[52:55], a[68:71]
    ds_read_b64_tr_b16 v[92:93], v137 offset:8192
    v_exp_f32 v165, v27
    v_mfma_f32_16x16x32_bf16 a[72:75], v[96:99], v[52:55], a[72:75]
    ds_read_b64_tr_b16 v[96:97], v138 offset:8192
    v_add_f32 v152, v152, v164
    v_add_f32 v152, v152, v165
    v_mfma_f32_16x16x32_bf16 a[76:79], v[100:103], v[52:55], a[76:79]
    ds_read_b64_tr_b16 v[100:101], v139 offset:8192
    v_cvt_pk_bf16_f32 v47, v164, v165
    v_cmp_nge_f32 vcc, s28, v152
    buffer_load_dwordx4 a[180:183], v253, s[16:19], s35 offen offset:0 sc1
    v_mfma_f32_16x16x32_bf16 a[80:83], v[104:107], v[52:55], a[80:83]
    ds_read_b64_tr_b16 v[104:105], v140 offset:8192
    v_exp_f32 v158, v28
    v_mfma_f32_16x16x32_bf16 a[84:87], v[108:111], v[52:55], a[84:87]
    ds_read_b64_tr_b16 v[108:109], v141 offset:8192
    v_exp_f32 v159, v29
    v_mfma_f32_16x16x32_bf16 a[88:91], v[112:115], v[52:55], a[88:91]
    ds_read_b64_tr_b16 v[112:113], v142 offset:8192
    v_add_f32 v153, v156, v158
    v_add_f32 v153, v153, v159
    v_mfma_f32_16x16x32_bf16 a[92:95], v[116:119], v[52:55], a[92:95]
    ds_read_b64_tr_b16 v[116:117], v143 offset:8192
    v_exp_f32 v160, v30
    v_mfma_f32_16x16x32_bf16 v[36:39], v[56:59], a[128:131], v[16:19]
    s_cbranch_vccnz L_rare_t30_2_0
L_back_t30_2_0:
    ds_read_b64_tr_b16 v[94:95], v137 offset:12288
    ds_read_b64_tr_b16 v[90:91], v136 offset:12288
    v_cvt_pk_bf16_f32 v48, v158, v159
    v_mfma_f32_16x16x32_bf16 v[36:39], v[60:63], a[132:135], v[36:39]
    ds_read_b64_tr_b16 v[102:103], v139 offset:12288
    ds_read_b64_tr_b16 v[98:99], v138 offset:12288
    v_exp_f32 v161, v31
    v_mfma_f32_16x16x32_bf16 v[36:39], v[64:67], a[136:139], v[36:39]
    s_waitcnt vmcnt(10)
    ds_read_b64_tr_b16 v[110:111], v141 offset:12288
    ds_read_b64_tr_b16 v[106:107], v140 offset:12288
    v_add_f32 v153, v153, v160
    v_add_f32 v153, v153, v161
    v_mfma_f32_16x16x32_bf16 v[36:39], v[68:71], a[140:143], v[36:39]
    s_barrier
    ds_read_b64_tr_b16 v[118:119], v143 offset:12288
    ds_read_b64_tr_b16 v[114:115], v142 offset:12288
    v_exp_f32 v158, v32
    v_mfma_f32_16x16x32_bf16 v[40:43], v[72:75], a[128:131], v[16:19]
    ds_read_b128 v[56:59], v124 offset:32768
    v_cvt_pk_bf16_f32 v49, v160, v161
    v_mfma_f32_16x16x32_bf16 v[40:43], v[76:79], a[132:135], v[40:43]
    ds_read_b128 v[60:63], v125 offset:32768
    v_exp_f32 v159, v33
    v_mfma_f32_16x16x32_bf16 v[40:43], v[80:83], a[136:139], v[40:43]
    ds_read_b128 v[64:67], v126 offset:32768
    v_add_f32 v153, v153, v158
    v_add_f32 v153, v153, v159
    v_mfma_f32_16x16x32_bf16 v[40:43], v[84:87], a[140:143], v[40:43]
    s_waitcnt lgkmcnt(3)
    ds_read_b128 v[68:71], v127 offset:32768
    v_exp_f32 v160, v34
    v_mfma_f32_16x16x32_bf16 a[0:3], v[88:91], v[44:47], a[0:3]
    ds_read_b128 v[72:75], v124 offset:36864
    v_cvt_pk_bf16_f32 v50, v158, v159
    v_mfma_f32_16x16x32_bf16 a[4:7], v[92:95], v[44:47], a[4:7]
    ds_read_b128 v[76:79], v125 offset:36864
    v_exp_f32 v161, v35
    v_mfma_f32_16x16x32_bf16 a[8:11], v[96:99], v[44:47], a[8:11]
    ds_read_b128 v[80:83], v126 offset:36864
    v_add_f32 v153, v153, v160
    v_add_f32 v153, v153, v161
    v_mfma_f32_16x16x32_bf16 a[12:15], v[100:103], v[44:47], a[12:15]
    ds_read_b128 v[84:87], v127 offset:36864
    v_cvt_pk_bf16_f32 v51, v160, v161
    v_cmp_nge_f32 vcc, s28, v153
    v_mfma_f32_16x16x32_bf16 a[16:19], v[104:107], v[44:47], a[16:19]
    v_exp_f32 v162, v36
    v_mfma_f32_16x16x32_bf16 a[20:23], v[108:111], v[44:47], a[20:23]
    v_exp_f32 v163, v37
    v_mfma_f32_16x16x32_bf16 a[24:27], v[112:115], v[44:47], a[24:27]
    v_add_f32 v154, v157, v162
    v_add_f32 v154, v154, v163
    v_mfma_f32_16x16x32_bf16 a[28:31], v[116:119], v[44:47], a[28:31]
    s_waitcnt lgkmcnt(0)
    v_exp_f32 v164, v38
    v_mfma_f32_16x16x32_bf16 v[20:23], v[56:59], a[96:99], v[8:11]
    s_cbranch_vccnz L_rare_t31_0_1
L_back_t31_0_1:
    v_cvt_pk_bf16_f32 v52, v162, v163
    v_mfma_f32_16x16x32_bf16 v[20:23], v[60:63], a[100:103], v[20:23]
    s_add_u32 s35, s91, 2
    s_and_b32 s35, s35, 15
    s_mul_i32 s35, s35, 5120
    v_exp_f32 v165, v39
    v_mfma_f32_16x16x32_bf16 v[20:23], v[64:67], a[104:107], v[20:23]
    v_add_f32 v154, v154, v164
    v_add_f32 v154, v154, v165
    buffer_load_dwordx4 a[184:187], v252, s[16:19], s35 offen offset:0 sc1
    v_mfma_f32_16x16x32_bf16 v[20:23], v[68:71], a[108:111], v[20:23]
    v_exp_f32 v162, v40
    v_mfma_f32_16x16x32_bf16 v[24:27], v[72:75], a[96:99], v[8:11]
    v_cvt_pk_bf16_f32 v53, v164, v165
    v_mfma_f32_16x16x32_bf16 v[24:27], v[76:79], a[100:103], v[24:27]
    v_exp_f32 v163, v41
    v_mfma_f32_16x16x32_bf16 v[24:27], v[80:83], a[104:107], v[24:27]
    v_add_f32 v154, v154, v162
    v_add_f32 v154, v154, v163
    v_mfma_f32_16x16x32_bf16 v[24:27], v[84:87], a[108:111], v[24:27]
    v_exp_f32 v164, v42
    v_mfma_f32_16x16x32_bf16 a[32:35], v[88:91], v[48:51], a[32:35]
    v_cvt_pk_bf16_f32 v54, v162, v163
    v_mfma_f32_16x16x32_bf16 a[36:39], v[92:95], v[48:51], a[36:39]
    v_exp_f32 v165, v43
    v_mfma_f32_16x16x32_bf16 a[40:43], v[96:99], v[48:51], a[40:43]
    v_add_f32 v154, v154, v164
    v_add_f32 v154, v154, v165
    v_mfma_f32_16x16x32_bf16 a[44:47], v[100:103], v[48:51], a[44:47]
    v_cvt_pk_bf16_f32 v55, v164, v165
    v_cmp_nge_f32 vcc, s28, v154
    v_mfma_f32_16x16x32_bf16 a[48:51], v[104:107], v[48:51], a[48:51]
    v_exp_f32 v158, v20
    v_mfma_f32_16x16x32_bf16 a[52:55], v[108:111], v[48:51], a[52:55]
    v_exp_f32 v159, v21
    v_mfma_f32_16x16x32_bf16 a[56:59], v[112:115], v[48:51], a[56:59]
    v_add_f32 v155, v152, v158
    v_add_f32 v155, v155, v159
    v_mfma_f32_16x16x32_bf16 a[60:63], v[116:119], v[48:51], a[60:63]
    v_exp_f32 v160, v22
    v_mfma_f32_16x16x32_bf16 v[28:31], v[56:59], a[112:115], v[12:15]
    s_cbranch_vccnz L_rare_t31_0_2
L_back_t31_0_2:
    v_cvt_pk_bf16_f32 v44, v158, v159
    v_mfma_f32_16x16x32_bf16 v[28:31], v[60:63], a[116:119], v[28:31]
    v_exp_f32 v161, v23
    v_mfma_f32_16x16x32_bf16 v[28:31], v[64:67], a[120:123], v[28:31]
    v_add_f32 v155, v155, v160
    v_add_f32 v155, v155, v161
    v_mfma_f32_16x16x32_bf16 v[28:31], v[68:71], a[124:127], v[28:31]
    v_exp_f32 v158, v24
    v_mfma_f32_16x16x32_bf16 v[32:35], v[72:75], a[112:115], v[12:15]
    v_cvt_pk_bf16_f32 v45, v160, v161
    buffer_load_dwordx4 a[188:191], v252, s[16:19], s35 offen offset:1024 sc1
    v_mfma_f32_16x16x32_bf16 v[32:35], v[76:79], a[116:119], v[32:35]
    v_exp_f32 v159, v25
    v_mfma_f32_16x16x32_bf16 v[32:35], v[80:83], a[120:123], v[32:35]
    v_add_f32 v155, v155, v158
    v_add_f32 v155, v155, v159
    v_mfma_f32_16x16x32_bf16 v[32:35], v[84:87], a[124:127], v[32:35]
    v_exp_f32 v160, v26
    v_mfma_f32_16x16x32_bf16 a[64:67], v[88:91], v[52:55], a[64:67]
    ds_read_b64_tr_b16 v[88:89], v136 offset:32768
    v_cvt_pk_bf16_f32 v46, v158, v159
    v_mfma_f32_16x16x32_bf16 a[68:71], v[92:95], v[52:55], a[68:71]
    ds_read_b64_tr_b16 v[92:93], v137 offset:32768
    v_exp_f32 v161, v27
    v_mfma_f32_16x16x32_bf16 a[72:75], v[96:99], v[52:55], a[72:75]
    ds_read_b64_tr_b16 v[96:97], v138 offset:32768
    v_add_f32 v155, v155, v160
    v_add_f32 v155, v155, v161
    v_mfma_f32_16x16x32_bf16 a[76:79], v[100:103], v[52:55], a[76:79]
    ds_read_b64_tr_b16 v[100:101], v139 offset:32768
    v_cvt_pk_bf16_f32 v47, v160, v161
    v_cmp_nge_f32 vcc, s28, v155
    v_mfma_f32_16x16x32_bf16 a[80:83], v[104:107], v[52:55], a[80:83]
    ds_read_b64_tr_b16 v[104:105], v140 offset:32768
    v_exp_f32 v162, v28
    v_mfma_f32_16x16x32_bf16 a[84:87], v[108:111], v[52:55], a[84:87]
    ds_read_b64_tr_b16 v[108:109], v141 offset:32768
    v_exp_f32 v163, v29
    v_mfma_f32_16x16x32_bf16 a[88:91], v[112:115], v[52:55], a[88:91]
    ds_read_b64_tr_b16 v[112:113], v142 offset:32768
    v_add_f32 v156, v153, v162
    v_add_f32 v156, v156, v163
    v_mfma_f32_16x16x32_bf16 a[92:95], v[116:119], v[52:55], a[92:95]
    ds_read_b64_tr_b16 v[116:117], v143 offset:32768
    v_exp_f32 v164, v30
    v_mfma_f32_16x16x32_bf16 v[36:39], v[56:59], a[128:131], v[16:19]
    s_cbranch_vccnz L_rare_t31_1_0
L_back_t31_1_0:
    ds_read_b64_tr_b16 v[94:95], v137 offset:36864
    ds_read_b64_tr_b16 v[90:91], v136 offset:36864
    v_cvt_pk_bf16_f32 v48, v162, v163
    v_mfma_f32_16x16x32_bf16 v[36:39], v[60:63], a[132:135], v[36:39]
    ds_read_b64_tr_b16 v[102:103], v139 offset:36864
    ds_read_b64_tr_b16 v[98:99], v138 offset:36864
    v_exp_f32 v165, v31
    v_mfma_f32_16x16x32_bf16 v[36:39], v[64:67], a[136:139], v[36:39]
    ds_read_b64_tr_b16 v[110:111], v141 offset:36864
    ds_read_b64_tr_b16 v[106:107], v140 offset:36864
    v_add_f32 v156, v156, v164
    v_add_f32 v156, v156, v165
    v_mfma_f32_16x16x32_bf16 v[36:39], v[68:71], a[140:143], v[36:39]
    ds_read_b64_tr_b16 v[118:119], v143 offset:36864
    ds_read_b64_tr_b16 v[114:115], v142 offset:36864
    v_exp_f32 v162, v32
    v_mfma_f32_16x16x32_bf16 v[40:43], v[72:75], a[128:131], v[16:19]
    ds_read_b128 v[56:59], v124 offset:40960
    v_cvt_pk_bf16_f32 v49, v164, v165
    v_mfma_f32_16x16x32_bf16 v[40:43], v[76:79], a[132:135], v[40:43]
    ds_read_b128 v[60:63], v125 offset:40960
    v_exp_f32 v163, v33
    v_mfma_f32_16x16x32_bf16 v[40:43], v[80:83], a[136:139], v[40:43]
    ds_read_b128 v[64:67], v126 offset:40960
    v_add_f32 v156, v156, v162
    v_add_f32 v156, v156, v163
    buffer_load_dwordx4 a[192:195], v252, s[16:19], s35 offen offset:2048 sc1
    v_mfma_f32_16x16x32_bf16 v[40:43], v[84:87], a[140:143], v[40:43]
    s_waitcnt lgkmcnt(3)
    ds_read_b128 v[68:71], v127 offset:40960
    v_exp_f32 v164, v34
    v_mfma_f32_16x16x32_bf16 a[0:3], v[88:91], v[44:47], a[0:3]
    ds_read_b128 v[72:75], v124 offset:45056
    v_cvt_pk_bf16_f32 v50, v162, v163
    v_mfma_f32_16x16x32_bf16 a[4:7], v[92:95], v[44:47], a[4:7]
    ds_read_b128 v[76:79], v125 offset:45056
    v_exp_f32 v165, v35
    v_mfma_f32_16x16x32_bf16 a[8:11], v[96:99], v[44:47], a[8:11]
    ds_read_b128 v[80:83], v126 offset:45056
    v_add_f32 v156, v156, v164
    v_add_f32 v156, v156, v165
    v_mfma_f32_16x16x32_bf16 a[12:15], v[100:103], v[44:47], a[12:15]
    ds_read_b128 v[84:87], v127 offset:45056
    v_cvt_pk_bf16_f32 v51, v164, v165
    v_cmp_nge_f32 vcc, s28, v156
    v_mfma_f32_16x16x32_bf16 a[16:19], v[104:107], v[44:47], a[16:19]
    v_exp_f32 v158, v36
    v_mfma_f32_16x16x32_bf16 a[20:23], v[108:111], v[44:47], a[20:23]
    v_exp_f32 v159, v37
    v_mfma_f32_16x16x32_bf16 a[24:27], v[112:115], v[44:47], a[24:27]
    v_add_f32 v157, v154, v158
    v_add_f32 v157, v157, v159
    v_mfma_f32_16x16x32_bf16 a[28:31], v[116:119], v[44:47], a[28:31]
    s_waitcnt lgkmcnt(0)
    v_exp_f32 v160, v38
    v_mfma_f32_16x16x32_bf16 v[20:23], v[56:59], a[96:99], v[8:11]
    s_cbranch_vccnz L_rare_t31_1_1
L_back_t31_1_1:
    v_cvt_pk_bf16_f32 v52, v158, v159
    v_mfma_f32_16x16x32_bf16 v[20:23], v[60:63], a[100:103], v[20:23]
    v_exp_f32 v161, v39
    v_mfma_f32_16x16x32_bf16 v[20:23], v[64:67], a[104:107], v[20:23]
    v_add_f32 v157, v157, v160
    v_add_f32 v157, v157, v161
    v_mfma_f32_16x16x32_bf16 v[20:23], v[68:71], a[108:111], v[20:23]
    v_exp_f32 v158, v40
    v_mfma_f32_16x16x32_bf16 v[24:27], v[72:75], a[96:99], v[8:11]
    v_cvt_pk_bf16_f32 v53, v160, v161
    v_mfma_f32_16x16x32_bf16 v[24:27], v[76:79], a[100:103], v[24:27]
    v_exp_f32 v159, v41
    v_mfma_f32_16x16x32_bf16 v[24:27], v[80:83], a[104:107], v[24:27]
    v_add_f32 v157, v157, v158
    v_add_f32 v157, v157, v159
    v_mfma_f32_16x16x32_bf16 v[24:27], v[84:87], a[108:111], v[24:27]
    v_exp_f32 v160, v42
    v_mfma_f32_16x16x32_bf16 a[32:35], v[88:91], v[48:51], a[32:35]
    v_cvt_pk_bf16_f32 v54, v158, v159
    v_mfma_f32_16x16x32_bf16 a[36:39], v[92:95], v[48:51], a[36:39]
    v_exp_f32 v161, v43
    buffer_load_dwordx4 a[196:199], v252, s[16:19], s35 offen offset:3072 sc1
    v_mfma_f32_16x16x32_bf16 a[40:43], v[96:99], v[48:51], a[40:43]
    v_add_f32 v157, v157, v160
    v_add_f32 v157, v157, v161
    v_mfma_f32_16x16x32_bf16 a[44:47], v[100:103], v[48:51], a[44:47]
    v_cvt_pk_bf16_f32 v55, v160, v161
    v_cmp_nge_f32 vcc, s28, v157
    v_mfma_f32_16x16x32_bf16 a[48:51], v[104:107], v[48:51], a[48:51]
    v_exp_f32 v162, v20
    v_mfma_f32_16x16x32_bf16 a[52:55], v[108:111], v[48:51], a[52:55]
    v_exp_f32 v163, v21
    v_mfma_f32_16x16x32_bf16 a[56:59], v[112:115], v[48:51], a[56:59]
    v_add_f32 v152, v155, v162
    v_add_f32 v152, v152, v163
    v_mfma_f32_16x16x32_bf16 a[60:63], v[116:119], v[48:51], a[60:63]
    v_exp_f32 v164, v22
    v_mfma_f32_16x16x32_bf16 v[28:31], v[56:59], a[112:115], v[12:15]
    s_cbranch_vccnz L_rare_t31_1_2
L_back_t31_1_2:
    v_cvt_pk_bf16_f32 v44, v162, v163
    v_mfma_f32_16x16x32_bf16 v[28:31], v[60:63], a[116:119], v[28:31]
    v_exp_f32 v165, v23
    v_mfma_f32_16x16x32_bf16 v[28:31], v[64:67], a[120:123], v[28:31]
    v_add_f32 v152, v152, v164
    v_add_f32 v152, v152, v165
    v_mfma_f32_16x16x32_bf16 v[28:31], v[68:71], a[124:127], v[28:31]
    v_exp_f32 v162, v24
    v_mfma_f32_16x16x32_bf16 v[32:35], v[72:75], a[112:115], v[12:15]
    v_cvt_pk_bf16_f32 v45, v164, v165
    v_mfma_f32_16x16x32_bf16 v[32:35], v[76:79], a[116:119], v[32:35]
    v_exp_f32 v163, v25
    v_mfma_f32_16x16x32_bf16 v[32:35], v[80:83], a[120:123], v[32:35]
    v_add_f32 v152, v152, v162
    v_add_f32 v152, v152, v163
    v_mfma_f32_16x16x32_bf16 v[32:35], v[84:87], a[124:127], v[32:35]
    v_exp_f32 v164, v26
    v_mfma_f32_16x16x32_bf16 a[64:67], v[88:91], v[52:55], a[64:67]
    ds_read_b64_tr_b16 v[88:89], v136 offset:40960
    v_cvt_pk_bf16_f32 v46, v162, v163
    v_mfma_f32_16x16x32_bf16 a[68:71], v[92:95], v[52:55], a[68:71]
    ds_read_b64_tr_b16 v[92:93], v137 offset:40960
    v_exp_f32 v165, v27
    v_mfma_f32_16x16x32_bf16 a[72:75], v[96:99], v[52:55], a[72:75]
    ds_read_b64_tr_b16 v[96:97], v138 offset:40960
    v_add_f32 v152, v152, v164
    v_add_f32 v152, v152, v165
    v_mfma_f32_16x16x32_bf16 a[76:79], v[100:103], v[52:55], a[76:79]
    ds_read_b64_tr_b16 v[100:101], v139 offset:40960
    v_cvt_pk_bf16_f32 v47, v164, v165
    v_cmp_nge_f32 vcc, s28, v152
    buffer_load_dwordx4 a[200:203], v253, s[16:19], s35 offen offset:0 sc1
    v_mfma_f32_16x16x32_bf16 a[80:83], v[104:107], v[52:55], a[80:83]
    ds_read_b64_tr_b16 v[104:105], v140 offset:40960
    v_exp_f32 v158, v28
    v_mfma_f32_16x16x32_bf16 a[84:87], v[108:111], v[52:55], a[84:87]
    ds_read_b64_tr_b16 v[108:109], v141 offset:40960
    v_exp_f32 v159, v29
    v_mfma_f32_16x16x32_bf16 a[88:91], v[112:115], v[52:55], a[88:91]
    ds_read_b64_tr_b16 v[112:113], v142 offset:40960
    v_add_f32 v153, v156, v158
    v_add_f32 v153, v153, v159
    v_mfma_f32_16x16x32_bf16 a[92:95], v[116:119], v[52:55], a[92:95]
    ds_read_b64_tr_b16 v[116:117], v143 offset:40960
    v_exp_f32 v160, v30
    v_mfma_f32_16x16x32_bf16 v[36:39], v[56:59], a[128:131], v[16:19]
    s_cbranch_vccnz L_rare_t31_2_0
L_back_t31_2_0:
    ds_read_b64_tr_b16 v[94:95], v137 offset:45056
    ds_read_b64_tr_b16 v[90:91], v136 offset:45056
    v_cvt_pk_bf16_f32 v48, v158, v159
    v_mfma_f32_16x16x32_bf16 v[36:39], v[60:63], a[132:135], v[36:39]
    ds_read_b64_tr_b16 v[102:103], v139 offset:45056
    ds_read_b64_tr_b16 v[98:99], v138 offset:45056
    v_exp_f32 v161, v31
    v_mfma_f32_16x16x32_bf16 v[36:39], v[64:67], a[136:139], v[36:39]
    ds_read_b64_tr_b16 v[110:111], v141 offset:45056
    ds_read_b64_tr_b16 v[106:107], v140 offset:45056
    v_add_f32 v153, v153, v160
    v_add_f32 v153, v153, v161
    v_mfma_f32_16x16x32_bf16 v[36:39], v[68:71], a[140:143], v[36:39]
    ds_read_b64_tr_b16 v[118:119], v143 offset:45056
    ds_read_b64_tr_b16 v[114:115], v142 offset:45056
    v_exp_f32 v158, v32
    v_mfma_f32_16x16x32_bf16 v[40:43], v[72:75], a[128:131], v[16:19]
    v_cvt_pk_bf16_f32 v49, v160, v161
    v_mfma_f32_16x16x32_bf16 v[40:43], v[76:79], a[132:135], v[40:43]
    v_exp_f32 v159, v33
    v_mfma_f32_16x16x32_bf16 v[40:43], v[80:83], a[136:139], v[40:43]
    v_add_f32 v153, v153, v158
    v_add_f32 v153, v153, v159
    v_mfma_f32_16x16x32_bf16 v[40:43], v[84:87], a[140:143], v[40:43]
    s_waitcnt lgkmcnt(0)
    v_exp_f32 v160, v34
    v_mfma_f32_16x16x32_bf16 a[0:3], v[88:91], v[44:47], a[0:3]
    v_cvt_pk_bf16_f32 v50, v158, v159
    v_mfma_f32_16x16x32_bf16 a[4:7], v[92:95], v[44:47], a[4:7]
    v_exp_f32 v161, v35
    v_mfma_f32_16x16x32_bf16 a[8:11], v[96:99], v[44:47], a[8:11]
    v_add_f32 v153, v153, v160
    v_add_f32 v153, v153, v161
    v_mfma_f32_16x16x32_bf16 a[12:15], v[100:103], v[44:47], a[12:15]
    v_cvt_pk_bf16_f32 v51, v160, v161
    v_cmp_nge_f32 vcc, s28, v153
    v_mfma_f32_16x16x32_bf16 a[16:19], v[104:107], v[44:47], a[16:19]
    v_exp_f32 v162, v36
    v_mfma_f32_16x16x32_bf16 a[20:23], v[108:111], v[44:47], a[20:23]
    v_exp_f32 v163, v37
    v_mfma_f32_16x16x32_bf16 a[24:27], v[112:115], v[44:47], a[24:27]
    v_add_f32 v154, v157, v162
    v_add_f32 v154, v154, v163
    v_mfma_f32_16x16x32_bf16 a[28:31], v[116:119], v[44:47], a[28:31]
    s_waitcnt lgkmcnt(0)
    v_exp_f32 v164, v38
    s_cbranch_vccnz L_rare_d_1
L_back_d_1:
    v_mfma_f32_16x16x32_bf16 a[32:35], v[88:91], v[48:51], a[32:35]
    v_cvt_pk_bf16_f32 v52, v162, v163
    v_exp_f32 v165, v39
    v_mfma_f32_16x16x32_bf16 a[36:39], v[92:95], v[48:51], a[36:39]
    v_add_f32 v154, v154, v164
    v_add_f32 v154, v154, v165
    v_mfma_f32_16x16x32_bf16 a[40:43], v[96:99], v[48:51], a[40:43]
    v_exp_f32 v162, v40
    v_cvt_pk_bf16_f32 v53, v164, v165
    v_mfma_f32_16x16x32_bf16 a[44:47], v[100:103], v[48:51], a[44:47]
    v_exp_f32 v163, v41
    v_add_f32 v154, v154, v162
    v_mfma_f32_16x16x32_bf16 a[48:51], v[104:107], v[48:51], a[48:51]
    v_add_f32 v154, v154, v163
    v_exp_f32 v164, v42
    v_mfma_f32_16x16x32_bf16 a[52:55], v[108:111], v[48:51], a[52:55]
    v_cvt_pk_bf16_f32 v54, v162, v163
    v_exp_f32 v165, v43
    v_mfma_f32_16x16x32_bf16 a[56:59], v[112:115], v[48:51], a[56:59]
    v_add_f32 v154, v154, v164
    v_add_f32 v154, v154, v165
    v_mfma_f32_16x16x32_bf16 a[60:63], v[116:119], v[48:51], a[60:63]
    v_cvt_pk_bf16_f32 v55, v164, v165
    v_cmp_nge_f32 vcc, s28, v154
    s_nop 7
    s_cbranch_vccnz L_rare_d_2
L_back_d_2:
    v_mfma_f32_16x16x32_bf16 a[64:67], v[88:91], v[52:55], a[64:67]
    v_mfma_f32_16x16x32_bf16 a[68:71], v[92:95], v[52:55], a[68:71]
    v_mfma_f32_16x16x32_bf16 a[72:75], v[96:99], v[52:55], a[72:75]
    v_mfma_f32_16x16x32_bf16 a[76:79], v[100:103], v[52:55], a[76:79]
    v_mfma_f32_16x16x32_bf16 a[80:83], v[104:107], v[52:55], a[80:83]
    v_mfma_f32_16x16x32_bf16 a[84:87], v[108:111], v[52:55], a[84:87]
    v_mfma_f32_16x16x32_bf16 a[88:91], v[112:115], v[52:55], a[88:91]
    v_mfma_f32_16x16x32_bf16 a[92:95], v[116:119], v[52:55], a[92:95]
    s_barrier
    v_mov_b32 v166, v152
    v_mov_b32 v167, v153
    v_mov_b32 v168, v154
    s_nop 1
    v_permlane32_swap_b32 v152, v166
    v_permlane32_swap_b32 v153, v167
    v_permlane32_swap_b32 v154, v168
    v_add_f32 v152, v152, v166
    v_mov_b32 v166, v152
    v_add_f32 v153, v153, v167
    v_mov_b32 v167, v153
    v_add_f32 v154, v154, v168
    v_mov_b32 v168, v154
    s_nop 1
    v_permlane16_swap_b32 v152, v166
    v_permlane16_swap_b32 v153, v167
    v_permlane16_swap_b32 v154, v168
    v_add_f32 v152, v152, v166
    v_add_f32 v153, v153, v167
    v_add_f32 v154, v154, v168
    v_rcp_f32 v152, v152
    v_rcp_f32 v153, v153
    v_rcp_f32 v154, v154
    s_mul_i32 s48, s30, 12
    s_mul_i32 s49, s24, 3
    s_add_u32 s48, s48, s49
    s_lshl_b32 s48, s48, 7
    s_lshl_b32 s49, s31, 2
    s_add_u32 s48, s48, s49
    s_lshl_b32 s48, s48, 10
    v_add_u32 v4, s48, v252
    v_accvgpr_read_b32 v8, a0
    v_accvgpr_read_b32 v9, a1
    v_accvgpr_read_b32 v10, a2
    v_accvgpr_read_b32 v11, a3
    v_accvgpr_read_b32 v12, a4
    v_accvgpr_read_b32 v13, a5
    v_accvgpr_read_b32 v14, a6
    v_accvgpr_read_b32 v15, a7
    v_mul_f32 v8, v8, v152
    v_mul_f32 v9, v9, v152
    v_mul_f32 v10, v10, v152
    v_mul_f32 v11, v11, v152
    v_mul_f32 v12, v12, v152
    v_mul_f32 v13, v13, v152
    v_mul_f32 v14, v14, v152
    v_mul_f32 v15, v15, v152
    v_cvt_pk_bf16_f32 v8, v8, v9
    v_cvt_pk_bf16_f32 v9, v10, v11
    v_cvt_pk_bf16_f32 v10, v12, v13
    v_cvt_pk_bf16_f32 v11, v14, v15
    buffer_store_dwordx4 v[8:11], v4, s[20:23], 0 offen offset:0 sc1
    v_accvgpr_read_b32 v16, a8
    v_accvgpr_read_b32 v17, a9
    v_accvgpr_read_b32 v18, a10
    v_accvgpr_read_b32 v19, a11
    v_accvgpr_read_b32 v20, a12
    v_accvgpr_read_b32 v21, a13
    v_accvgpr_read_b32 v22, a14
    v_accvgpr_read_b32 v23, a15
    v_mul_f32 v16, v16, v152
    v_mul_f32 v17, v17, v152
    v_mul_f32 v18, v18, v152
    v_mul_f32 v19, v19, v152
    v_mul_f32 v20, v20, v152
    v_mul_f32 v21, v21, v152
    v_mul_f32 v22, v22, v152
    v_mul_f32 v23, v23, v152
    v_cvt_pk_bf16_f32 v16, v16, v17
    v_cvt_pk_bf16_f32 v17, v18, v19
    v_cvt_pk_bf16_f32 v18, v20, v21
    v_cvt_pk_bf16_f32 v19, v22, v23
    buffer_store_dwordx4 v[16:19], v4, s[20:23], 0 offen offset:1024 sc1
    v_accvgpr_read_b32 v24, a16
    v_accvgpr_read_b32 v25, a17
    v_accvgpr_read_b32 v26, a18
    v_accvgpr_read_b32 v27, a19
    v_accvgpr_read_b32 v28, a20
    v_accvgpr_read_b32 v29, a21
    v_accvgpr_read_b32 v30, a22
    v_accvgpr_read_b32 v31, a23
    v_mul_f32 v24, v24, v152
    v_mul_f32 v25, v25, v152
    v_mul_f32 v26, v26, v152
    v_mul_f32 v27, v27, v152
    v_mul_f32 v28, v28, v152
    v_mul_f32 v29, v29, v152
    v_mul_f32 v30, v30, v152
    v_mul_f32 v31, v31, v152
    v_cvt_pk_bf16_f32 v24, v24, v25
    v_cvt_pk_bf16_f32 v25, v26, v27
    v_cvt_pk_bf16_f32 v26, v28, v29
    v_cvt_pk_bf16_f32 v27, v30, v31
    buffer_store_dwordx4 v[24:27], v4, s[20:23], 0 offen offset:2048 sc1
    v_accvgpr_read_b32 v32, a24
    v_accvgpr_read_b32 v33, a25
    v_accvgpr_read_b32 v34, a26
    v_accvgpr_read_b32 v35, a27
    v_accvgpr_read_b32 v36, a28
    v_accvgpr_read_b32 v37, a29
    v_accvgpr_read_b32 v38, a30
    v_accvgpr_read_b32 v39, a31
    v_mul_f32 v32, v32, v152
    v_mul_f32 v33, v33, v152
    v_mul_f32 v34, v34, v152
    v_mul_f32 v35, v35, v152
    v_mul_f32 v36, v36, v152
    v_mul_f32 v37, v37, v152
    v_mul_f32 v38, v38, v152
    v_mul_f32 v39, v39, v152
    v_cvt_pk_bf16_f32 v32, v32, v33
    v_cvt_pk_bf16_f32 v33, v34, v35
    v_cvt_pk_bf16_f32 v34, v36, v37
    v_cvt_pk_bf16_f32 v35, v38, v39
    buffer_store_dwordx4 v[32:35], v4, s[20:23], 0 offen offset:3072 sc1
    v_add_u32 v4, 131072, v4
    v_accvgpr_read_b32 v40, a32
    v_accvgpr_read_b32 v41, a33
    v_accvgpr_read_b32 v42, a34
    v_accvgpr_read_b32 v43, a35
    v_accvgpr_read_b32 v44, a36
    v_accvgpr_read_b32 v45, a37
    v_accvgpr_read_b32 v46, a38
    v_accvgpr_read_b32 v47, a39
    v_mul_f32 v40, v40, v153
    v_mul_f32 v41, v41, v153
    v_mul_f32 v42, v42, v153
    v_mul_f32 v43, v43, v153
    v_mul_f32 v44, v44, v153
    v_mul_f32 v45, v45, v153
    v_mul_f32 v46, v46, v153
    v_mul_f32 v47, v47, v153
    v_cvt_pk_bf16_f32 v40, v40, v41
    v_cvt_pk_bf16_f32 v41, v42, v43
    v_cvt_pk_bf16_f32 v42, v44, v45
    v_cvt_pk_bf16_f32 v43, v46, v47
    buffer_store_dwordx4 v[40:43], v4, s[20:23], 0 offen offset:0 sc1
    v_accvgpr_read_b32 v48, a40
    v_accvgpr_read_b32 v49, a41
    v_accvgpr_read_b32 v50, a42
    v_accvgpr_read_b32 v51, a43
    v_accvgpr_read_b32 v52, a44
    v_accvgpr_read_b32 v53, a45
    v_accvgpr_read_b32 v54, a46
    v_accvgpr_read_b32 v55, a47
    v_mul_f32 v48, v48, v153
    v_mul_f32 v49, v49, v153
    v_mul_f32 v50, v50, v153
    v_mul_f32 v51, v51, v153
    v_mul_f32 v52, v52, v153
    v_mul_f32 v53, v53, v153
    v_mul_f32 v54, v54, v153
    v_mul_f32 v55, v55, v153
    v_cvt_pk_bf16_f32 v48, v48, v49
    v_cvt_pk_bf16_f32 v49, v50, v51
    v_cvt_pk_bf16_f32 v50, v52, v53
    v_cvt_pk_bf16_f32 v51, v54, v55
    buffer_store_dwordx4 v[48:51], v4, s[20:23], 0 offen offset:1024 sc1
    v_accvgpr_read_b32 v56, a48
    v_accvgpr_read_b32 v57, a49
    v_accvgpr_read_b32 v58, a50
    v_accvgpr_read_b32 v59, a51
    v_accvgpr_read_b32 v60, a52
    v_accvgpr_read_b32 v61, a53
    v_accvgpr_read_b32 v62, a54
    v_accvgpr_read_b32 v63, a55
    v_mul_f32 v56, v56, v153
    v_mul_f32 v57, v57, v153
    v_mul_f32 v58, v58, v153
    v_mul_f32 v59, v59, v153
    v_mul_f32 v60, v60, v153
    v_mul_f32 v61, v61, v153
    v_mul_f32 v62, v62, v153
    v_mul_f32 v63, v63, v153
    v_cvt_pk_bf16_f32 v56, v56, v57
    v_cvt_pk_bf16_f32 v57, v58, v59
    v_cvt_pk_bf16_f32 v58, v60, v61
    v_cvt_pk_bf16_f32 v59, v62, v63
    buffer_store_dwordx4 v[56:59], v4, s[20:23], 0 offen offset:2048 sc1
    v_accvgpr_read_b32 v64, a56
    v_accvgpr_read_b32 v65, a57
    v_accvgpr_read_b32 v66, a58
    v_accvgpr_read_b32 v67, a59
    v_accvgpr_read_b32 v68, a60
    v_accvgpr_read_b32 v69, a61
    v_accvgpr_read_b32 v70, a62
    v_accvgpr_read_b32 v71, a63
    v_mul_f32 v64, v64, v153
    v_mul_f32 v65, v65, v153
    v_mul_f32 v66, v66, v153
    v_mul_f32 v67, v67, v153
    v_mul_f32 v68, v68, v153
    v_mul_f32 v69, v69, v153
    v_mul_f32 v70, v70, v153
    v_mul_f32 v71, v71, v153
    v_cvt_pk_bf16_f32 v64, v64, v65
    v_cvt_pk_bf16_f32 v65, v66, v67
    v_cvt_pk_bf16_f32 v66, v68, v69
    v_cvt_pk_bf16_f32 v67, v70, v71
    buffer_store_dwordx4 v[64:67], v4, s[20:23], 0 offen offset:3072 sc1
    v_add_u32 v4, 131072, v4
    v_accvgpr_read_b32 v72, a64
    v_accvgpr_read_b32 v73, a65
    v_accvgpr_read_b32 v74, a66
    v_accvgpr_read_b32 v75, a67
    v_accvgpr_read_b32 v76, a68
    v_accvgpr_read_b32 v77, a69
    v_accvgpr_read_b32 v78, a70
    v_accvgpr_read_b32 v79, a71
    v_mul_f32 v72, v72, v154
    v_mul_f32 v73, v73, v154
    v_mul_f32 v74, v74, v154
    v_mul_f32 v75, v75, v154
    v_mul_f32 v76, v76, v154
    v_mul_f32 v77, v77, v154
    v_mul_f32 v78, v78, v154
    v_mul_f32 v79, v79, v154
    v_cvt_pk_bf16_f32 v72, v72, v73
    v_cvt_pk_bf16_f32 v73, v74, v75
    v_cvt_pk_bf16_f32 v74, v76, v77
    v_cvt_pk_bf16_f32 v75, v78, v79
    buffer_store_dwordx4 v[72:75], v4, s[20:23], 0 offen offset:0 sc1
    v_accvgpr_read_b32 v80, a72
    v_accvgpr_read_b32 v81, a73
    v_accvgpr_read_b32 v82, a74
    v_accvgpr_read_b32 v83, a75
    v_accvgpr_read_b32 v84, a76
    v_accvgpr_read_b32 v85, a77
    v_accvgpr_read_b32 v86, a78
    v_accvgpr_read_b32 v87, a79
    v_mul_f32 v80, v80, v154
    v_mul_f32 v81, v81, v154
    v_mul_f32 v82, v82, v154
    v_mul_f32 v83, v83, v154
    v_mul_f32 v84, v84, v154
    v_mul_f32 v85, v85, v154
    v_mul_f32 v86, v86, v154
    v_mul_f32 v87, v87, v154
    v_cvt_pk_bf16_f32 v80, v80, v81
    v_cvt_pk_bf16_f32 v81, v82, v83
    v_cvt_pk_bf16_f32 v82, v84, v85
    v_cvt_pk_bf16_f32 v83, v86, v87
    buffer_store_dwordx4 v[80:83], v4, s[20:23], 0 offen offset:1024 sc1
    v_accvgpr_read_b32 v88, a80
    v_accvgpr_read_b32 v89, a81
    v_accvgpr_read_b32 v90, a82
    v_accvgpr_read_b32 v91, a83
    v_accvgpr_read_b32 v92, a84
    v_accvgpr_read_b32 v93, a85
    v_accvgpr_read_b32 v94, a86
    v_accvgpr_read_b32 v95, a87
    v_mul_f32 v88, v88, v154
    v_mul_f32 v89, v89, v154
    v_mul_f32 v90, v90, v154
    v_mul_f32 v91, v91, v154
    v_mul_f32 v92, v92, v154
    v_mul_f32 v93, v93, v154
    v_mul_f32 v94, v94, v154
    v_mul_f32 v95, v95, v154
    v_cvt_pk_bf16_f32 v88, v88, v89
    v_cvt_pk_bf16_f32 v89, v90, v91
    v_cvt_pk_bf16_f32 v90, v92, v93
    v_cvt_pk_bf16_f32 v91, v94, v95
    buffer_store_dwordx4 v[88:91], v4, s[20:23], 0 offen offset:2048 sc1
    v_accvgpr_read_b32 v96, a88
    v_accvgpr_read_b32 v97, a89
    v_accvgpr_read_b32 v98, a90
    v_accvgpr_read_b32 v99, a91
    v_accvgpr_read_b32 v100, a92
    v_accvgpr_read_b32 v101, a93
    v_accvgpr_read_b32 v102, a94
    v_accvgpr_read_b32 v103, a95
    v_mul_f32 v96, v96, v154
    v_mul_f32 v97, v97, v154
    v_mul_f32 v98, v98, v154
    v_mul_f32 v99, v99, v154
    v_mul_f32 v100, v100, v154
    v_mul_f32 v101, v101, v154
    v_mul_f32 v102, v102, v154
    v_mul_f32 v103, v103, v154
    v_cvt_pk_bf16_f32 v96, v96, v97
    v_cvt_pk_bf16_f32 v97, v98, v99
    v_cvt_pk_bf16_f32 v98, v100, v101
    v_cvt_pk_bf16_f32 v99, v102, v103
    buffer_store_dwordx4 v[96:99], v4, s[20:23], 0 offen offset:3072 sc1
    s_add_u32 s35, s91, 3
    s_and_b32 s35, s35, 15
    s_mul_i32 s35, s35, 5120
    buffer_load_dwordx4 a[204:207], v252, s[16:19], s35 offen offset:0 sc1
    buffer_load_dwordx4 a[208:211], v252, s[16:19], s35 offen offset:1024 sc1
    buffer_load_dwordx4 a[212:215], v252, s[16:19], s35 offen offset:2048 sc1
    buffer_load_dwordx4 a[216:219], v252, s[16:19], s35 offen offset:3072 sc1
    buffer_load_dwordx4 a[220:223], v253, s[16:19], s35 offen offset:0 sc1
    s_add_u32 s35, s91, 4
    s_and_b32 s35, s35, 15
    s_mul_i32 s35, s35, 5120
    buffer_load_dwordx4 a[224:227], v252, s[16:19], s35 offen offset:0 sc1
    buffer_load_dwordx4 a[228:231], v252, s[16:19], s35 offen offset:1024 sc1
    buffer_load_dwordx4 a[232:235], v252, s[16:19], s35 offen offset:2048 sc1
    buffer_load_dwordx4 a[236:239], v252, s[16:19], s35 offen offset:3072 sc1
    buffer_load_dwordx4 a[240:243], v253, s[16:19], s35 offen offset:0 sc1
    s_add_u32 s35, s91, 5
    s_and_b32 s35, s35, 15
    s_mul_i32 s35, s35, 5120
    buffer_load_dwordx4 v[172:175], v252, s[16:19], s35 offen offset:0 sc1
    buffer_load_dwordx4 v[176:179], v252, s[16:19], s35 offen offset:1024 sc1
    buffer_load_dwordx4 v[180:183], v252, s[16:19], s35 offen offset:2048 sc1
    buffer_load_dwordx4 v[184:187], v252, s[16:19], s35 offen offset:3072 sc1
    buffer_load_dwordx4 v[188:191], v253, s[16:19], s35 offen offset:0 sc1
    s_lshl_b32 s48, s38, 10
    v_add_u32 v4, s48, v252
    s_mul_i32 s48, s37, 393216
    s_sub_u32 s49, 393216, s48
    v_add_u32 v5, s48, v4
    v_add_u32 v4, s49, v4
    v_add_u32 v144, 0, v5
    v_add_u32 v145, 131072, v5
    v_add_u32 v146, 262144, v5
    v_add_u32 v147, 0, v4
    v_add_u32 v148, 131072, v4
    v_add_u32 v149, 262144, v4
    s_mul_i32 s45, s24, 30720
    v_add_u32 v151, s45, v252
    s_mul_i32 s48, s32, 12
    s_mul_i32 s49, s33, 6
    s_add_u32 s48, s48, s49
    s_lshl_b32 s48, s48, 17
    s_add_u32 s52, s40, s48
    s_addc_u32 s53, s41, 0
    s_mov_b32 s54, 786432
    s_mov_b32 s55, 0x20000
    s_mov_b32 s12, s46
    s_mov_b32 s13, s50
    s_mov_b32 s14, 1966080
    s_mov_b32 s15, 0x20000
    s_lshl_b32 s48, s32, 2
    s_lshl_b32 s49, s33, 1
    s_add_u32 s48, s48, s49
    s_lshl_b32 s48, s48, 7
    s_add_u32 s48, s48, s38
    s_add_u32 s48, s48, 12582912
    v_and_b32 v4, 3, v1
    v_lshlrev_b32 v4, 2, v4
    v_and_b32 v5, 4, v1
    v_lshlrev_b32 v5, 5, v5
    v_add_u32 v4, v4, v5
    v_add_u32 v150, s48, v4
    v_mov_b32 v6, s44
    s_waitcnt vmcnt(15)
    s_mov_b64 exec, 1
    buffer_store_dword v6, off, s[20:23], s3 sc1
    s_mov_b64 exec, -1
    s_add_u32 s35, s91, 6
    s_and_b32 s35, s35, 15
    s_mul_i32 s35, s35, 5120
    buffer_load_dwordx4 v[192:195], v252, s[16:19], s35 offen offset:0 sc1
    buffer_load_dwordx4 v[196:199], v252, s[16:19], s35 offen offset:1024 sc1
    buffer_load_dwordx4 v[200:203], v252, s[16:19], s35 offen offset:2048 sc1
    buffer_load_dwordx4 v[204:207], v252, s[16:19], s35 offen offset:3072 sc1
    buffer_load_dwordx4 v[208:211], v253, s[16:19], s35 offen offset:0 sc1
    s_add_u32 s35, s91, 7
    s_and_b32 s35, s35, 15
    s_mul_i32 s35, s35, 5120
    buffer_load_dwordx4 v[212:215], v252, s[16:19], s35 offen offset:0 sc1
    buffer_load_dwordx4 v[216:219], v252, s[16:19], s35 offen offset:1024 sc1
    buffer_load_dwordx4 v[220:223], v252, s[16:19], s35 offen offset:2048 sc1
    buffer_load_dwordx4 v[224:227], v252, s[16:19], s35 offen offset:3072 sc1
    buffer_load_dwordx4 v[228:231], v253, s[16:19], s35 offen offset:0 sc1
    s_add_u32 s35, s91, 8
    s_and_b32 s35, s35, 15
    s_mul_i32 s35, s35, 5120
    buffer_load_dwordx4 v[232:235], v252, s[16:19], s35 offen offset:0 sc1
    buffer_load_dwordx4 v[236:239], v252, s[16:19], s35 offen offset:1024 sc1
    buffer_load_dwordx4 v[240:243], v252, s[16:19], s35 offen offset:2048 sc1
    buffer_load_dwordx4 v[244:247], v252, s[16:19], s35 offen offset:3072 sc1
    buffer_load_dwordx4 v[248:251], v253, s[16:19], s35 offen offset:0 sc1
    s_add_u32 s35, s91, 9
    s_and_b32 s35, s35, 15
    s_mul_i32 s35, s35, 5120
    buffer_load_dwordx4 a[60:63], v252, s[16:19], s35 offen offset:0 sc1
    buffer_load_dwordx4 a[64:67], v252, s[16:19], s35 offen offset:1024 sc1
    buffer_load_dwordx4 a[68:71], v252, s[16:19], s35 offen offset:2048 sc1
    buffer_load_dwordx4 a[72:75], v252, s[16:19], s35 offen offset:3072 sc1
    buffer_load_dwordx4 a[76:79], v253, s[16:19], s35 offen offset:0 sc1
    s_add_u32 s35, s91, 10
    s_and_b32 s35, s35, 15
    s_mul_i32 s35, s35, 5120
    buffer_load_dwordx4 a[80:83], v252, s[16:19], s35 offen offset:0 sc1
    buffer_load_dwordx4 a[84:87], v252, s[16:19], s35 offen offset:1024 sc1
    buffer_load_dwordx4 a[88:91], v252, s[16:19], s35 offen offset:2048 sc1
    buffer_load_dwordx4 a[92:95], v252, s[16:19], s35 offen offset:3072 sc1
    buffer_load_dwordx4 a[96:99], v253, s[16:19], s35 offen offset:0 sc1
    s_add_u32 s35, s91, 11
    s_and_b32 s35, s35, 15
    s_mul_i32 s35, s35, 5120
    buffer_load_dwordx4 a[100:103], v252, s[16:19], s35 offen offset:0 sc1
    buffer_load_dwordx4 a[104:107], v252, s[16:19], s35 offen offset:1024 sc1
    buffer_load_dwordx4 a[108:111], v252, s[16:19], s35 offen offset:2048 sc1
    buffer_load_dwordx4 a[112:115], v252, s[16:19], s35 offen offset:3072 sc1
    buffer_load_dwordx4 a[116:119], v253, s[16:19], s35 offen offset:0 sc1
    s_add_u32 s35, s91, 12
    s_and_b32 s35, s35, 15
    s_mul_i32 s35, s35, 5120
    buffer_load_dwordx4 a[120:123], v252, s[16:19], s35 offen offset:0 sc1
    buffer_load_dwordx4 a[124:127], v252, s[16:19], s35 offen offset:1024 sc1
    buffer_load_dwordx4 a[128:131], v252, s[16:19], s35 offen offset:2048 sc1
    buffer_load_dwordx4 a[132:135], v252, s[16:19], s35 offen offset:3072 sc1
    buffer_load_dwordx4 a[136:139], v253, s[16:19], s35 offen offset:0 sc1
    s_add_u32 s35, s91, 13
    s_and_b32 s35, s35, 15
    s_mul_i32 s35, s35, 5120
    buffer_load_dwordx4 v[104:107], v252, s[16:19], s35 offen offset:0 sc1
    buffer_load_dwordx4 v[108:111], v252, s[16:19], s35 offen offset:1024 sc1
    buffer_load_dwordx4 v[112:115], v252, s[16:19], s35 offen offset:2048 sc1
    buffer_load_dwordx4 v[116:119], v252, s[16:19], s35 offen offset:3072 sc1
    buffer_load_dwordx4 v[120:123], v253, s[16:19], s35 offen offset:0 sc1
    s_add_u32 s35, s91, 14
    s_and_b32 s35, s35, 15
    s_mul_i32 s35, s35, 5120
    buffer_load_dwordx4 v[124:127], v252, s[16:19], s35 offen offset:0 sc1
    buffer_load_dwordx4 v[128:131], v252, s[16:19], s35 offen offset:1024 sc1
    buffer_load_dwordx4 v[132:135], v252, s[16:19], s35 offen offset:2048 sc1
    buffer_load_dwordx4 v[136:139], v252, s[16:19], s35 offen offset:3072 sc1
    buffer_load_dwordx4 v[140:143], v253, s[16:19], s35 offen offset:0 sc1
    s_add_u32 s35, s91, 15
    s_and_b32 s35, s35, 15
    s_mul_i32 s35, s35, 5120
    buffer_load_dwordx4 v[152:155], v252, s[16:19], s35 offen offset:0 sc1
    buffer_load_dwordx4 v[156:159], v252, s[16:19], s35 offen offset:1024 sc1
    buffer_load_dwordx4 v[160:163], v252, s[16:19], s35 offen offset:2048 sc1
    buffer_load_dwordx4 v[164:167], v252, s[16:19], s35 offen offset:3072 sc1
    buffer_load_dwordx4 v[168:171], v253, s[16:19], s35 offen offset:0 sc1
    s_mov_b32 s47, 0xffffff00
    s_lshl_b32 s48, s2, 14
    s_add_u32 s36, s48, 18874368
    s_xor_b32 s48, s48, 65536
    s_add_u32 s35, s48, 18874368
    s_mul_i32 s48, s32, 192
    s_mul_i32 s49, s33, 96
    s_add_u32 s48, s48, s49
    s_mul_i32 s49, s37, 48
    s_add_u32 s48, s48, s49
    v_add_u32 v6, s48, v3
    v_mul_u32_u24 v6, 1280, v6
    s_mul_i32 s48, s34, 160
    v_lshlrev_b32 v7, 3, v2
    v_add_u32 v6, v6, v7
    v_add_u32 v6, s48, v6
    s_add_u32 s48, s24, 0
    s_mul_i32 s49, s48, 52
    s_lshr_b32 s49, s49, 8
    s_mul_i32 s51, s49, 5
    s_sub_u32 s51, s48, s51
    s_mul_i32 s49, s49, 20480
    s_lshl_b32 s51, s51, 5
    s_add_u32 s28, s51, s49
    s_cmp_eq_u32 s48, 15
    s_cselect_b32 s28, 0x7ff00000, s28
    s_add_u32 s4, s36, 0
    s_add_u32 s8, s35, 0
    s_add_u32 s48, s24, 4
    s_mul_i32 s49, s48, 52
    s_lshr_b32 s49, s49, 8
    s_mul_i32 s51, s49, 5
    s_sub_u32 s51, s48, s51
    s_mul_i32 s49, s49, 20480
    s_lshl_b32 s51, s51, 5
    s_add_u32 s29, s51, s49
    s_cmp_eq_u32 s48, 15
    s_cselect_b32 s29, 0x7ff00000, s29
    s_add_u32 s5, s36, 4096
    s_add_u32 s9, s35, 4096
    s_add_u32 s48, s24, 8
    s_mul_i32 s49, s48, 52
    s_lshr_b32 s49, s49, 8
    s_mul_i32 s51, s49, 5
    s_sub_u32 s51, s48, s51
    s_mul_i32 s49, s49, 20480
    s_lshl_b32 s51, s51, 5
    s_add_u32 s30, s51, s49
    s_cmp_eq_u32 s48, 15
    s_cselect_b32 s30, 0x7ff00000, s30
    s_add_u32 s6, s36, 8192
    s_add_u32 s10, s35, 8192
    s_add_u32 s48, s24, 12
    s_mul_i32 s49, s48, 52
    s_lshr_b32 s49, s49, 8
    s_mul_i32 s51, s49, 5
    s_sub_u32 s51, s48, s51
    s_mul_i32 s49, s49, 20480
    s_lshl_b32 s51, s51, 5
    s_add_u32 s31, s51, s49
    s_cmp_eq_u32 s48, 15
    s_cselect_b32 s31, 0x7ff00000, s31
    s_add_u32 s7, s36, 12288
    s_add_u32 s11, s35, 12288
    s_lshl_b32 s48, s24, 10
    v_add_u32 v7, s48, v252
    v_add_u32 v4, 61440, v7
L_poll:
    buffer_load_dword v5, v150, s[20:23], 0 offen sc1
    s_waitcnt vmcnt(0)
    v_cmp_ne_u32 vcc, s44, v5
    s_cbranch_vccnz L_poll
    s_add_u32 s27, s91, 0
    s_and_b32 s27, s27, 15
    s_lshl_b32 s27, s27, 10
    buffer_load_dwordx4 v[8:11], v147, s[52:55], s27 offen sc1
    buffer_load_dwordx4 v[12:15], v148, s[52:55], s27 offen sc1
    buffer_load_dwordx4 v[16:19], v149, s[52:55], s27 offen sc1
    s_add_u32 s27, s91, 1
    s_and_b32 s27, s27, 15
    s_lshl_b32 s27, s27, 10
    buffer_load_dwordx4 v[20:23], v147, s[52:55], s27 offen sc1
    buffer_load_dwordx4 v[24:27], v148, s[52:55], s27 offen sc1
    buffer_load_dwordx4 v[28:31], v149, s[52:55], s27 offen sc1
    s_add_u32 s27, s91, 2
    s_and_b32 s27, s27, 15
    s_lshl_b32 s27, s27, 10
    buffer_load_dwordx4 v[32:35], v147, s[52:55], s27 offen sc1
    buffer_load_dwordx4 v[36:39], v148, s[52:55], s27 offen sc1
    buffer_load_dwordx4 v[40:43], v149, s[52:55], s27 offen sc1
    s_add_u32 s27, s91, 3
    s_and_b32 s27, s27, 15
    s_lshl_b32 s27, s27, 10
    buffer_load_dwordx4 v[44:47], v147, s[52:55], s27 offen sc1
    buffer_load_dwordx4 v[48:51], v148, s[52:55], s27 offen sc1
    buffer_load_dwordx4 v[52:55], v149, s[52:55], s27 offen sc1
    s_add_u32 s27, s91, 4
    s_and_b32 s27, s27, 15
    s_lshl_b32 s27, s27, 10
    buffer_load_dwordx4 v[56:59], v147, s[52:55], s27 offen sc1
    buffer_load_dwordx4 v[60:63], v148, s[52:55], s27 offen sc1
    buffer_load_dwordx4 v[64:67], v149, s[52:55], s27 offen sc1
    s_lshr_b32 s48, s44, 0
    s_and_b32 s48, s48, 0xff
    v_mov_b32 v96, s48
    s_lshr_b32 s48, s44, 8
    s_and_b32 s48, s48, 0xff
    v_mov_b32 v97, s48
    s_lshr_b32 s48, s44, 16
    s_and_b32 s48, s48, 0xff
    v_mov_b32 v98, s48
    s_lshr_b32 s48, s44, 24
    s_and_b32 s48, s48, 0xff
    v_mov_b32 v99, s48
    s_waitcnt vmcnt(12)
    v_mfma_f32_16x16x32_bf16 a[0:3], a[144:147], v[8:11], 0
    s_add_u32 s27, s91, 5
    s_and_b32 s27, s27, 15
    s_lshl_b32 s27, s27, 10
    buffer_load_dwordx4 v[68:71], v147, s[52:55], s27 offen sc1
    v_mfma_f32_16x16x32_bf16 a[4:7], a[148:151], v[8:11], 0
    buffer_load_dwordx4 v[72:75], v148, s[52:55], s27 offen sc1
    v_mfma_f32_16x16x32_bf16 a[8:11], a[152:155], v[8:11], 0
    buffer_load_dwordx4 v[76:79], v149, s[52:55], s27 offen sc1
    v_mfma_f32_16x16x32_bf16 a[12:15], a[156:159], v[8:11], 0
    v_mfma_f32_16x16x32_bf16 a[16:19], a[160:163], v[8:11], 0
    v_mfma_f32_16x16x32_bf16 a[20:23], a[144:147], v[12:15], 0
    v_mfma_f32_16x16x32_bf16 a[24:27], a[148:151], v[12:15], 0
    v_mfma_f32_16x16x32_bf16 a[28:31], a[152:155], v[12:15], 0
    v_mfma_f32_16x16x32_bf16 a[32:35], a[156:159], v[12:15], 0
    v_mfma_f32_16x16x32_bf16 a[36:39], a[160:163], v[12:15], 0
    v_mfma_f32_16x16x32_bf16 a[40:43], a[144:147], v[16:19], 0
    v_mfma_f32_16x16x32_bf16 a[44:47], a[148:151], v[16:19], 0
    v_mfma_f32_16x16x32_bf16 a[48:51], a[152:155], v[16:19], 0
    v_mfma_f32_16x16x32_bf16 a[52:55], a[156:159], v[16:19], 0
    v_mfma_f32_16x16x32_bf16 a[56:59], a[160:163], v[16:19], 0
    s_waitcnt vmcnt(12)
    v_mfma_f32_16x16x32_bf16 a[0:3], a[164:167], v[20:23], a[0:3]
    s_add_u32 s27, s91, 6
    s_and_b32 s27, s27, 15
    s_lshl_b32 s27, s27, 10
    buffer_load_dwordx4 v[8:11], v147, s[52:55], s27 offen sc1
    v_mfma_f32_16x16x32_bf16 a[4:7], a[168:171], v[20:23], a[4:7]
    buffer_load_dwordx4 v[12:15], v148, s[52:55], s27 offen sc1
    v_mfma_f32_16x16x32_bf16 a[8:11], a[172:175], v[20:23], a[8:11]
    buffer_load_dwordx4 v[16:19], v149, s[52:55], s27 offen sc1
    v_mfma_f32_16x16x32_bf16 a[12:15], a[176:179], v[20:23], a[12:15]
    v_mfma_f32_16x16x32_bf16 a[16:19], a[180:183], v[20:23], a[16:19]
    v_mfma_f32_16x16x32_bf16 a[20:23], a[164:167], v[24:27], a[20:23]
    v_mfma_f32_16x16x32_bf16 a[24:27], a[168:171], v[24:27], a[24:27]
    v_mfma_f32_16x16x32_bf16 a[28:31], a[172:175], v[24:27], a[28:31]
    v_mfma_f32_16x16x32_bf16 a[32:35], a[176:179], v[24:27], a[32:35]
    v_mfma_f32_16x16x32_bf16 a[36:39], a[180:183], v[24:27], a[36:39]
    v_mfma_f32_16x16x32_bf16 a[40:43], a[164:167], v[28:31], a[40:43]
    v_mfma_f32_16x16x32_bf16 a[44:47], a[168:171], v[28:31], a[44:47]
    v_mfma_f32_16x16x32_bf16 a[48:51], a[172:175], v[28:31], a[48:51]
    v_mfma_f32_16x16x32_bf16 a[52:55], a[176:179], v[28:31], a[52:55]
    v_mfma_f32_16x16x32_bf16 a[56:59], a[180:183], v[28:31], a[56:59]
    s_waitcnt vmcnt(12)
    v_mfma_f32_16x16x32_bf16 a[0:3], a[184:187], v[32:35], a[0:3]
    s_add_u32 s27, s91, 7
    s_and_b32 s27, s27, 15
    s_lshl_b32 s27, s27, 10
    buffer_load_dwordx4 v[20:23], v147, s[52:55], s27 offen sc1
    v_mfma_f32_16x16x32_bf16 a[4:7], a[188:191], v[32:35], a[4:7]
    buffer_load_dwordx4 v[24:27], v148, s[52:55], s27 offen sc1
    v_mfma_f32_16x16x32_bf16 a[8:11], a[192:195], v[32:35], a[8:11]
    buffer_load_dwordx4 v[28:31], v149, s[52:55], s27 offen sc1
    v_mfma_f32_16x16x32_bf16 a[12:15], a[196:199], v[32:35], a[12:15]
    v_mfma_f32_16x16x32_bf16 a[16:19], a[200:203], v[32:35], a[16:19]
    v_mfma_f32_16x16x32_bf16 a[20:23], a[184:187], v[36:39], a[20:23]
    v_mfma_f32_16x16x32_bf16 a[24:27], a[188:191], v[36:39], a[24:27]
    v_mfma_f32_16x16x32_bf16 a[28:31], a[192:195], v[36:39], a[28:31]
    v_mfma_f32_16x16x32_bf16 a[32:35], a[196:199], v[36:39], a[32:35]
    v_mfma_f32_16x16x32_bf16 a[36:39], a[200:203], v[36:39], a[36:39]
    v_mfma_f32_16x16x32_bf16 a[40:43], a[184:187], v[40:43], a[40:43]
    v_mfma_f32_16x16x32_bf16 a[44:47], a[188:191], v[40:43], a[44:47]
    v_mfma_f32_16x16x32_bf16 a[48:51], a[192:195], v[40:43], a[48:51]
    v_mfma_f32_16x16x32_bf16 a[52:55], a[196:199], v[40:43], a[52:55]
    v_mfma_f32_16x16x32_bf16 a[56:59], a[200:203], v[40:43], a[56:59]
    s_waitcnt vmcnt(12)
    v_mfma_f32_16x16x32_bf16 a[0:3], a[204:207], v[44:47], a[0:3]
    s_add_u32 s27, s91, 8
    s_and_b32 s27, s27, 15
    s_lshl_b32 s27, s27, 10
    buffer_load_dwordx4 v[32:35], v147, s[52:55], s27 offen sc1
    v_mfma_f32_16x16x32_bf16 a[4:7], a[208:211], v[44:47], a[4:7]
    buffer_load_dwordx4 v[36:39], v148, s[52:55], s27 offen sc1
    v_mfma_f32_16x16x32_bf16 a[8:11], a[212:215], v[44:47], a[8:11]
    buffer_load_dwordx4 v[40:43], v149, s[52:55], s27 offen sc1
    v_mfma_f32_16x16x32_bf16 a[12:15], a[216:219], v[44:47], a[12:15]
    v_mfma_f32_16x16x32_bf16 a[16:19], a[220:223], v[44:47], a[16:19]
    v_mfma_f32_16x16x32_bf16 a[20:23], a[204:207], v[48:51], a[20:23]
    v_mfma_f32_16x16x32_bf16 a[24:27], a[208:211], v[48:51], a[24:27]
    v_mfma_f32_16x16x32_bf16 a[28:31], a[212:215], v[48:51], a[28:31]
    v_mfma_f32_16x16x32_bf16 a[32:35], a[216:219], v[48:51], a[32:35]
    v_mfma_f32_16x16x32_bf16 a[36:39], a[220:223], v[48:51], a[36:39]
    v_mfma_f32_16x16x32_bf16 a[40:43], a[204:207], v[52:55], a[40:43]
    v_mfma_f32_16x16x32_bf16 a[44:47], a[208:211], v[52:55], a[44:47]
    v_mfma_f32_16x16x32_bf16 a[48:51], a[212:215], v[52:55], a[48:51]
    v_mfma_f32_16x16x32_bf16 a[52:55], a[216:219], v[52:55], a[52:55]
    v_mfma_f32_16x16x32_bf16 a[56:59], a[220:223], v[52:55], a[56:59]
    s_waitcnt vmcnt(12)
    v_mfma_f32_16x16x32_bf16 a[0:3], a[224:227], v[56:59], a[0:3]
    s_add_u32 s27, s91, 9
    s_and_b32 s27, s27, 15
    s_lshl_b32 s27, s27, 10
    buffer_load_dwordx4 v[44:47], v147, s[52:55], s27 offen sc1
    v_mfma_f32_16x16x32_bf16 a[4:7], a[228:231], v[56:59], a[4:7]
    buffer_load_dwordx4 v[48:51], v148, s[52:55], s27 offen sc1
    v_mfma_f32_16x16x32_bf16 a[8:11], a[232:235], v[56:59], a[8:11]
    buffer_load_dwordx4 v[52:55], v149, s[52:55], s27 offen sc1
    v_mfma_f32_16x16x32_bf16 a[12:15], a[236:239], v[56:59], a[12:15]
    v_mfma_f32_16x16x32_bf16 a[16:19], a[240:243], v[56:59], a[16:19]
    v_mfma_f32_16x16x32_bf16 a[20:23], a[224:227], v[60:63], a[20:23]
    v_mfma_f32_16x16x32_bf16 a[24:27], a[228:231], v[60:63], a[24:27]
    v_mfma_f32_16x16x32_bf16 a[28:31], a[232:235], v[60:63], a[28:31]
    v_mfma_f32_16x16x32_bf16 a[32:35], a[236:239], v[60:63], a[32:35]
    v_mfma_f32_16x16x32_bf16 a[36:39], a[240:243], v[60:63], a[36:39]
    v_mfma_f32_16x16x32_bf16 a[40:43], a[224:227], v[64:67], a[40:43]
    v_mfma_f32_16x16x32_bf16 a[44:47], a[228:231], v[64:67], a[44:47]
    v_mfma_f32_16x16x32_bf16 a[48:51], a[232:235], v[64:67], a[48:51]
    v_mfma_f32_16x16x32_bf16 a[52:55], a[236:239], v[64:67], a[52:55]
    v_mfma_f32_16x16x32_bf16 a[56:59], a[240:243], v[64:67], a[56:59]
    s_waitcnt vmcnt(12)
    v_mfma_f32_16x16x32_bf16 a[0:3], v[172:175], v[68:71], a[0:3]
    s_add_u32 s27, s91, 10
    s_and_b32 s27, s27, 15
    s_lshl_b32 s27, s27, 10
    buffer_load_dwordx4 v[56:59], v147, s[52:55], s27 offen sc1
    v_mfma_f32_16x16x32_bf16 a[4:7], v[176:179], v[68:71], a[4:7]
    buffer_load_dwordx4 v[60:63], v148, s[52:55], s27 offen sc1
    v_mfma_f32_16x16x32_bf16 a[8:11], v[180:183], v[68:71], a[8:11]
    buffer_load_dwordx4 v[64:67], v149, s[52:55], s27 offen sc1
    v_mfma_f32_16x16x32_bf16 a[12:15], v[184:187], v[68:71], a[12:15]
    v_mfma_f32_16x16x32_bf16 a[16:19], v[188:191], v[68:71], a[16:19]
    v_mfma_f32_16x16x32_bf16 a[20:23], v[172:175], v[72:75], a[20:23]
    v_mfma_f32_16x16x32_bf16 a[24:27], v[176:179], v[72:75], a[24:27]
    v_mfma_f32_16x16x32_bf16 a[28:31], v[180:183], v[72:75], a[28:31]
    v_mfma_f32_16x16x32_bf16 a[32:35], v[184:187], v[72:75], a[32:35]
    v_mfma_f32_16x16x32_bf16 a[36:39], v[188:191], v[72:75], a[36:39]
    v_mfma_f32_16x16x32_bf16 a[40:43], v[172:175], v[76:79], a[40:43]
    v_mfma_f32_16x16x32_bf16 a[44:47], v[176:179], v[76:79], a[44:47]
    v_mfma_f32_16x16x32_bf16 a[48:51], v[180:183], v[76:79], a[48:51]
    v_mfma_f32_16x16x32_bf16 a[52:55], v[184:187], v[76:79], a[52:55]
    v_mfma_f32_16x16x32_bf16 a[56:59], v[188:191], v[76:79], a[56:59]
    s_waitcnt vmcnt(12)
    v_mfma_f32_16x16x32_bf16 a[0:3], v[192:195], v[8:11], a[0:3]
    s_add_u32 s27, s91, 11
    s_and_b32 s27, s27, 15
    s_lshl_b32 s27, s27, 10
    buffer_load_dwordx4 v[68:71], v147, s[52:55], s27 offen sc1
    v_mfma_f32_16x16x32_bf16 a[4:7], v[196:199], v[8:11], a[4:7]
    buffer_load_dwordx4 v[72:75], v148, s[52:55], s27 offen sc1
    v_mfma_f32_16x16x32_bf16 a[8:11], v[200:203], v[8:11], a[8:11]
    buffer_load_dwordx4 v[76:79], v149, s[52:55], s27 offen sc1
    v_mfma_f32_16x16x32_bf16 a[12:15], v[204:207], v[8:11], a[12:15]
    v_mfma_f32_16x16x32_bf16 a[16:19], v[208:211], v[8:11], a[16:19]
    v_mfma_f32_16x16x32_bf16 a[20:23], v[192:195], v[12:15], a[20:23]
    v_mfma_f32_16x16x32_bf16 a[24:27], v[196:199], v[12:15], a[24:27]
    v_mfma_f32_16x16x32_bf16 a[28:31], v[200:203], v[12:15], a[28:31]
    v_mfma_f32_16x16x32_bf16 a[32:35], v[204:207], v[12:15], a[32:35]
    v_mfma_f32_16x16x32_bf16 a[36:39], v[208:211], v[12:15], a[36:39]
    v_mfma_f32_16x16x32_bf16 a[40:43], v[192:195], v[16:19], a[40:43]
    v_mfma_f32_16x16x32_bf16 a[44:47], v[196:199], v[16:19], a[44:47]
    v_mfma_f32_16x16x32_bf16 a[48:51], v[200:203], v[16:19], a[48:51]
    v_mfma_f32_16x16x32_bf16 a[52:55], v[204:207], v[16:19], a[52:55]
    v_mfma_f32_16x16x32_bf16 a[56:59], v[208:211], v[16:19], a[56:59]
    s_waitcnt vmcnt(12)
    v_mfma_f32_16x16x32_bf16 a[0:3], v[212:215], v[20:23], a[0:3]
    s_add_u32 s27, s91, 12
    s_and_b32 s27, s27, 15
    s_lshl_b32 s27, s27, 10
    buffer_load_dwordx4 v[8:11], v147, s[52:55], s27 offen sc1
    v_mfma_f32_16x16x32_bf16 a[4:7], v[216:219], v[20:23], a[4:7]
    buffer_load_dwordx4 v[12:15], v148, s[52:55], s27 offen sc1
    v_mfma_f32_16x16x32_bf16 a[8:11], v[220:223], v[20:23], a[8:11]
    buffer_load_dwordx4 v[16:19], v149, s[52:55], s27 offen sc1
    v_mfma_f32_16x16x32_bf16 a[12:15], v[224:227], v[20:23], a[12:15]
    v_mfma_f32_16x16x32_bf16 a[16:19], v[228:231], v[20:23], a[16:19]
    v_mfma_f32_16x16x32_bf16 a[20:23], v[212:215], v[24:27], a[20:23]
    v_mfma_f32_16x16x32_bf16 a[24:27], v[216:219], v[24:27], a[24:27]
    v_mfma_f32_16x16x32_bf16 a[28:31], v[220:223], v[24:27], a[28:31]
    v_mfma_f32_16x16x32_bf16 a[32:35], v[224:227], v[24:27], a[32:35]
    v_mfma_f32_16x16x32_bf16 a[36:39], v[228:231], v[24:27], a[36:39]
    v_mfma_f32_16x16x32_bf16 a[40:43], v[212:215], v[28:31], a[40:43]
    v_mfma_f32_16x16x32_bf16 a[44:47], v[216:219], v[28:31], a[44:47]
    v_mfma_f32_16x16x32_bf16 a[48:51], v[220:223], v[28:31], a[48:51]
    v_mfma_f32_16x16x32_bf16 a[52:55], v[224:227], v[28:31], a[52:55]
    v_mfma_f32_16x16x32_bf16 a[56:59], v[228:231], v[28:31], a[56:59]
    s_waitcnt vmcnt(12)
    v_mfma_f32_16x16x32_bf16 a[0:3], v[232:235], v[32:35], a[0:3]
    s_add_u32 s27, s91, 13
    s_and_b32 s27, s27, 15
    s_lshl_b32 s27, s27, 10
    buffer_load_dwordx4 v[20:23], v147, s[52:55], s27 offen sc1
    v_mfma_f32_16x16x32_bf16 a[4:7], v[236:239], v[32:35], a[4:7]
    buffer_load_dwordx4 v[24:27], v148, s[52:55], s27 offen sc1
    v_mfma_f32_16x16x32_bf16 a[8:11], v[240:243], v[32:35], a[8:11]
    buffer_load_dwordx4 v[28:31], v149, s[52:55], s27 offen sc1
    v_mfma_f32_16x16x32_bf16 a[12:15], v[244:247], v[32:35], a[12:15]
    v_mfma_f32_16x16x32_bf16 a[16:19], v[248:251], v[32:35], a[16:19]
    v_mfma_f32_16x16x32_bf16 a[20:23], v[232:235], v[36:39], a[20:23]
    v_mfma_f32_16x16x32_bf16 a[24:27], v[236:239], v[36:39], a[24:27]
    v_mfma_f32_16x16x32_bf16 a[28:31], v[240:243], v[36:39], a[28:31]
    v_mfma_f32_16x16x32_bf16 a[32:35], v[244:247], v[36:39], a[32:35]
    v_mfma_f32_16x16x32_bf16 a[36:39], v[248:251], v[36:39], a[36:39]
    v_mfma_f32_16x16x32_bf16 a[40:43], v[232:235], v[40:43], a[40:43]
    v_mfma_f32_16x16x32_bf16 a[44:47], v[236:239], v[40:43], a[44:47]
    v_mfma_f32_16x16x32_bf16 a[48:51], v[240:243], v[40:43], a[48:51]
    v_mfma_f32_16x16x32_bf16 a[52:55], v[244:247], v[40:43], a[52:55]
    v_mfma_f32_16x16x32_bf16 a[56:59], v[248:251], v[40:43], a[56:59]
    s_waitcnt vmcnt(12)
    v_mfma_f32_16x16x32_bf16 a[0:3], a[60:63], v[44:47], a[0:3]
    s_add_u32 s27, s91, 14
    s_and_b32 s27, s27, 15
    s_lshl_b32 s27, s27, 10
    buffer_load_dwordx4 v[32:35], v147, s[52:55], s27 offen sc1
    v_mfma_f32_16x16x32_bf16 a[4:7], a[64:67], v[44:47], a[4:7]
    buffer_load_dwordx4 v[36:39], v148, s[52:55], s27 offen sc1
    v_mfma_f32_16x16x32_bf16 a[8:11], a[68:71], v[44:47], a[8:11]
    buffer_load_dwordx4 v[40:43], v149, s[52:55], s27 offen sc1
    v_mfma_f32_16x16x32_bf16 a[12:15], a[72:75], v[44:47], a[12:15]
    v_mfma_f32_16x16x32_bf16 a[16:19], a[76:79], v[44:47], a[16:19]
    v_mfma_f32_16x16x32_bf16 a[20:23], a[60:63], v[48:51], a[20:23]
    v_mfma_f32_16x16x32_bf16 a[24:27], a[64:67], v[48:51], a[24:27]
    v_mfma_f32_16x16x32_bf16 a[28:31], a[68:71], v[48:51], a[28:31]
    v_mfma_f32_16x16x32_bf16 a[32:35], a[72:75], v[48:51], a[32:35]
    v_mfma_f32_16x16x32_bf16 a[36:39], a[76:79], v[48:51], a[36:39]
    v_mfma_f32_16x16x32_bf16 a[40:43], a[60:63], v[52:55], a[40:43]
    v_mfma_f32_16x16x32_bf16 a[44:47], a[64:67], v[52:55], a[44:47]
    v_mfma_f32_16x16x32_bf16 a[48:51], a[68:71], v[52:55], a[48:51]
    v_mfma_f32_16x16x32_bf16 a[52:55], a[72:75], v[52:55], a[52:55]
    v_mfma_f32_16x16x32_bf16 a[56:59], a[76:79], v[52:55], a[56:59]
    s_waitcnt vmcnt(12)
    v_mfma_f32_16x16x32_bf16 a[0:3], a[80:83], v[56:59], a[0:3]
    s_add_u32 s27, s91, 15
    s_and_b32 s27, s27, 15
    s_lshl_b32 s27, s27, 10
    buffer_load_dwordx4 v[44:47], v147, s[52:55], s27 offen sc1
    v_mfma_f32_16x16x32_bf16 a[4:7], a[84:87], v[56:59], a[4:7]
    buffer_load_dwordx4 v[48:51], v148, s[52:55], s27 offen sc1
    v_mfma_f32_16x16x32_bf16 a[8:11], a[88:91], v[56:59], a[8:11]
    buffer_load_dwordx4 v[52:55], v149, s[52:55], s27 offen sc1
    v_mfma_f32_16x16x32_bf16 a[12:15], a[92:95], v[56:59], a[12:15]
    v_mfma_f32_16x16x32_bf16 a[16:19], a[96:99], v[56:59], a[16:19]
    v_mfma_f32_16x16x32_bf16 a[20:23], a[80:83], v[60:63], a[20:23]
    v_mfma_f32_16x16x32_bf16 a[24:27], a[84:87], v[60:63], a[24:27]
    v_mfma_f32_16x16x32_bf16 a[28:31], a[88:91], v[60:63], a[28:31]
    v_mfma_f32_16x16x32_bf16 a[32:35], a[92:95], v[60:63], a[32:35]
    v_mfma_f32_16x16x32_bf16 a[36:39], a[96:99], v[60:63], a[36:39]
    v_mfma_f32_16x16x32_bf16 a[40:43], a[80:83], v[64:67], a[40:43]
    v_mfma_f32_16x16x32_bf16 a[44:47], a[84:87], v[64:67], a[44:47]
    v_mfma_f32_16x16x32_bf16 a[48:51], a[88:91], v[64:67], a[48:51]
    v_mfma_f32_16x16x32_bf16 a[52:55], a[92:95], v[64:67], a[52:55]
    v_mfma_f32_16x16x32_bf16 a[56:59], a[96:99], v[64:67], a[56:59]
    s_waitcnt vmcnt(12)
    v_mfma_f32_16x16x32_bf16 a[0:3], a[100:103], v[68:71], a[0:3]
    s_add_u32 s27, s91, 0
    s_and_b32 s27, s27, 15
    s_lshl_b32 s27, s27, 10
    buffer_load_dwordx4 v[56:59], v144, s[52:55], s27 offen sc1
    v_mfma_f32_16x16x32_bf16 a[4:7], a[104:107], v[68:71], a[4:7]
    buffer_load_dwordx4 v[60:63], v145, s[52:55], s27 offen sc1
    v_mfma_f32_16x16x32_bf16 a[8:11], a[108:111], v[68:71], a[8:11]
    buffer_load_dwordx4 v[64:67], v146, s[52:55], s27 offen sc1
    v_mfma_f32_16x16x32_bf16 a[12:15], a[112:115], v[68:71], a[12:15]
    v_mfma_f32_16x16x32_bf16 a[16:19], a[116:119], v[68:71], a[16:19]
    v_mfma_f32_16x16x32_bf16 a[20:23], a[100:103], v[72:75], a[20:23]
    v_mfma_f32_16x16x32_bf16 a[24:27], a[104:107], v[72:75], a[24:27]
    v_mfma_f32_16x16x32_bf16 a[28:31], a[108:111], v[72:75], a[28:31]
    v_mfma_f32_16x16x32_bf16 a[32:35], a[112:115], v[72:75], a[32:35]
    v_mfma_f32_16x16x32_bf16 a[36:39], a[116:119], v[72:75], a[36:39]
    v_mfma_f32_16x16x32_bf16 a[40:43], a[100:103], v[76:79], a[40:43]
    v_mfma_f32_16x16x32_bf16 a[44:47], a[104:107], v[76:79], a[44:47]
    v_mfma_f32_16x16x32_bf16 a[48:51], a[108:111], v[76:79], a[48:51]
    v_mfma_f32_16x16x32_bf16 a[52:55], a[112:115], v[76:79], a[52:55]
    v_mfma_f32_16x16x32_bf16 a[56:59], a[116:119], v[76:79], a[56:59]
    s_waitcnt vmcnt(12)
    v_mfma_f32_16x16x32_bf16 a[0:3], a[120:123], v[8:11], a[0:3]
    s_add_u32 s27, s91, 1
    s_and_b32 s27, s27, 15
    s_lshl_b32 s27, s27, 10
    buffer_load_dwordx4 v[68:71], v144, s[52:55], s27 offen sc1
    v_mfma_f32_16x16x32_bf16 a[4:7], a[124:127], v[8:11], a[4:7]
    buffer_load_dwordx4 v[72:75], v145, s[52:55], s27 offen sc1
    v_mfma_f32_16x16x32_bf16 a[8:11], a[128:131], v[8:11], a[8:11]
    buffer_load_dwordx4 v[76:79], v146, s[52:55], s27 offen sc1
    v_mfma_f32_16x16x32_bf16 a[12:15], a[132:135], v[8:11], a[12:15]
    v_mfma_f32_16x16x32_bf16 a[16:19], a[136:139], v[8:11], a[16:19]
    v_mfma_f32_16x16x32_bf16 a[20:23], a[120:123], v[12:15], a[20:23]
    v_mfma_f32_16x16x32_bf16 a[24:27], a[124:127], v[12:15], a[24:27]
    v_mfma_f32_16x16x32_bf16 a[28:31], a[128:131], v[12:15], a[28:31]
    v_mfma_f32_16x16x32_bf16 a[32:35], a[132:135], v[12:15], a[32:35]
    v_mfma_f32_16x16x32_bf16 a[36:39], a[136:139], v[12:15], a[36:39]
    v_mfma_f32_16x16x32_bf16 a[40:43], a[120:123], v[16:19], a[40:43]
    v_mfma_f32_16x16x32_bf16 a[44:47], a[124:127], v[16:19], a[44:47]
    v_mfma_f32_16x16x32_bf16 a[48:51], a[128:131], v[16:19], a[48:51]
    v_mfma_f32_16x16x32_bf16 a[52:55], a[132:135], v[16:19], a[52:55]
    v_mfma_f32_16x16x32_bf16 a[56:59], a[136:139], v[16:19], a[56:59]
    s_waitcnt vmcnt(12)
    v_mfma_f32_16x16x32_bf16 a[0:3], v[104:107], v[20:23], a[0:3]
    s_add_u32 s27, s91, 2
    s_and_b32 s27, s27, 15
    s_lshl_b32 s27, s27, 10
    buffer_load_dwordx4 v[8:11], v144, s[52:55], s27 offen sc1
    v_mfma_f32_16x16x32_bf16 a[4:7], v[108:111], v[20:23], a[4:7]
    buffer_load_dwordx4 v[12:15], v145, s[52:55], s27 offen sc1
    v_mfma_f32_16x16x32_bf16 a[8:11], v[112:115], v[20:23], a[8:11]
    buffer_load_dwordx4 v[16:19], v146, s[52:55], s27 offen sc1
    v_mfma_f32_16x16x32_bf16 a[12:15], v[116:119], v[20:23], a[12:15]
    v_mfma_f32_16x16x32_bf16 a[16:19], v[120:123], v[20:23], a[16:19]
    v_mfma_f32_16x16x32_bf16 a[20:23], v[104:107], v[24:27], a[20:23]
    v_mfma_f32_16x16x32_bf16 a[24:27], v[108:111], v[24:27], a[24:27]
    v_mfma_f32_16x16x32_bf16 a[28:31], v[112:115], v[24:27], a[28:31]
    v_mfma_f32_16x16x32_bf16 a[32:35], v[116:119], v[24:27], a[32:35]
    v_mfma_f32_16x16x32_bf16 a[36:39], v[120:123], v[24:27], a[36:39]
    v_mfma_f32_16x16x32_bf16 a[40:43], v[104:107], v[28:31], a[40:43]
    v_mfma_f32_16x16x32_bf16 a[44:47], v[108:111], v[28:31], a[44:47]
    v_mfma_f32_16x16x32_bf16 a[48:51], v[112:115], v[28:31], a[48:51]
    v_mfma_f32_16x16x32_bf16 a[52:55], v[116:119], v[28:31], a[52:55]
    v_mfma_f32_16x16x32_bf16 a[56:59], v[120:123], v[28:31], a[56:59]
    s_waitcnt vmcnt(12)
    v_mfma_f32_16x16x32_bf16 a[0:3], v[124:127], v[32:35], a[0:3]
    s_add_u32 s27, s91, 3
    s_and_b32 s27, s27, 15
    s_lshl_b32 s27, s27, 10
    buffer_load_dwordx4 v[20:23], v144, s[52:55], s27 offen sc1
    v_mfma_f32_16x16x32_bf16 a[4:7], v[128:131], v[32:35], a[4:7]
    buffer_load_dwordx4 v[24:27], v145, s[52:55], s27 offen sc1
    v_mfma_f32_16x16x32_bf16 a[8:11], v[132:135], v[32:35], a[8:11]
    buffer_load_dwordx4 v[28:31], v146, s[52:55], s27 offen sc1
    v_mfma_f32_16x16x32_bf16 a[12:15], v[136:139], v[32:35], a[12:15]
    v_mfma_f32_16x16x32_bf16 a[16:19], v[140:143], v[32:35], a[16:19]
    v_mfma_f32_16x16x32_bf16 a[20:23], v[124:127], v[36:39], a[20:23]
    v_mfma_f32_16x16x32_bf16 a[24:27], v[128:131], v[36:39], a[24:27]
    v_mfma_f32_16x16x32_bf16 a[28:31], v[132:135], v[36:39], a[28:31]
    v_mfma_f32_16x16x32_bf16 a[32:35], v[136:139], v[36:39], a[32:35]
    v_mfma_f32_16x16x32_bf16 a[36:39], v[140:143], v[36:39], a[36:39]
    v_mfma_f32_16x16x32_bf16 a[40:43], v[124:127], v[40:43], a[40:43]
    v_mfma_f32_16x16x32_bf16 a[44:47], v[128:131], v[40:43], a[44:47]
    v_mfma_f32_16x16x32_bf16 a[48:51], v[132:135], v[40:43], a[48:51]
    v_mfma_f32_16x16x32_bf16 a[52:55], v[136:139], v[40:43], a[52:55]
    v_mfma_f32_16x16x32_bf16 a[56:59], v[140:143], v[40:43], a[56:59]
    s_waitcnt vmcnt(12)
    v_mfma_f32_16x16x32_bf16 a[0:3], v[152:155], v[44:47], a[0:3]
    s_add_u32 s27, s91, 4
    s_and_b32 s27, s27, 15
    s_lshl_b32 s27, s27, 10
    buffer_load_dwordx4 v[32:35], v144, s[52:55], s27 offen sc1
    v_mfma_f32_16x16x32_bf16 a[4:7], v[156:159], v[44:47], a[4:7]
    buffer_load_dwordx4 v[36:39], v145, s[52:55], s27 offen sc1
    v_mfma_f32_16x16x32_bf16 a[8:11], v[160:163], v[44:47], a[8:11]
    buffer_load_dwordx4 v[40:43], v146, s[52:55], s27 offen sc1
    v_mfma_f32_16x16x32_bf16 a[12:15], v[164:167], v[44:47], a[12:15]
    v_mfma_f32_16x16x32_bf16 a[16:19], v[168:171], v[44:47], a[16:19]
    v_mfma_f32_16x16x32_bf16 a[20:23], v[152:155], v[48:51], a[20:23]
    v_mfma_f32_16x16x32_bf16 a[24:27], v[156:159], v[48:51], a[24:27]
    v_mfma_f32_16x16x32_bf16 a[28:31], v[160:163], v[48:51], a[28:31]
    v_mfma_f32_16x16x32_bf16 a[32:35], v[164:167], v[48:51], a[32:35]
    v_mfma_f32_16x16x32_bf16 a[36:39], v[168:171], v[48:51], a[36:39]
    v_mfma_f32_16x16x32_bf16 a[40:43], v[152:155], v[52:55], a[40:43]
    v_mfma_f32_16x16x32_bf16 a[44:47], v[156:159], v[52:55], a[44:47]
    v_mfma_f32_16x16x32_bf16 a[48:51], v[160:163], v[52:55], a[48:51]
    v_mfma_f32_16x16x32_bf16 a[52:55], v[164:167], v[52:55], a[52:55]
    v_mfma_f32_16x16x32_bf16 a[56:59], v[168:171], v[52:55], a[56:59]
    s_nop 7
    ds_write_b128 v151, a[0:3] offset:0
    ds_write_b128 v151, a[4:7] offset:1024
    ds_write_b128 v151, a[8:11] offset:2048
    ds_write_b128 v151, a[12:15] offset:3072
    ds_write_b128 v151, a[16:19] offset:4096
    ds_write_b128 v151, a[20:23] offset:5120
    ds_write_b128 v151, a[24:27] offset:6144
    ds_write_b128 v151, a[28:31] offset:7168
    ds_write_b128 v151, a[32:35] offset:8192
    ds_write_b128 v151, a[36:39] offset:9216
    ds_write_b128 v151, a[40:43] offset:10240
    ds_write_b128 v151, a[44:47] offset:11264
    ds_write_b128 v151, a[48:51] offset:12288
    ds_write_b128 v151, a[52:55] offset:13312
    ds_write_b128 v151, a[56:59] offset:14336
    s_waitcnt lgkmcnt(0)
    s_waitcnt vmcnt(12)
    v_mfma_f32_16x16x32_bf16 a[0:3], a[144:147], v[56:59], 0
    s_add_u32 s27, s91, 5
    s_and_b32 s27, s27, 15
    s_lshl_b32 s27, s27, 10
    buffer_load_dwordx4 v[44:47], v144, s[52:55], s27 offen sc1
    v_mfma_f32_16x16x32_bf16 a[4:7], a[148:151], v[56:59], 0
    buffer_load_dwordx4 v[48:51], v145, s[52:55], s27 offen sc1
    v_mfma_f32_16x16x32_bf16 a[8:11], a[152:155], v[56:59], 0
    buffer_load_dwordx4 v[52:55], v146, s[52:55], s27 offen sc1
    v_mfma_f32_16x16x32_bf16 a[12:15], a[156:159], v[56:59], 0
    v_mfma_f32_16x16x32_bf16 a[16:19], a[160:163], v[56:59], 0
    v_mfma_f32_16x16x32_bf16 a[20:23], a[144:147], v[60:63], 0
    v_mfma_f32_16x16x32_bf16 a[24:27], a[148:151], v[60:63], 0
    v_mfma_f32_16x16x32_bf16 a[28:31], a[152:155], v[60:63], 0
    v_mfma_f32_16x16x32_bf16 a[32:35], a[156:159], v[60:63], 0
    v_mfma_f32_16x16x32_bf16 a[36:39], a[160:163], v[60:63], 0
    v_mfma_f32_16x16x32_bf16 a[40:43], a[144:147], v[64:67], 0
    v_mfma_f32_16x16x32_bf16 a[44:47], a[148:151], v[64:67], 0
    v_mfma_f32_16x16x32_bf16 a[48:51], a[152:155], v[64:67], 0
    v_mfma_f32_16x16x32_bf16 a[52:55], a[156:159], v[64:67], 0
    v_mfma_f32_16x16x32_bf16 a[56:59], a[160:163], v[64:67], 0
    s_barrier
    s_waitcnt vmcnt(12)
    v_mfma_f32_16x16x32_bf16 a[0:3], a[164:167], v[68:71], a[0:3]
    s_add_u32 s27, s91, 6
    s_and_b32 s27, s27, 15
    s_lshl_b32 s27, s27, 10
    buffer_load_dwordx4 v[56:59], v144, s[52:55], s27 offen sc1
    v_mfma_f32_16x16x32_bf16 a[4:7], a[168:171], v[68:71], a[4:7]
    buffer_load_dwordx4 v[60:63], v145, s[52:55], s27 offen sc1
    v_mfma_f32_16x16x32_bf16 a[8:11], a[172:175], v[68:71], a[8:11]
    buffer_load_dwordx4 v[64:67], v146, s[52:55], s27 offen sc1
    ds_read_b128 v[80:83], v7 offset:0
    v_mfma_f32_16x16x32_bf16 a[12:15], a[176:179], v[68:71], a[12:15]
    ds_read_b128 v[84:87], v7 offset:30720
    ds_read_b128 v[88:91], v4 offset:0
    v_mfma_f32_16x16x32_bf16 a[16:19], a[180:183], v[68:71], a[16:19]
    ds_read_b128 v[92:95], v4 offset:30720
    v_mfma_f32_16x16x32_bf16 a[20:23], a[164:167], v[72:75], a[20:23]
    v_mfma_f32_16x16x32_bf16 a[24:27], a[168:171], v[72:75], a[24:27]
    v_mfma_f32_16x16x32_bf16 a[28:31], a[172:175], v[72:75], a[28:31]
    v_mfma_f32_16x16x32_bf16 a[32:35], a[176:179], v[72:75], a[32:35]
    v_mfma_f32_16x16x32_bf16 a[36:39], a[180:183], v[72:75], a[36:39]
    v_mfma_f32_16x16x32_bf16 a[40:43], a[164:167], v[76:79], a[40:43]
    v_mfma_f32_16x16x32_bf16 a[44:47], a[168:171], v[76:79], a[44:47]
    v_mfma_f32_16x16x32_bf16 a[48:51], a[172:175], v[76:79], a[48:51]
    v_mfma_f32_16x16x32_bf16 a[52:55], a[176:179], v[76:79], a[52:55]
    v_mfma_f32_16x16x32_bf16 a[56:59], a[180:183], v[76:79], a[56:59]
    s_waitcnt vmcnt(12)
    v_mfma_f32_16x16x32_bf16 a[0:3], a[184:187], v[8:11], a[0:3]
    s_add_u32 s27, s91, 7
    s_and_b32 s27, s27, 15
    s_lshl_b32 s27, s27, 10
    buffer_load_dwordx4 v[68:71], v144, s[52:55], s27 offen sc1
    v_mfma_f32_16x16x32_bf16 a[4:7], a[188:191], v[8:11], a[4:7]
    buffer_load_dwordx4 v[72:75], v145, s[52:55], s27 offen sc1
    v_mfma_f32_16x16x32_bf16 a[8:11], a[192:195], v[8:11], a[8:11]
    buffer_load_dwordx4 v[76:79], v146, s[52:55], s27 offen sc1
    s_waitcnt lgkmcnt(0)
    v_mfma_f32_16x16x32_bf16 a[12:15], a[196:199], v[8:11], a[12:15]
    v_add_f32 v80, v80, v84
    v_add_f32 v81, v81, v85
    v_mfma_f32_16x16x32_bf16 a[16:19], a[200:203], v[8:11], a[16:19]
    v_add_f32 v82, v82, v86
    v_add_f32 v83, v83, v87
    v_mfma_f32_16x16x32_bf16 a[20:23], a[184:187], v[12:15], a[20:23]
    v_add_f32 v88, v88, v92
    v_add_f32 v89, v89, v93
    v_mfma_f32_16x16x32_bf16 a[24:27], a[188:191], v[12:15], a[24:27]
    v_add_f32 v90, v90, v94
    v_add_f32 v91, v91, v95
    v_mfma_f32_16x16x32_bf16 a[28:31], a[192:195], v[12:15], a[28:31]
    v_add_f32 v80, v80, v88
    v_add_f32 v81, v81, v89
    v_mfma_f32_16x16x32_bf16 a[32:35], a[196:199], v[12:15], a[32:35]
    v_add_f32 v82, v82, v90
    v_add_f32 v83, v83, v91
    v_mfma_f32_16x16x32_bf16 a[36:39], a[200:203], v[12:15], a[36:39]
    v_and_or_b32 v80, v80, s47, v96
    v_and_or_b32 v81, v81, s47, v97
    v_mfma_f32_16x16x32_bf16 a[40:43], a[184:187], v[16:19], a[40:43]
    v_and_or_b32 v82, v82, s47, v98
    v_and_or_b32 v83, v83, s47, v99
    v_mfma_f32_16x16x32_bf16 a[44:47], a[188:191], v[16:19], a[44:47]
    buffer_store_dwordx4 v[80:83], v7, s[20:23], s4 offen sc1
    s_nop 1
    v_mfma_f32_16x16x32_bf16 a[48:51], a[192:195], v[16:19], a[48:51]
    ds_read_b128 v[80:83], v7 offset:4096
    ds_read_b128 v[84:87], v7 offset:34816
    v_mfma_f32_16x16x32_bf16 a[52:55], a[196:199], v[16:19], a[52:55]
    ds_read_b128 v[88:91], v4 offset:4096
    ds_read_b128 v[92:95], v4 offset:34816
    v_mfma_f32_16x16x32_bf16 a[56:59], a[200:203], v[16:19], a[56:59]
    s_waitcnt vmcnt(13)
    v_mfma_f32_16x16x32_bf16 a[0:3], a[204:207], v[20:23], a[0:3]
    s_add_u32 s27, s91, 8
    s_and_b32 s27, s27, 15
    s_lshl_b32 s27, s27, 10
    buffer_load_dwordx4 v[8:11], v144, s[52:55], s27 offen sc1
    v_mfma_f32_16x16x32_bf16 a[4:7], a[208:211], v[20:23], a[4:7]
    buffer_load_dwordx4 v[12:15], v145, s[52:55], s27 offen sc1
    v_mfma_f32_16x16x32_bf16 a[8:11], a[212:215], v[20:23], a[8:11]
    buffer_load_dwordx4 v[16:19], v146, s[52:55], s27 offen sc1
    s_waitcnt lgkmcnt(0)
    v_mfma_f32_16x16x32_bf16 a[12:15], a[216:219], v[20:23], a[12:15]
    v_add_f32 v80, v80, v84
    v_add_f32 v81, v81, v85
    v_mfma_f32_16x16x32_bf16 a[16:19], a[220:223], v[20:23], a[16:19]
    v_add_f32 v82, v82, v86
    v_add_f32 v83, v83, v87
    v_mfma_f32_16x16x32_bf16 a[20:23], a[204:207], v[24:27], a[20:23]
    v_add_f32 v88, v88, v92
    v_add_f32 v89, v89, v93
    v_mfma_f32_16x16x32_bf16 a[24:27], a[208:211], v[24:27], a[24:27]
    v_add_f32 v90, v90, v94
    v_add_f32 v91, v91, v95
    v_mfma_f32_16x16x32_bf16 a[28:31], a[212:215], v[24:27], a[28:31]
    v_add_f32 v80, v80, v88
    v_add_f32 v81, v81, v89
    v_mfma_f32_16x16x32_bf16 a[32:35], a[216:219], v[24:27], a[32:35]
    v_add_f32 v82, v82, v90
    v_add_f32 v83, v83, v91
    v_mfma_f32_16x16x32_bf16 a[36:39], a[220:223], v[24:27], a[36:39]
    v_and_or_b32 v80, v80, s47, v96
    v_and_or_b32 v81, v81, s47, v97
    v_mfma_f32_16x16x32_bf16 a[40:43], a[204:207], v[28:31], a[40:43]
    v_and_or_b32 v82, v82, s47, v98
    v_and_or_b32 v83, v83, s47, v99
    v_mfma_f32_16x16x32_bf16 a[44:47], a[208:211], v[28:31], a[44:47]
    buffer_store_dwordx4 v[80:83], v7, s[20:23], s5 offen sc1
    s_nop 1
    v_mfma_f32_16x16x32_bf16 a[48:51], a[212:215], v[28:31], a[48:51]
    ds_read_b128 v[80:83], v7 offset:8192
    ds_read_b128 v[84:87], v7 offset:38912
    v_mfma_f32_16x16x32_bf16 a[52:55], a[216:219], v[28:31], a[52:55]
    ds_read_b128 v[88:91], v4 offset:8192
    ds_read_b128 v[92:95], v4 offset:38912
    v_mfma_f32_16x16x32_bf16 a[56:59], a[220:223], v[28:31], a[56:59]
    s_waitcnt vmcnt(14)
    v_mfma_f32_16x16x32_bf16 a[0:3], a[224:227], v[32:35], a[0:3]
    s_add_u32 s27, s91, 9
    s_and_b32 s27, s27, 15
    s_lshl_b32 s27, s27, 10
    buffer_load_dwordx4 v[20:23], v144, s[52:55], s27 offen sc1
    v_mfma_f32_16x16x32_bf16 a[4:7], a[228:231], v[32:35], a[4:7]
    buffer_load_dwordx4 v[24:27], v145, s[52:55], s27 offen sc1
    v_mfma_f32_16x16x32_bf16 a[8:11], a[232:235], v[32:35], a[8:11]
    buffer_load_dwordx4 v[28:31], v146, s[52:55], s27 offen sc1
    s_waitcnt lgkmcnt(0)
    v_mfma_f32_16x16x32_bf16 a[12:15], a[236:239], v[32:35], a[12:15]
    v_add_f32 v80, v80, v84
    v_add_f32 v81, v81, v85
    v_mfma_f32_16x16x32_bf16 a[16:19], a[240:243], v[32:35], a[16:19]
    v_add_f32 v82, v82, v86
    v_add_f32 v83, v83, v87
    v_mfma_f32_16x16x32_bf16 a[20:23], a[224:227], v[36:39], a[20:23]
    v_add_f32 v88, v88, v92
    v_add_f32 v89, v89, v93
    v_mfma_f32_16x16x32_bf16 a[24:27], a[228:231], v[36:39], a[24:27]
    v_add_f32 v90, v90, v94
    v_add_f32 v91, v91, v95
    v_mfma_f32_16x16x32_bf16 a[28:31], a[232:235], v[36:39], a[28:31]
    v_add_f32 v80, v80, v88
    v_add_f32 v81, v81, v89
    v_mfma_f32_16x16x32_bf16 a[32:35], a[236:239], v[36:39], a[32:35]
    v_add_f32 v82, v82, v90
    v_add_f32 v83, v83, v91
    v_mfma_f32_16x16x32_bf16 a[36:39], a[240:243], v[36:39], a[36:39]
    v_and_or_b32 v80, v80, s47, v96
    v_and_or_b32 v81, v81, s47, v97
    v_mfma_f32_16x16x32_bf16 a[40:43], a[224:227], v[40:43], a[40:43]
    v_and_or_b32 v82, v82, s47, v98
    v_and_or_b32 v83, v83, s47, v99
    v_mfma_f32_16x16x32_bf16 a[44:47], a[228:231], v[40:43], a[44:47]
    buffer_store_dwordx4 v[80:83], v7, s[20:23], s6 offen sc1
    s_nop 1
    v_mfma_f32_16x16x32_bf16 a[48:51], a[232:235], v[40:43], a[48:51]
    ds_read_b128 v[80:83], v7 offset:12288
    ds_read_b128 v[84:87], v7 offset:43008
    v_mfma_f32_16x16x32_bf16 a[52:55], a[236:239], v[40:43], a[52:55]
    ds_read_b128 v[88:91], v4 offset:12288
    ds_read_b128 v[92:95], v4 offset:43008
    v_mfma_f32_16x16x32_bf16 a[56:59], a[240:243], v[40:43], a[56:59]
    s_waitcnt vmcnt(15)
    v_mfma_f32_16x16x32_bf16 a[0:3], v[172:175], v[44:47], a[0:3]
    s_add_u32 s27, s91, 10
    s_and_b32 s27, s27, 15
    s_lshl_b32 s27, s27, 10
    buffer_load_dwordx4 v[32:35], v144, s[52:55], s27 offen sc1
    v_mfma_f32_16x16x32_bf16 a[4:7], v[176:179], v[44:47], a[4:7]
    buffer_load_dwordx4 v[36:39], v145, s[52:55], s27 offen sc1
    v_mfma_f32_16x16x32_bf16 a[8:11], v[180:183], v[44:47], a[8:11]
    buffer_load_dwordx4 v[40:43], v146, s[52:55], s27 offen sc1
    s_waitcnt lgkmcnt(0)
    v_mfma_f32_16x16x32_bf16 a[12:15], v[184:187], v[44:47], a[12:15]
    v_add_f32 v80, v80, v84
    v_add_f32 v81, v81, v85
    v_mfma_f32_16x16x32_bf16 a[16:19], v[188:191], v[44:47], a[16:19]
    v_add_f32 v82, v82, v86
    v_add_f32 v83, v83, v87
    v_mfma_f32_16x16x32_bf16 a[20:23], v[172:175], v[48:51], a[20:23]
    v_add_f32 v88, v88, v92
    v_add_f32 v89, v89, v93
    v_mfma_f32_16x16x32_bf16 a[24:27], v[176:179], v[48:51], a[24:27]
    v_add_f32 v90, v90, v94
    v_add_f32 v91, v91, v95
    v_mfma_f32_16x16x32_bf16 a[28:31], v[180:183], v[48:51], a[28:31]
    v_add_f32 v80, v80, v88
    v_add_f32 v81, v81, v89
    v_mfma_f32_16x16x32_bf16 a[32:35], v[184:187], v[48:51], a[32:35]
    v_add_f32 v82, v82, v90
    v_add_f32 v83, v83, v91
    v_mfma_f32_16x16x32_bf16 a[36:39], v[188:191], v[48:51], a[36:39]
    v_and_or_b32 v80, v80, s47, v96
    v_and_or_b32 v81, v81, s47, v97
    v_mfma_f32_16x16x32_bf16 a[40:43], v[172:175], v[52:55], a[40:43]
    v_and_or_b32 v82, v82, s47, v98
    v_and_or_b32 v83, v83, s47, v99
    v_mfma_f32_16x16x32_bf16 a[44:47], v[176:179], v[52:55], a[44:47]
    buffer_store_dwordx4 v[80:83], v7, s[20:23], s7 offen sc1
    v_mfma_f32_16x16x32_bf16 a[48:51], v[180:183], v[52:55], a[48:51]
    v_mfma_f32_16x16x32_bf16 a[52:55], v[184:187], v[52:55], a[52:55]
    v_mfma_f32_16x16x32_bf16 a[56:59], v[188:191], v[52:55], a[56:59]
    s_waitcnt vmcnt(16)
    v_mfma_f32_16x16x32_bf16 a[0:3], v[192:195], v[56:59], a[0:3]
    s_add_u32 s27, s91, 11
    s_and_b32 s27, s27, 15
    s_lshl_b32 s27, s27, 10
    buffer_load_dwordx4 v[44:47], v144, s[52:55], s27 offen sc1
    v_mfma_f32_16x16x32_bf16 a[4:7], v[196:199], v[56:59], a[4:7]
    buffer_load_dwordx4 v[48:51], v145, s[52:55], s27 offen sc1
    v_mfma_f32_16x16x32_bf16 a[8:11], v[200:203], v[56:59], a[8:11]
    buffer_load_dwordx4 v[52:55], v146, s[52:55], s27 offen sc1
    v_mfma_f32_16x16x32_bf16 a[12:15], v[204:207], v[56:59], a[12:15]
    v_mfma_f32_16x16x32_bf16 a[16:19], v[208:211], v[56:59], a[16:19]
    v_mfma_f32_16x16x32_bf16 a[20:23], v[192:195], v[60:63], a[20:23]
    v_mfma_f32_16x16x32_bf16 a[24:27], v[196:199], v[60:63], a[24:27]
    v_mfma_f32_16x16x32_bf16 a[28:31], v[200:203], v[60:63], a[28:31]
    v_mfma_f32_16x16x32_bf16 a[32:35], v[204:207], v[60:63], a[32:35]
    v_mfma_f32_16x16x32_bf16 a[36:39], v[208:211], v[60:63], a[36:39]
    v_mfma_f32_16x16x32_bf16 a[40:43], v[192:195], v[64:67], a[40:43]
    v_mfma_f32_16x16x32_bf16 a[44:47], v[196:199], v[64:67], a[44:47]
    v_mfma_f32_16x16x32_bf16 a[48:51], v[200:203], v[64:67], a[48:51]
    v_mfma_f32_16x16x32_bf16 a[52:55], v[204:207], v[64:67], a[52:55]
    v_mfma_f32_16x16x32_bf16 a[56:59], v[208:211], v[64:67], a[56:59]
    s_waitcnt vmcnt(16)
    v_mfma_f32_16x16x32_bf16 a[0:3], v[212:215], v[68:71], a[0:3]
    s_add_u32 s27, s91, 12
    s_and_b32 s27, s27, 15
    s_lshl_b32 s27, s27, 10
    buffer_load_dwordx4 v[56:59], v144, s[52:55], s27 offen sc1
    v_mfma_f32_16x16x32_bf16 a[4:7], v[216:219], v[68:71], a[4:7]
    buffer_load_dwordx4 v[60:63], v145, s[52:55], s27 offen sc1
    v_mfma_f32_16x16x32_bf16 a[8:11], v[220:223], v[68:71], a[8:11]
    buffer_load_dwordx4 v[64:67], v146, s[52:55], s27 offen sc1
    v_mfma_f32_16x16x32_bf16 a[12:15], v[224:227], v[68:71], a[12:15]
    v_mfma_f32_16x16x32_bf16 a[16:19], v[228:231], v[68:71], a[16:19]
    v_mfma_f32_16x16x32_bf16 a[20:23], v[212:215], v[72:75], a[20:23]
    v_mfma_f32_16x16x32_bf16 a[24:27], v[216:219], v[72:75], a[24:27]
    v_mfma_f32_16x16x32_bf16 a[28:31], v[220:223], v[72:75], a[28:31]
    v_mfma_f32_16x16x32_bf16 a[32:35], v[224:227], v[72:75], a[32:35]
    v_mfma_f32_16x16x32_bf16 a[36:39], v[228:231], v[72:75], a[36:39]
    v_mfma_f32_16x16x32_bf16 a[40:43], v[212:215], v[76:79], a[40:43]
    v_mfma_f32_16x16x32_bf16 a[44:47], v[216:219], v[76:79], a[44:47]
    v_mfma_f32_16x16x32_bf16 a[48:51], v[220:223], v[76:79], a[48:51]
    v_mfma_f32_16x16x32_bf16 a[52:55], v[224:227], v[76:79], a[52:55]
    v_mfma_f32_16x16x32_bf16 a[56:59], v[228:231], v[76:79], a[56:59]
    s_waitcnt vmcnt(15)
    v_mfma_f32_16x16x32_bf16 a[0:3], v[232:235], v[8:11], a[0:3]
    s_add_u32 s27, s91, 13
    s_and_b32 s27, s27, 15
    s_lshl_b32 s27, s27, 10
    buffer_load_dwordx4 v[68:71], v144, s[52:55], s27 offen sc1
    v_mfma_f32_16x16x32_bf16 a[4:7], v[236:239], v[8:11], a[4:7]
    buffer_load_dwordx4 v[72:75], v145, s[52:55], s27 offen sc1
    v_mfma_f32_16x16x32_bf16 a[8:11], v[240:243], v[8:11], a[8:11]
    buffer_load_dwordx4 v[76:79], v146, s[52:55], s27 offen sc1
    v_mfma_f32_16x16x32_bf16 a[12:15], v[244:247], v[8:11], a[12:15]
    v_mfma_f32_16x16x32_bf16 a[16:19], v[248:251], v[8:11], a[16:19]
    v_mfma_f32_16x16x32_bf16 a[20:23], v[232:235], v[12:15], a[20:23]
    v_mfma_f32_16x16x32_bf16 a[24:27], v[236:239], v[12:15], a[24:27]
    v_mfma_f32_16x16x32_bf16 a[28:31], v[240:243], v[12:15], a[28:31]
    v_mfma_f32_16x16x32_bf16 a[32:35], v[244:247], v[12:15], a[32:35]
    v_mfma_f32_16x16x32_bf16 a[36:39], v[248:251], v[12:15], a[36:39]
    v_mfma_f32_16x16x32_bf16 a[40:43], v[232:235], v[16:19], a[40:43]
    v_mfma_f32_16x16x32_bf16 a[44:47], v[236:239], v[16:19], a[44:47]
    v_mfma_f32_16x16x32_bf16 a[48:51], v[240:243], v[16:19], a[48:51]
    v_mfma_f32_16x16x32_bf16 a[52:55], v[244:247], v[16:19], a[52:55]
    v_mfma_f32_16x16x32_bf16 a[56:59], v[248:251], v[16:19], a[56:59]
    s_waitcnt vmcnt(14)
    v_mfma_f32_16x16x32_bf16 a[0:3], a[60:63], v[20:23], a[0:3]
    s_add_u32 s27, s91, 14
    s_and_b32 s27, s27, 15
    s_lshl_b32 s27, s27, 10
    buffer_load_dwordx4 v[8:11], v144, s[52:55], s27 offen sc1
    v_mfma_f32_16x16x32_bf16 a[4:7], a[64:67], v[20:23], a[4:7]
    buffer_load_dwordx4 v[12:15], v145, s[52:55], s27 offen sc1
    v_mfma_f32_16x16x32_bf16 a[8:11], a[68:71], v[20:23], a[8:11]
    buffer_load_dwordx4 v[16:19], v146, s[52:55], s27 offen sc1
    v_mfma_f32_16x16x32_bf16 a[12:15], a[72:75], v[20:23], a[12:15]
    v_mfma_f32_16x16x32_bf16 a[16:19], a[76:79], v[20:23], a[16:19]
    v_mfma_f32_16x16x32_bf16 a[20:23], a[60:63], v[24:27], a[20:23]
    v_mfma_f32_16x16x32_bf16 a[24:27], a[64:67], v[24:27], a[24:27]
    v_mfma_f32_16x16x32_bf16 a[28:31], a[68:71], v[24:27], a[28:31]
    v_mfma_f32_16x16x32_bf16 a[32:35], a[72:75], v[24:27], a[32:35]
    v_mfma_f32_16x16x32_bf16 a[36:39], a[76:79], v[24:27], a[36:39]
    v_mfma_f32_16x16x32_bf16 a[40:43], a[60:63], v[28:31], a[40:43]
    v_mfma_f32_16x16x32_bf16 a[44:47], a[64:67], v[28:31], a[44:47]
    v_mfma_f32_16x16x32_bf16 a[48:51], a[68:71], v[28:31], a[48:51]
    v_mfma_f32_16x16x32_bf16 a[52:55], a[72:75], v[28:31], a[52:55]
    v_mfma_f32_16x16x32_bf16 a[56:59], a[76:79], v[28:31], a[56:59]
    s_waitcnt vmcnt(13)
    v_mfma_f32_16x16x32_bf16 a[0:3], a[80:83], v[32:35], a[0:3]
    s_add_u32 s27, s91, 15
    s_and_b32 s27, s27, 15
    s_lshl_b32 s27, s27, 10
    buffer_load_dwordx4 v[20:23], v144, s[52:55], s27 offen sc1
    v_mfma_f32_16x16x32_bf16 a[4:7], a[84:87], v[32:35], a[4:7]
    buffer_load_dwordx4 v[24:27], v145, s[52:55], s27 offen sc1
    v_mfma_f32_16x16x32_bf16 a[8:11], a[88:91], v[32:35], a[8:11]
    buffer_load_dwordx4 v[28:31], v146, s[52:55], s27 offen sc1
    v_mfma_f32_16x16x32_bf16 a[12:15], a[92:95], v[32:35], a[12:15]
    v_mfma_f32_16x16x32_bf16 a[16:19], a[96:99], v[32:35], a[16:19]
    v_mfma_f32_16x16x32_bf16 a[20:23], a[80:83], v[36:39], a[20:23]
    v_mfma_f32_16x16x32_bf16 a[24:27], a[84:87], v[36:39], a[24:27]
    v_mfma_f32_16x16x32_bf16 a[28:31], a[88:91], v[36:39], a[28:31]
    v_mfma_f32_16x16x32_bf16 a[32:35], a[92:95], v[36:39], a[32:35]
    v_mfma_f32_16x16x32_bf16 a[36:39], a[96:99], v[36:39], a[36:39]
    v_mfma_f32_16x16x32_bf16 a[40:43], a[80:83], v[40:43], a[40:43]
    v_mfma_f32_16x16x32_bf16 a[44:47], a[84:87], v[40:43], a[44:47]
    v_mfma_f32_16x16x32_bf16 a[48:51], a[88:91], v[40:43], a[48:51]
    v_mfma_f32_16x16x32_bf16 a[52:55], a[92:95], v[40:43], a[52:55]
    v_mfma_f32_16x16x32_bf16 a[56:59], a[96:99], v[40:43], a[56:59]
    s_waitcnt vmcnt(12)
    v_mfma_f32_16x16x32_bf16 a[0:3], a[100:103], v[44:47], a[0:3]
    v_mfma_f32_16x16x32_bf16 a[4:7], a[104:107], v[44:47], a[4:7]
    v_mfma_f32_16x16x32_bf16 a[8:11], a[108:111], v[44:47], a[8:11]
    v_mfma_f32_16x16x32_bf16 a[12:15], a[112:115], v[44:47], a[12:15]
    v_mfma_f32_16x16x32_bf16 a[16:19], a[116:119], v[44:47], a[16:19]
    v_mfma_f32_16x16x32_bf16 a[20:23], a[100:103], v[48:51], a[20:23]
    v_mfma_f32_16x16x32_bf16 a[24:27], a[104:107], v[48:51], a[24:27]
    v_mfma_f32_16x16x32_bf16 a[28:31], a[108:111], v[48:51], a[28:31]
    v_mfma_f32_16x16x32_bf16 a[32:35], a[112:115], v[48:51], a[32:35]
    v_mfma_f32_16x16x32_bf16 a[36:39], a[116:119], v[48:51], a[36:39]
    v_mfma_f32_16x16x32_bf16 a[40:43], a[100:103], v[52:55], a[40:43]
    v_mfma_f32_16x16x32_bf16 a[44:47], a[104:107], v[52:55], a[44:47]
    v_mfma_f32_16x16x32_bf16 a[48:51], a[108:111], v[52:55], a[48:51]
    v_mfma_f32_16x16x32_bf16 a[52:55], a[112:115], v[52:55], a[52:55]
    v_mfma_f32_16x16x32_bf16 a[56:59], a[116:119], v[52:55], a[56:59]
    s_waitcnt vmcnt(9)
    v_mfma_f32_16x16x32_bf16 a[0:3], a[120:123], v[56:59], a[0:3]
    v_mfma_f32_16x16x32_bf16 a[4:7], a[124:127], v[56:59], a[4:7]
    v_mfma_f32_16x16x32_bf16 a[8:11], a[128:131], v[56:59], a[8:11]
    v_mfma_f32_16x16x32_bf16 a[12:15], a[132:135], v[56:59], a[12:15]
    v_mfma_f32_16x16x32_bf16 a[16:19], a[136:139], v[56:59], a[16:19]
    v_mfma_f32_16x16x32_bf16 a[20:23], a[120:123], v[60:63], a[20:23]
    v_mfma_f32_16x16x32_bf16 a[24:27], a[124:127], v[60:63], a[24:27]
    v_mfma_f32_16x16x32_bf16 a[28:31], a[128:131], v[60:63], a[28:31]
    v_mfma_f32_16x16x32_bf16 a[32:35], a[132:135], v[60:63], a[32:35]
    v_mfma_f32_16x16x32_bf16 a[36:39], a[136:139], v[60:63], a[36:39]
    v_mfma_f32_16x16x32_bf16 a[40:43], a[120:123], v[64:67], a[40:43]
    v_mfma_f32_16x16x32_bf16 a[44:47], a[124:127], v[64:67], a[44:47]
    v_mfma_f32_16x16x32_bf16 a[48:51], a[128:131], v[64:67], a[48:51]
    v_mfma_f32_16x16x32_bf16 a[52:55], a[132:135], v[64:67], a[52:55]
    v_mfma_f32_16x16x32_bf16 a[56:59], a[136:139], v[64:67], a[56:59]
    s_waitcnt vmcnt(6)
    v_mfma_f32_16x16x32_bf16 a[0:3], v[104:107], v[68:71], a[0:3]
    v_mfma_f32_16x16x32_bf16 a[4:7], v[108:111], v[68:71], a[4:7]
    v_mfma_f32_16x16x32_bf16 a[8:11], v[112:115], v[68:71], a[8:11]
    v_mfma_f32_16x16x32_bf16 a[12:15], v[116:119], v[68:71], a[12:15]
    v_mfma_f32_16x16x32_bf16 a[16:19], v[120:123], v[68:71], a[16:19]
    v_mfma_f32_16x16x32_bf16 a[20:23], v[104:107], v[72:75], a[20:23]
    v_mfma_f32_16x16x32_bf16 a[24:27], v[108:111], v[72:75], a[24:27]
    v_mfma_f32_16x16x32_bf16 a[28:31], v[112:115], v[72:75], a[28:31]
    v_mfma_f32_16x16x32_bf16 a[32:35], v[116:119], v[72:75], a[32:35]
    v_mfma_f32_16x16x32_bf16 a[36:39], v[120:123], v[72:75], a[36:39]
    v_mfma_f32_16x16x32_bf16 a[40:43], v[104:107], v[76:79], a[40:43]
    v_mfma_f32_16x16x32_bf16 a[44:47], v[108:111], v[76:79], a[44:47]
    v_mfma_f32_16x16x32_bf16 a[48:51], v[112:115], v[76:79], a[48:51]
    v_mfma_f32_16x16x32_bf16 a[52:55], v[116:119], v[76:79], a[52:55]
    v_mfma_f32_16x16x32_bf16 a[56:59], v[120:123], v[76:79], a[56:59]
    s_waitcnt vmcnt(3)
    v_mfma_f32_16x16x32_bf16 a[0:3], v[124:127], v[8:11], a[0:3]
    v_mfma_f32_16x16x32_bf16 a[4:7], v[128:131], v[8:11], a[4:7]
    v_mfma_f32_16x16x32_bf16 a[8:11], v[132:135], v[8:11], a[8:11]
    v_mfma_f32_16x16x32_bf16 a[12:15], v[136:139], v[8:11], a[12:15]
    v_mfma_f32_16x16x32_bf16 a[16:19], v[140:143], v[8:11], a[16:19]
    v_mfma_f32_16x16x32_bf16 a[20:23], v[124:127], v[12:15], a[20:23]
    v_mfma_f32_16x16x32_bf16 a[24:27], v[128:131], v[12:15], a[24:27]
    v_mfma_f32_16x16x32_bf16 a[28:31], v[132:135], v[12:15], a[28:31]
    v_mfma_f32_16x16x32_bf16 a[32:35], v[136:139], v[12:15], a[32:35]
    v_mfma_f32_16x16x32_bf16 a[36:39], v[140:143], v[12:15], a[36:39]
    v_mfma_f32_16x16x32_bf16 a[40:43], v[124:127], v[16:19], a[40:43]
    v_mfma_f32_16x16x32_bf16 a[44:47], v[128:131], v[16:19], a[44:47]
    v_mfma_f32_16x16x32_bf16 a[48:51], v[132:135], v[16:19], a[48:51]
    v_mfma_f32_16x16x32_bf16 a[52:55], v[136:139], v[16:19], a[52:55]
    v_mfma_f32_16x16x32_bf16 a[56:59], v[140:143], v[16:19], a[56:59]
    s_waitcnt vmcnt(0)
    v_mfma_f32_16x16x32_bf16 a[0:3], v[152:155], v[20:23], a[0:3]
    v_mfma_f32_16x16x32_bf16 a[4:7], v[156:159], v[20:23], a[4:7]
    v_mfma_f32_16x16x32_bf16 a[8:11], v[160:163], v[20:23], a[8:11]
    v_mfma_f32_16x16x32_bf16 a[12:15], v[164:167], v[20:23], a[12:15]
    v_mfma_f32_16x16x32_bf16 a[16:19], v[168:171], v[20:23], a[16:19]
    v_mfma_f32_16x16x32_bf16 a[20:23], v[152:155], v[24:27], a[20:23]
    v_mfma_f32_16x16x32_bf16 a[24:27], v[156:159], v[24:27], a[24:27]
    v_mfma_f32_16x16x32_bf16 a[28:31], v[160:163], v[24:27], a[28:31]
    v_mfma_f32_16x16x32_bf16 a[32:35], v[164:167], v[24:27], a[32:35]
    v_mfma_f32_16x16x32_bf16 a[36:39], v[168:171], v[24:27], a[36:39]
    v_mfma_f32_16x16x32_bf16 a[40:43], v[152:155], v[28:31], a[40:43]
    v_mfma_f32_16x16x32_bf16 a[44:47], v[156:159], v[28:31], a[44:47]
    v_mfma_f32_16x16x32_bf16 a[48:51], v[160:163], v[28:31], a[48:51]
    v_mfma_f32_16x16x32_bf16 a[52:55], v[164:167], v[28:31], a[52:55]
    v_mfma_f32_16x16x32_bf16 a[56:59], v[168:171], v[28:31], a[56:59]
    buffer_load_dwordx4 v[8:11], v7, s[20:23], s8 offen sc1
    buffer_load_dwordx4 v[12:15], v7, s[20:23], s9 offen sc1
    buffer_load_dwordx4 v[16:19], v7, s[20:23], s10 offen sc1
    buffer_load_dwordx4 v[20:23], v7, s[20:23], s11 offen sc1
    s_nop 3
    ds_write_b128 v151, a[0:3] offset:15360
    ds_write_b128 v151, a[4:7] offset:16384
    ds_write_b128 v151, a[8:11] offset:17408
    ds_write_b128 v151, a[12:15] offset:18432
    ds_write_b128 v151, a[16:19] offset:19456
    ds_write_b128 v151, a[20:23] offset:20480
    ds_write_b128 v151, a[24:27] offset:21504
    ds_write_b128 v151, a[28:31] offset:22528
    ds_write_b128 v151, a[32:35] offset:23552
    ds_write_b128 v151, a[36:39] offset:24576
    ds_write_b128 v151, a[40:43] offset:25600
    ds_write_b128 v151, a[44:47] offset:26624
    ds_write_b128 v151, a[48:51] offset:27648
    ds_write_b128 v151, a[52:55] offset:28672
    ds_write_b128 v151, a[56:59] offset:29696
    s_waitcnt lgkmcnt(0)
    s_barrier
    ds_read_b128 v[172:175], v7 offset:15360
    ds_read_b128 v[176:179], v7 offset:46080
    ds_read_b128 v[180:183], v4 offset:15360
    ds_read_b128 v[184:187], v4 offset:46080
    ds_read_b128 v[188:191], v7 offset:19456
    ds_read_b128 v[192:195], v7 offset:50176
    ds_read_b128 v[196:199], v4 offset:19456
    ds_read_b128 v[200:203], v4 offset:50176
    ds_read_b128 v[204:207], v7 offset:23552
    ds_read_b128 v[208:211], v7 offset:54272
    ds_read_b128 v[212:215], v4 offset:23552
    ds_read_b128 v[216:219], v4 offset:54272
    ds_read_b128 v[220:223], v7 offset:27648
    ds_read_b128 v[224:227], v7 offset:58368
    ds_read_b128 v[228:231], v4 offset:27648
    ds_read_b128 v[232:235], v4 offset:58368
    s_waitcnt lgkmcnt(12)
    v_add_f32 v172, v172, v176
    v_add_f32 v173, v173, v177
    v_add_f32 v174, v174, v178
    v_add_f32 v175, v175, v179
    v_add_f32 v180, v180, v184
    v_add_f32 v181, v181, v185
    v_add_f32 v182, v182, v186
    v_add_f32 v183, v183, v187
    v_add_f32 v172, v172, v180
    v_add_f32 v173, v173, v181
    v_add_f32 v174, v174, v182
    v_add_f32 v175, v175, v183
    s_waitcnt lgkmcnt(8)
    v_add_f32 v188, v188, v192
    v_add_f32 v189, v189, v193
    v_add_f32 v190, v190, v194
    v_add_f32 v191, v191, v195
    v_add_f32 v196, v196, v200
    v_add_f32 v197, v197, v201
    v_add_f32 v198, v198, v202
    v_add_f32 v199, v199, v203
    v_add_f32 v188, v188, v196
    v_add_f32 v189, v189, v197
    v_add_f32 v190, v190, v198
    v_add_f32 v191, v191, v199
    s_waitcnt lgkmcnt(4)
    v_add_f32 v204, v204, v208
    v_add_f32 v205, v205, v209
    v_add_f32 v206, v206, v210
    v_add_f32 v207, v207, v211
    v_add_f32 v212, v212, v216
    v_add_f32 v213, v213, v217
    v_add_f32 v214, v214, v218
    v_add_f32 v215, v215, v219
    v_add_f32 v204, v204, v212
    v_add_f32 v205, v205, v213
    v_add_f32 v206, v206, v214
    v_add_f32 v207, v207, v215
    s_waitcnt lgkmcnt(0)
    v_add_f32 v220, v220, v224
    v_add_f32 v221, v221, v225
    v_add_f32 v222, v222, v226
    v_add_f32 v223, v223, v227
    v_add_f32 v228, v228, v232
    v_add_f32 v229, v229, v233
    v_add_f32 v230, v230, v234
    v_add_f32 v231, v231, v235
    v_add_f32 v220, v220, v228
    v_add_f32 v221, v221, v229
    v_add_f32 v222, v222, v230
    v_add_f32 v223, v223, v231
    s_branch L_xchk
L_xpoll:
    buffer_load_dwordx4 v[8:11], v7, s[20:23], s8 offen sc1
    buffer_load_dwordx4 v[12:15], v7, s[20:23], s9 offen sc1
    buffer_load_dwordx4 v[16:19], v7, s[20:23], s10 offen sc1
    buffer_load_dwordx4 v[20:23], v7, s[20:23], s11 offen sc1
L_xchk:
    s_waitcnt vmcnt(0)
    v_xor_b32 v24, v8, v96
    v_xor_b32 v25, v9, v97
    v_xor_b32 v26, v10, v98
    v_xor_b32 v27, v11, v99
    v_xor_b32 v28, v12, v96
    v_xor_b32 v29, v13, v97
    v_xor_b32 v30, v14, v98
    v_xor_b32 v31, v15, v99
    v_xor_b32 v32, v16, v96
    v_xor_b32 v33, v17, v97
    v_xor_b32 v34, v18, v98
    v_xor_b32 v35, v19, v99
    v_xor_b32 v36, v20, v96
    v_xor_b32 v37, v21, v97
    v_xor_b32 v38, v22, v98
    v_xor_b32 v39, v23, v99
    v_or3_b32 v24, v24, v25, v26
    v_or_b32 v24, v24, v27
    v_or3_b32 v28, v28, v29, v30
    v_or_b32 v28, v28, v31
    v_or3_b32 v32, v32, v33, v34
    v_or_b32 v32, v32, v35
    v_or3_b32 v36, v36, v37, v38
    v_or_b32 v36, v36, v39
    v_or3_b32 v24, v24, v28, v32
    v_or_b32 v24, v24, v36
    v_and_b32 v24, 0xff, v24
    v_cmp_ne_u32 vcc, 0, v24
    s_cbranch_vccnz L_xpoll
    v_and_b32 v8, s47, v8
    v_add_f32 v172, v172, v8
    v_and_b32 v9, s47, v9
    v_add_f32 v173, v173, v9
    v_and_b32 v10, s47, v10
    v_add_f32 v174, v174, v10
    v_and_b32 v11, s47, v11
    v_add_f32 v175, v175, v11
    v_cvt_pk_bf16_f32 v172, v172, v173
    v_cvt_pk_bf16_f32 v173, v174, v175
    buffer_store_dwordx2 v[172:173], v6, s[12:15], s28 offen
    v_and_b32 v12, s47, v12
    v_add_f32 v188, v188, v12
    v_and_b32 v13, s47, v13
    v_add_f32 v189, v189, v13
    v_and_b32 v14, s47, v14
    v_add_f32 v190, v190, v14
    v_and_b32 v15, s47, v15
    v_add_f32 v191, v191, v15
    v_cvt_pk_bf16_f32 v188, v188, v189
    v_cvt_pk_bf16_f32 v189, v190, v191
    buffer_store_dwordx2 v[188:189], v6, s[12:15], s29 offen
    v_and_b32 v16, s47, v16
    v_add_f32 v204, v204, v16
    v_and_b32 v17, s47, v17
    v_add_f32 v205, v205, v17
    v_and_b32 v18, s47, v18
    v_add_f32 v206, v206, v18
    v_and_b32 v19, s47, v19
    v_add_f32 v207, v207, v19
    v_cvt_pk_bf16_f32 v204, v204, v205
    v_cvt_pk_bf16_f32 v205, v206, v207
    buffer_store_dwordx2 v[204:205], v6, s[12:15], s30 offen
    v_and_b32 v20, s47, v20
    v_add_f32 v220, v220, v20
    v_and_b32 v21, s47, v21
    v_add_f32 v221, v221, v21
    v_and_b32 v22, s47, v22
    v_add_f32 v222, v222, v22
    v_and_b32 v23, s47, v23
    v_add_f32 v223, v223, v23
    v_cvt_pk_bf16_f32 v220, v220, v221
    v_cvt_pk_bf16_f32 v221, v222, v223
    buffer_store_dwordx2 v[220:221], v6, s[12:15], s31 offen
    s_waitcnt vmcnt(0)
L_k1_end:
    s_endpgm
L_rare_p0_1_0:
    s_call_b64 s[42:43], L_rarefn_0_0
    s_branch L_back_p0_1_0
L_rare_p0_1_1:
    s_call_b64 s[42:43], L_rarefn_1_0
    s_branch L_back_p0_1_1
L_rare_p0_1_2:
    s_call_b64 s[42:43], L_rarefn_2_0
    s_branch L_back_p0_1_2
L_rare_p0_2_0:
    s_call_b64 s[42:43], L_rarefn_0_1
    s_branch L_back_p0_2_0
L_rare_l1_0_1:
    s_call_b64 s[42:43], L_rarefn_1_1
    s_branch L_back_l1_0_1
L_rare_l1_0_2:
    s_call_b64 s[42:43], L_rarefn_2_1
    s_branch L_back_l1_0_2
L_rare_l1_1_0:
    s_call_b64 s[42:43], L_rarefn_0_0
    s_branch L_back_l1_1_0
L_rare_l1_1_1:
    s_call_b64 s[42:43], L_rarefn_1_0
    s_branch L_back_l1_1_1
L_rare_l1_1_2:
    s_call_b64 s[42:43], L_rarefn_2_0
    s_branch L_back_l1_1_2
L_rare_l1_2_0:
    s_call_b64 s[42:43], L_rarefn_0_1
    s_branch L_back_l1_2_0
L_rare_l2_0_1:
    s_call_b64 s[42:43], L_rarefn_1_1
    s_branch L_back_l2_0_1
L_rare_l2_0_2:
    s_call_b64 s[42:43], L_rarefn_2_1
    s_branch L_back_l2_0_2
L_rare_l2_1_0:
    s_call_b64 s[42:43], L_rarefn_0_0
    s_branch L_back_l2_1_0
L_rare_l2_1_1:
    s_call_b64 s[42:43], L_rarefn_1_0
    s_branch L_back_l2_1_1
L_rare_l2_1_2:
    s_call_b64 s[42:43], L_rarefn_2_0
    s_branch L_back_l2_1_2
L_rare_l2_2_0:
    s_call_b64 s[42:43], L_rarefn_0_1
    s_branch L_back_l2_2_0
L_rare_l3_0_1:
    s_call_b64 s[42:43], L_rarefn_1_1
    s_branch L_back_l3_0_1
L_rare_l3_0_2:
    s_call_b64 s[42:43], L_rarefn_2_1
    s_branch L_back_l3_0_2
L_rare_l3_1_0:
    s_call_b64 s[42:43], L_rarefn_0_0
    s_branch L_back_l3_1_0
L_rare_l3_1_1:
    s_call_b64 s[42:43], L_rarefn_1_0
    s_branch L_back_l3_1_1
L_rare_l3_1_2:
    s_call_b64 s[42:43], L_rarefn_2_0
    s_branch L_back_l3_1_2
L_rare_l3_2_0:
    s_call_b64 s[42:43], L_rarefn_0_1
    s_branch L_back_l3_2_0
L_rare_l4_0_1:
    s_call_b64 s[42:43], L_rarefn_1_1
    s_branch L_back_l4_0_1
L_rare_l4_0_2:
    s_call_b64 s[42:43], L_rarefn_2_1
    s_branch L_back_l4_0_2
L_rare_l4_1_0:
    s_call_b64 s[42:43], L_rarefn_0_0
    s_branch L_back_l4_1_0
L_rare_l4_1_1:
    s_call_b64 s[42:43], L_rarefn_1_0
    s_branch L_back_l4_1_1
L_rare_l4_1_2:
    s_call_b64 s[42:43], L_rarefn_2_0
    s_branch L_back_l4_1_2
L_rare_l4_2_0:
    s_call_b64 s[42:43], L_rarefn_0_1
    s_branch L_back_l4_2_0
L_rare_t29_0_1:
    s_call_b64 s[42:43], L_rarefn_1_1
    s_branch L_back_t29_0_1
L_rare_t29_0_2:
    s_call_b64 s[42:43], L_rarefn_2_1
    s_branch L_back_t29_0_2
L_rare_t29_1_0:
    s_call_b64 s[42:43], L_rarefn_0_0
    s_branch L_back_t29_1_0
L_rare_t29_1_1:
    s_call_b64 s[42:43], L_rarefn_1_0
    s_branch L_back_t29_1_1
L_rare_t29_1_2:
    s_call_b64 s[42:43], L_rarefn_2_0
    s_branch L_back_t29_1_2
L_rare_t29_2_0:
    s_call_b64 s[42:43], L_rarefn_0_1
    s_branch L_back_t29_2_0
L_rare_t30_0_1:
    s_call_b64 s[42:43], L_rarefn_1_1
    s_branch L_back_t30_0_1
L_rare_t30_0_2:
    s_call_b64 s[42:43], L_rarefn_2_1
    s_branch L_back_t30_0_2
L_rare_t30_1_0:
    s_call_b64 s[42:43], L_rarefn_0_0
    s_branch L_back_t30_1_0
L_rare_t30_1_1:
    s_call_b64 s[42:43], L_rarefn_1_0
    s_branch L_back_t30_1_1
L_rare_t30_1_2:
    s_call_b64 s[42:43], L_rarefn_2_0
    s_branch L_back_t30_1_2
L_rare_t30_2_0:
    s_call_b64 s[42:43], L_rarefn_0_1
    s_branch L_back_t30_2_0
L_rare_t31_0_1:
    s_call_b64 s[42:43], L_rarefn_1_1
    s_branch L_back_t31_0_1
L_rare_t31_0_2:
    s_call_b64 s[42:43], L_rarefn_2_1
    s_branch L_back_t31_0_2
L_rare_t31_1_0:
    s_call_b64 s[42:43], L_rarefn_0_0
    s_branch L_back_t31_1_0
L_rare_t31_1_1:
    s_call_b64 s[42:43], L_rarefn_1_0
    s_branch L_back_t31_1_1
L_rare_t31_1_2:
    s_call_b64 s[42:43], L_rarefn_2_0
    s_branch L_back_t31_1_2
L_rare_t31_2_0:
    s_call_b64 s[42:43], L_rarefn_0_1
    s_branch L_back_t31_2_0
L_rare_d_1:
    s_call_b64 s[42:43], L_rarefn_1_1
    s_branch L_back_d_1
L_rare_d_2:
    s_call_b64 s[42:43], L_rarefn_2_1
    s_branch L_back_d_2
L_rarefn_0_0:
    s_nop 15
    v_max3_f32 v166, v20, v21, v22
    v_max3_f32 v166, v166, v23, v24
    v_max3_f32 v166, v166, v25, v26
    v_max_f32 v166, v166, v27
    v_mov_b32 v167, v166
    s_nop 1
    v_permlane32_swap_b32 v166, v167
    v_max_f32 v166, v166, v167
    v_mov_b32 v167, v166
    s_nop 1
    v_permlane16_swap_b32 v166, v167
    v_max3_f32 v166, v166, v167, 0
    v_exp_f32 v167, -v166
    s_nop 0
    v_mul_f32 v155, v152, v167
    v_sub_f32 v8, v8, v166
    v_sub_f32 v9, v9, v166
    v_sub_f32 v10, v10, v166
    v_sub_f32 v11, v11, v166
    v_accvgpr_read_b32 v168, a0
    v_accvgpr_read_b32 v169, a1
    v_accvgpr_read_b32 v170, a2
    v_accvgpr_read_b32 v171, a3
    v_mul_f32 v168, v168, v167
    v_mul_f32 v169, v169, v167
    v_mul_f32 v170, v170, v167
    v_mul_f32 v171, v171, v167
    v_accvgpr_write_b32 a0, v168
    v_accvgpr_write_b32 a1, v169
    v_accvgpr_write_b32 a2, v170
    v_accvgpr_write_b32 a3, v171
    v_accvgpr_read_b32 v168, a4
    v_accvgpr_read_b32 v169, a5
    v_accvgpr_read_b32 v170, a6
    v_accvgpr_read_b32 v171, a7
    v_mul_f32 v168, v168, v167
    v_mul_f32 v169, v169, v167
    v_mul_f32 v170, v170, v167
    v_mul_f32 v171, v171, v167
    v_accvgpr_write_b32 a4, v168
    v_accvgpr_write_b32 a5, v169
    v_accvgpr_write_b32 a6, v170
    v_accvgpr_write_b32 a7, v171
    v_accvgpr_read_b32 v168, a8
    v_accvgpr_read_b32 v169, a9
    v_accvgpr_read_b32 v170, a10
    v_accvgpr_read_b32 v171, a11
    v_mul_f32 v168, v168, v167
    v_mul_f32 v169, v169, v167
    v_mul_f32 v170, v170, v167
    v_mul_f32 v171, v171, v167
    v_accvgpr_write_b32 a8, v168
    v_accvgpr_write_b32 a9, v169
    v_accvgpr_write_b32 a10, v170
    v_accvgpr_write_b32 a11, v171
    v_accvgpr_read_b32 v168, a12
    v_accvgpr_read_b32 v169, a13
    v_accvgpr_read_b32 v170, a14
    v_accvgpr_read_b32 v171, a15
    v_mul_f32 v168, v168, v167
    v_mul_f32 v169, v169, v167
    v_mul_f32 v170, v170, v167
    v_mul_f32 v171, v171, v167
    v_accvgpr_write_b32 a12, v168
    v_accvgpr_write_b32 a13, v169
    v_accvgpr_write_b32 a14, v170
    v_accvgpr_write_b32 a15, v171
    v_accvgpr_read_b32 v168, a16
    v_accvgpr_read_b32 v169, a17
    v_accvgpr_read_b32 v170, a18
    v_accvgpr_read_b32 v171, a19
    v_mul_f32 v168, v168, v167
    v_mul_f32 v169, v169, v167
    v_mul_f32 v170, v170, v167
    v_mul_f32 v171, v171, v167
    v_accvgpr_write_b32 a16, v168
    v_accvgpr_write_b32 a17, v169
    v_accvgpr_write_b32 a18, v170
    v_accvgpr_write_b32 a19, v171
    v_accvgpr_read_b32 v168, a20
    v_accvgpr_read_b32 v169, a21
    v_accvgpr_read_b32 v170, a22
    v_accvgpr_read_b32 v171, a23
    v_mul_f32 v168, v168, v167
    v_mul_f32 v169, v169, v167
    v_mul_f32 v170, v170, v167
    v_mul_f32 v171, v171, v167
    v_accvgpr_write_b32 a20, v168
    v_accvgpr_write_b32 a21, v169
    v_accvgpr_write_b32 a22, v170
    v_accvgpr_write_b32 a23, v171
    v_accvgpr_read_b32 v168, a24
    v_accvgpr_read_b32 v169, a25
    v_accvgpr_read_b32 v170, a26
    v_accvgpr_read_b32 v171, a27
    v_mul_f32 v168, v168, v167
    v_mul_f32 v169, v169, v167
    v_mul_f32 v170, v170, v167
    v_mul_f32 v171, v171, v167
    v_accvgpr_write_b32 a24, v168
    v_accvgpr_write_b32 a25, v169
    v_accvgpr_write_b32 a26, v170
    v_accvgpr_write_b32 a27, v171
    v_accvgpr_read_b32 v168, a28
    v_accvgpr_read_b32 v169, a29
    v_accvgpr_read_b32 v170, a30
    v_accvgpr_read_b32 v171, a31
    v_mul_f32 v168, v168, v167
    v_mul_f32 v169, v169, v167
    v_mul_f32 v170, v170, v167
    v_mul_f32 v171, v171, v167
    v_accvgpr_write_b32 a28, v168
    v_accvgpr_write_b32 a29, v169
    v_accvgpr_write_b32 a30, v170
    v_accvgpr_write_b32 a31, v171
    v_sub_f32 v168, v20, v166
    v_sub_f32 v169, v21, v166
    v_exp_f32 v168, v168
    v_exp_f32 v169, v169
    s_nop 0
    v_add_f32 v155, v155, v168
    v_add_f32 v155, v155, v169
    v_cvt_pk_bf16_f32 v44, v168, v169
    v_sub_f32 v168, v22, v166
    v_sub_f32 v169, v23, v166
    v_exp_f32 v168, v168
    v_exp_f32 v169, v169
    s_nop 0
    v_add_f32 v155, v155, v168
    v_add_f32 v155, v155, v169
    v_cvt_pk_bf16_f32 v45, v168, v169
    v_sub_f32 v168, v24, v166
    v_sub_f32 v169, v25, v166
    v_exp_f32 v168, v168
    v_exp_f32 v169, v169
    s_nop 0
    v_add_f32 v155, v155, v168
    v_add_f32 v155, v155, v169
    v_cvt_pk_bf16_f32 v46, v168, v169
    v_sub_f32 v168, v26, v166
    v_sub_f32 v169, v27, v166
    v_exp_f32 v168, v168
    v_exp_f32 v169, v169
    s_nop 0
    v_add_f32 v155, v155, v168
    v_add_f32 v155, v155, v169
    v_cvt_pk_bf16_f32 v47, v168, v169
    s_nop 3
    s_setpc_b64 s[42:43]
L_rarefn_0_1:
    s_nop 15
    v_max3_f32 v166, v20, v21, v22
    v_max3_f32 v166, v166, v23, v24
    v_max3_f32 v166, v166, v25, v26
    v_max_f32 v166, v166, v27
    v_mov_b32 v167, v166
    s_nop 1
    v_permlane32_swap_b32 v166, v167
    v_max_f32 v166, v166, v167
    v_mov_b32 v167, v166
    s_nop 1
    v_permlane16_swap_b32 v166, v167
    v_max3_f32 v166, v166, v167, 0
    v_exp_f32 v167, -v166
    s_nop 0
    v_mul_f32 v152, v155, v167
    v_sub_f32 v8, v8, v166
    v_sub_f32 v9, v9, v166
    v_sub_f32 v10, v10, v166
    v_sub_f32 v11, v11, v166
    v_accvgpr_read_b32 v168, a0
    v_accvgpr_read_b32 v169, a1
    v_accvgpr_read_b32 v170, a2
    v_accvgpr_read_b32 v171, a3
    v_mul_f32 v168, v168, v167
    v_mul_f32 v169, v169, v167
    v_mul_f32 v170, v170, v167
    v_mul_f32 v171, v171, v167
    v_accvgpr_write_b32 a0, v168
    v_accvgpr_write_b32 a1, v169
    v_accvgpr_write_b32 a2, v170
    v_accvgpr_write_b32 a3, v171
    v_accvgpr_read_b32 v168, a4
    v_accvgpr_read_b32 v169, a5
    v_accvgpr_read_b32 v170, a6
    v_accvgpr_read_b32 v171, a7
    v_mul_f32 v168, v168, v167
    v_mul_f32 v169, v169, v167
    v_mul_f32 v170, v170, v167
    v_mul_f32 v171, v171, v167
    v_accvgpr_write_b32 a4, v168
    v_accvgpr_write_b32 a5, v169
    v_accvgpr_write_b32 a6, v170
    v_accvgpr_write_b32 a7, v171
    v_accvgpr_read_b32 v168, a8
    v_accvgpr_read_b32 v169, a9
    v_accvgpr_read_b32 v170, a10
    v_accvgpr_read_b32 v171, a11
    v_mul_f32 v168, v168, v167
    v_mul_f32 v169, v169, v167
    v_mul_f32 v170, v170, v167
    v_mul_f32 v171, v171, v167
    v_accvgpr_write_b32 a8, v168
    v_accvgpr_write_b32 a9, v169
    v_accvgpr_write_b32 a10, v170
    v_accvgpr_write_b32 a11, v171
    v_accvgpr_read_b32 v168, a12
    v_accvgpr_read_b32 v169, a13
    v_accvgpr_read_b32 v170, a14
    v_accvgpr_read_b32 v171, a15
    v_mul_f32 v168, v168, v167
    v_mul_f32 v169, v169, v167
    v_mul_f32 v170, v170, v167
    v_mul_f32 v171, v171, v167
    v_accvgpr_write_b32 a12, v168
    v_accvgpr_write_b32 a13, v169
    v_accvgpr_write_b32 a14, v170
    v_accvgpr_write_b32 a15, v171
    v_accvgpr_read_b32 v168, a16
    v_accvgpr_read_b32 v169, a17
    v_accvgpr_read_b32 v170, a18
    v_accvgpr_read_b32 v171, a19
    v_mul_f32 v168, v168, v167
    v_mul_f32 v169, v169, v167
    v_mul_f32 v170, v170, v167
    v_mul_f32 v171, v171, v167
    v_accvgpr_write_b32 a16, v168
    v_accvgpr_write_b32 a17, v169
    v_accvgpr_write_b32 a18, v170
    v_accvgpr_write_b32 a19, v171
    v_accvgpr_read_b32 v168, a20
    v_accvgpr_read_b32 v169, a21
    v_accvgpr_read_b32 v170, a22
    v_accvgpr_read_b32 v171, a23
    v_mul_f32 v168, v168, v167
    v_mul_f32 v169, v169, v167
    v_mul_f32 v170, v170, v167
    v_mul_f32 v171, v171, v167
    v_accvgpr_write_b32 a20, v168
    v_accvgpr_write_b32 a21, v169
    v_accvgpr_write_b32 a22, v170
    v_accvgpr_write_b32 a23, v171
    v_accvgpr_read_b32 v168, a24
    v_accvgpr_read_b32 v169, a25
    v_accvgpr_read_b32 v170, a26
    v_accvgpr_read_b32 v171, a27
    v_mul_f32 v168, v168, v167
    v_mul_f32 v169, v169, v167
    v_mul_f32 v170, v170, v167
    v_mul_f32 v171, v171, v167
    v_accvgpr_write_b32 a24, v168
    v_accvgpr_write_b32 a25, v169
    v_accvgpr_write_b32 a26, v170
    v_accvgpr_write_b32 a27, v171
    v_accvgpr_read_b32 v168, a28
    v_accvgpr_read_b32 v169, a29
    v_accvgpr_read_b32 v170, a30
    v_accvgpr_read_b32 v171, a31
    v_mul_f32 v168, v168, v167
    v_mul_f32 v169, v169, v167
    v_mul_f32 v170, v170, v167
    v_mul_f32 v171, v171, v167
    v_accvgpr_write_b32 a28, v168
    v_accvgpr_write_b32 a29, v169
    v_accvgpr_write_b32 a30, v170
    v_accvgpr_write_b32 a31, v171
    v_sub_f32 v168, v20, v166
    v_sub_f32 v169, v21, v166
    v_exp_f32 v168, v168
    v_exp_f32 v169, v169
    s_nop 0
    v_add_f32 v152, v152, v168
    v_add_f32 v152, v152, v169
    v_cvt_pk_bf16_f32 v44, v168, v169
    v_sub_f32 v168, v22, v166
    v_sub_f32 v169, v23, v166
    v_exp_f32 v168, v168
    v_exp_f32 v169, v169
    s_nop 0
    v_add_f32 v152, v152, v168
    v_add_f32 v152, v152, v169
    v_cvt_pk_bf16_f32 v45, v168, v169
    v_sub_f32 v168, v24, v166
    v_sub_f32 v169, v25, v166
    v_exp_f32 v168, v168
    v_exp_f32 v169, v169
    s_nop 0
    v_add_f32 v152, v152, v168
    v_add_f32 v152, v152, v169
    v_cvt_pk_bf16_f32 v46, v168, v169
    v_sub_f32 v168, v26, v166
    v_sub_f32 v169, v27, v166
    v_exp_f32 v168, v168
    v_exp_f32 v169, v169
    s_nop 0
    v_add_f32 v152, v152, v168
    v_add_f32 v152, v152, v169
    v_cvt_pk_bf16_f32 v47, v168, v169
    s_nop 3
    s_setpc_b64 s[42:43]
L_rarefn_1_0:
    s_nop 15
    v_max3_f32 v166, v28, v29, v30
    v_max3_f32 v166, v166, v31, v32
    v_max3_f32 v166, v166, v33, v34
    v_max_f32 v166, v166, v35
    v_mov_b32 v167, v166
    s_nop 1
    v_permlane32_swap_b32 v166, v167
    v_max_f32 v166, v166, v167
    v_mov_b32 v167, v166
    s_nop 1
    v_permlane16_swap_b32 v166, v167
    v_max3_f32 v166, v166, v167, 0
    v_exp_f32 v167, -v166
    s_nop 0
    v_mul_f32 v156, v153, v167
    v_sub_f32 v12, v12, v166
    v_sub_f32 v13, v13, v166
    v_sub_f32 v14, v14, v166
    v_sub_f32 v15, v15, v166
    v_accvgpr_read_b32 v168, a32
    v_accvgpr_read_b32 v169, a33
    v_accvgpr_read_b32 v170, a34
    v_accvgpr_read_b32 v171, a35
    v_mul_f32 v168, v168, v167
    v_mul_f32 v169, v169, v167
    v_mul_f32 v170, v170, v167
    v_mul_f32 v171, v171, v167
    v_accvgpr_write_b32 a32, v168
    v_accvgpr_write_b32 a33, v169
    v_accvgpr_write_b32 a34, v170
    v_accvgpr_write_b32 a35, v171
    v_accvgpr_read_b32 v168, a36
    v_accvgpr_read_b32 v169, a37
    v_accvgpr_read_b32 v170, a38
    v_accvgpr_read_b32 v171, a39
    v_mul_f32 v168, v168, v167
    v_mul_f32 v169, v169, v167
    v_mul_f32 v170, v170, v167
    v_mul_f32 v171, v171, v167
    v_accvgpr_write_b32 a36, v168
    v_accvgpr_write_b32 a37, v169
    v_accvgpr_write_b32 a38, v170
    v_accvgpr_write_b32 a39, v171
    v_accvgpr_read_b32 v168, a40
    v_accvgpr_read_b32 v169, a41
    v_accvgpr_read_b32 v170, a42
    v_accvgpr_read_b32 v171, a43
    v_mul_f32 v168, v168, v167
    v_mul_f32 v169, v169, v167
    v_mul_f32 v170, v170, v167
    v_mul_f32 v171, v171, v167
    v_accvgpr_write_b32 a40, v168
    v_accvgpr_write_b32 a41, v169
    v_accvgpr_write_b32 a42, v170
    v_accvgpr_write_b32 a43, v171
    v_accvgpr_read_b32 v168, a44
    v_accvgpr_read_b32 v169, a45
    v_accvgpr_read_b32 v170, a46
    v_accvgpr_read_b32 v171, a47
    v_mul_f32 v168, v168, v167
    v_mul_f32 v169, v169, v167
    v_mul_f32 v170, v170, v167
    v_mul_f32 v171, v171, v167
    v_accvgpr_write_b32 a44, v168
    v_accvgpr_write_b32 a45, v169
    v_accvgpr_write_b32 a46, v170
    v_accvgpr_write_b32 a47, v171
    v_accvgpr_read_b32 v168, a48
    v_accvgpr_read_b32 v169, a49
    v_accvgpr_read_b32 v170, a50
    v_accvgpr_read_b32 v171, a51
    v_mul_f32 v168, v168, v167
    v_mul_f32 v169, v169, v167
    v_mul_f32 v170, v170, v167
    v_mul_f32 v171, v171, v167
    v_accvgpr_write_b32 a48, v168
    v_accvgpr_write_b32 a49, v169
    v_accvgpr_write_b32 a50, v170
    v_accvgpr_write_b32 a51, v171
    v_accvgpr_read_b32 v168, a52
    v_accvgpr_read_b32 v169, a53
    v_accvgpr_read_b32 v170, a54
    v_accvgpr_read_b32 v171, a55
    v_mul_f32 v168, v168, v167
    v_mul_f32 v169, v169, v167
    v_mul_f32 v170, v170, v167
    v_mul_f32 v171, v171, v167
    v_accvgpr_write_b32 a52, v168
    v_accvgpr_write_b32 a53, v169
    v_accvgpr_write_b32 a54, v170
    v_accvgpr_write_b32 a55, v171
    v_accvgpr_read_b32 v168, a56
    v_accvgpr_read_b32 v169, a57
    v_accvgpr_read_b32 v170, a58
    v_accvgpr_read_b32 v171, a59
    v_mul_f32 v168, v168, v167
    v_mul_f32 v169, v169, v167
    v_mul_f32 v170, v170, v167
    v_mul_f32 v171, v171, v167
    v_accvgpr_write_b32 a56, v168
    v_accvgpr_write_b32 a57, v169
    v_accvgpr_write_b32 a58, v170
    v_accvgpr_write_b32 a59, v171
    v_accvgpr_read_b32 v168, a60
    v_accvgpr_read_b32 v169, a61
    v_accvgpr_read_b32 v170, a62
    v_accvgpr_read_b32 v171, a63
    v_mul_f32 v168, v168, v167
    v_mul_f32 v169, v169, v167
    v_mul_f32 v170, v170, v167
    v_mul_f32 v171, v171, v167
    v_accvgpr_write_b32 a60, v168
    v_accvgpr_write_b32 a61, v169
    v_accvgpr_write_b32 a62, v170
    v_accvgpr_write_b32 a63, v171
    v_sub_f32 v168, v28, v166
    v_sub_f32 v169, v29, v166
    v_exp_f32 v168, v168
    v_exp_f32 v169, v169
    s_nop 0
    v_add_f32 v156, v156, v168
    v_add_f32 v156, v156, v169
    v_cvt_pk_bf16_f32 v48, v168, v169
    v_sub_f32 v168, v30, v166
    v_sub_f32 v169, v31, v166
    v_exp_f32 v168, v168
    v_exp_f32 v169, v169
    s_nop 0
    v_add_f32 v156, v156, v168
    v_add_f32 v156, v156, v169
    v_cvt_pk_bf16_f32 v49, v168, v169
    v_sub_f32 v168, v32, v166
    v_sub_f32 v169, v33, v166
    v_exp_f32 v168, v168
    v_exp_f32 v169, v169
    s_nop 0
    v_add_f32 v156, v156, v168
    v_add_f32 v156, v156, v169
    v_cvt_pk_bf16_f32 v50, v168, v169
    v_sub_f32 v168, v34, v166
    v_sub_f32 v169, v35, v166
    v_exp_f32 v168, v168
    v_exp_f32 v169, v169
    s_nop 0
    v_add_f32 v156, v156, v168
    v_add_f32 v156, v156, v169
    v_cvt_pk_bf16_f32 v51, v168, v169
    s_nop 3
    s_setpc_b64 s[42:43]
L_rarefn_1_1:
    s_nop 15
    v_max3_f32 v166, v28, v29, v30
    v_max3_f32 v166, v166, v31, v32
    v_max3_f32 v166, v166, v33, v34
    v_max_f32 v166, v166, v35
    v_mov_b32 v167, v166
    s_nop 1
    v_permlane32_swap_b32 v166, v167
    v_max_f32 v166, v166, v167
    v_mov_b32 v167, v166
    s_nop 1
    v_permlane16_swap_b32 v166, v167
    v_max3_f32 v166, v166, v167, 0
    v_exp_f32 v167, -v166
    s_nop 0
    v_mul_f32 v153, v156, v167
    v_sub_f32 v12, v12, v166
    v_sub_f32 v13, v13, v166
    v_sub_f32 v14, v14, v166
    v_sub_f32 v15, v15, v166
    v_accvgpr_read_b32 v168, a32
    v_accvgpr_read_b32 v169, a33
    v_accvgpr_read_b32 v170, a34
    v_accvgpr_read_b32 v171, a35
    v_mul_f32 v168, v168, v167
    v_mul_f32 v169, v169, v167
    v_mul_f32 v170, v170, v167
    v_mul_f32 v171, v171, v167
    v_accvgpr_write_b32 a32, v168
    v_accvgpr_write_b32 a33, v169
    v_accvgpr_write_b32 a34, v170
    v_accvgpr_write_b32 a35, v171
    v_accvgpr_read_b32 v168, a36
    v_accvgpr_read_b32 v169, a37
    v_accvgpr_read_b32 v170, a38
    v_accvgpr_read_b32 v171, a39
    v_mul_f32 v168, v168, v167
    v_mul_f32 v169, v169, v167
    v_mul_f32 v170, v170, v167
    v_mul_f32 v171, v171, v167
    v_accvgpr_write_b32 a36, v168
    v_accvgpr_write_b32 a37, v169
    v_accvgpr_write_b32 a38, v170
    v_accvgpr_write_b32 a39, v171
    v_accvgpr_read_b32 v168, a40
    v_accvgpr_read_b32 v169, a41
    v_accvgpr_read_b32 v170, a42
    v_accvgpr_read_b32 v171, a43
    v_mul_f32 v168, v168, v167
    v_mul_f32 v169, v169, v167
    v_mul_f32 v170, v170, v167
    v_mul_f32 v171, v171, v167
    v_accvgpr_write_b32 a40, v168
    v_accvgpr_write_b32 a41, v169
    v_accvgpr_write_b32 a42, v170
    v_accvgpr_write_b32 a43, v171
    v_accvgpr_read_b32 v168, a44
    v_accvgpr_read_b32 v169, a45
    v_accvgpr_read_b32 v170, a46
    v_accvgpr_read_b32 v171, a47
    v_mul_f32 v168, v168, v167
    v_mul_f32 v169, v169, v167
    v_mul_f32 v170, v170, v167
    v_mul_f32 v171, v171, v167
    v_accvgpr_write_b32 a44, v168
    v_accvgpr_write_b32 a45, v169
    v_accvgpr_write_b32 a46, v170
    v_accvgpr_write_b32 a47, v171
    v_accvgpr_read_b32 v168, a48
    v_accvgpr_read_b32 v169, a49
    v_accvgpr_read_b32 v170, a50
    v_accvgpr_read_b32 v171, a51
    v_mul_f32 v168, v168, v167
    v_mul_f32 v169, v169, v167
    v_mul_f32 v170, v170, v167
    v_mul_f32 v171, v171, v167
    v_accvgpr_write_b32 a48, v168
    v_accvgpr_write_b32 a49, v169
    v_accvgpr_write_b32 a50, v170
    v_accvgpr_write_b32 a51, v171
    v_accvgpr_read_b32 v168, a52
    v_accvgpr_read_b32 v169, a53
    v_accvgpr_read_b32 v170, a54
    v_accvgpr_read_b32 v171, a55
    v_mul_f32 v168, v168, v167
    v_mul_f32 v169, v169, v167
    v_mul_f32 v170, v170, v167
    v_mul_f32 v171, v171, v167
    v_accvgpr_write_b32 a52, v168
    v_accvgpr_write_b32 a53, v169
    v_accvgpr_write_b32 a54, v170
    v_accvgpr_write_b32 a55, v171
    v_accvgpr_read_b32 v168, a56
    v_accvgpr_read_b32 v169, a57
    v_accvgpr_read_b32 v170, a58
    v_accvgpr_read_b32 v171, a59
    v_mul_f32 v168, v168, v167
    v_mul_f32 v169, v169, v167
    v_mul_f32 v170, v170, v167
    v_mul_f32 v171, v171, v167
    v_accvgpr_write_b32 a56, v168
    v_accvgpr_write_b32 a57, v169
    v_accvgpr_write_b32 a58, v170
    v_accvgpr_write_b32 a59, v171
    v_accvgpr_read_b32 v168, a60
    v_accvgpr_read_b32 v169, a61
    v_accvgpr_read_b32 v170, a62
    v_accvgpr_read_b32 v171, a63
    v_mul_f32 v168, v168, v167
    v_mul_f32 v169, v169, v167
    v_mul_f32 v170, v170, v167
    v_mul_f32 v171, v171, v167
    v_accvgpr_write_b32 a60, v168
    v_accvgpr_write_b32 a61, v169
    v_accvgpr_write_b32 a62, v170
    v_accvgpr_write_b32 a63, v171
    v_sub_f32 v168, v28, v166
    v_sub_f32 v169, v29, v166
    v_exp_f32 v168, v168
    v_exp_f32 v169, v169
    s_nop 0
    v_add_f32 v153, v153, v168
    v_add_f32 v153, v153, v169
    v_cvt_pk_bf16_f32 v48, v168, v169
    v_sub_f32 v168, v30, v166
    v_sub_f32 v169, v31, v166
    v_exp_f32 v168, v168
    v_exp_f32 v169, v169
    s_nop 0
    v_add_f32 v153, v153, v168
    v_add_f32 v153, v153, v169
    v_cvt_pk_bf16_f32 v49, v168, v169
    v_sub_f32 v168, v32, v166
    v_sub_f32 v169, v33, v166
    v_exp_f32 v168, v168
    v_exp_f32 v169, v169
    s_nop 0
    v_add_f32 v153, v153, v168
    v_add_f32 v153, v153, v169
    v_cvt_pk_bf16_f32 v50, v168, v169
    v_sub_f32 v168, v34, v166
    v_sub_f32 v169, v35, v166
    v_exp_f32 v168, v168
    v_exp_f32 v169, v169
    s_nop 0
    v_add_f32 v153, v153, v168
    v_add_f32 v153, v153, v169
    v_cvt_pk_bf16_f32 v51, v168, v169
    s_nop 3
    s_setpc_b64 s[42:43]
L_rarefn_2_0:
    s_nop 15
    v_max3_f32 v166, v36, v37, v38
    v_max3_f32 v166, v166, v39, v40
    v_max3_f32 v166, v166, v41, v42
    v_max_f32 v166, v166, v43
    v_mov_b32 v167, v166
    s_nop 1
    v_permlane32_swap_b32 v166, v167
    v_max_f32 v166, v166, v167
    v_mov_b32 v167, v166
    s_nop 1
    v_permlane16_swap_b32 v166, v167
    v_max3_f32 v166, v166, v167, 0
    v_exp_f32 v167, -v166
    s_nop 0
    v_mul_f32 v157, v154, v167
    v_sub_f32 v16, v16, v166
    v_sub_f32 v17, v17, v166
    v_sub_f32 v18, v18, v166
    v_sub_f32 v19, v19, v166
    v_accvgpr_read_b32 v168, a64
    v_accvgpr_read_b32 v169, a65
    v_accvgpr_read_b32 v170, a66
    v_accvgpr_read_b32 v171, a67
    v_mul_f32 v168, v168, v167
    v_mul_f32 v169, v169, v167
    v_mul_f32 v170, v170, v167
    v_mul_f32 v171, v171, v167
    v_accvgpr_write_b32 a64, v168
    v_accvgpr_write_b32 a65, v169
    v_accvgpr_write_b32 a66, v170
    v_accvgpr_write_b32 a67, v171
    v_accvgpr_read_b32 v168, a68
    v_accvgpr_read_b32 v169, a69
    v_accvgpr_read_b32 v170, a70
    v_accvgpr_read_b32 v171, a71
    v_mul_f32 v168, v168, v167
    v_mul_f32 v169, v169, v167
    v_mul_f32 v170, v170, v167
    v_mul_f32 v171, v171, v167
    v_accvgpr_write_b32 a68, v168
    v_accvgpr_write_b32 a69, v169
    v_accvgpr_write_b32 a70, v170
    v_accvgpr_write_b32 a71, v171
    v_accvgpr_read_b32 v168, a72
    v_accvgpr_read_b32 v169, a73
    v_accvgpr_read_b32 v170, a74
    v_accvgpr_read_b32 v171, a75
    v_mul_f32 v168, v168, v167
    v_mul_f32 v169, v169, v167
    v_mul_f32 v170, v170, v167
    v_mul_f32 v171, v171, v167
    v_accvgpr_write_b32 a72, v168
    v_accvgpr_write_b32 a73, v169
    v_accvgpr_write_b32 a74, v170
    v_accvgpr_write_b32 a75, v171
    v_accvgpr_read_b32 v168, a76
    v_accvgpr_read_b32 v169, a77
    v_accvgpr_read_b32 v170, a78
    v_accvgpr_read_b32 v171, a79
    v_mul_f32 v168, v168, v167
    v_mul_f32 v169, v169, v167
    v_mul_f32 v170, v170, v167
    v_mul_f32 v171, v171, v167
    v_accvgpr_write_b32 a76, v168
    v_accvgpr_write_b32 a77, v169
    v_accvgpr_write_b32 a78, v170
    v_accvgpr_write_b32 a79, v171
    v_accvgpr_read_b32 v168, a80
    v_accvgpr_read_b32 v169, a81
    v_accvgpr_read_b32 v170, a82
    v_accvgpr_read_b32 v171, a83
    v_mul_f32 v168, v168, v167
    v_mul_f32 v169, v169, v167
    v_mul_f32 v170, v170, v167
    v_mul_f32 v171, v171, v167
    v_accvgpr_write_b32 a80, v168
    v_accvgpr_write_b32 a81, v169
    v_accvgpr_write_b32 a82, v170
    v_accvgpr_write_b32 a83, v171
    v_accvgpr_read_b32 v168, a84
    v_accvgpr_read_b32 v169, a85
    v_accvgpr_read_b32 v170, a86
    v_accvgpr_read_b32 v171, a87
    v_mul_f32 v168, v168, v167
    v_mul_f32 v169, v169, v167
    v_mul_f32 v170, v170, v167
    v_mul_f32 v171, v171, v167
    v_accvgpr_write_b32 a84, v168
    v_accvgpr_write_b32 a85, v169
    v_accvgpr_write_b32 a86, v170
    v_accvgpr_write_b32 a87, v171
    v_accvgpr_read_b32 v168, a88
    v_accvgpr_read_b32 v169, a89
    v_accvgpr_read_b32 v170, a90
    v_accvgpr_read_b32 v171, a91
    v_mul_f32 v168, v168, v167
    v_mul_f32 v169, v169, v167
    v_mul_f32 v170, v170, v167
    v_mul_f32 v171, v171, v167
    v_accvgpr_write_b32 a88, v168
    v_accvgpr_write_b32 a89, v169
    v_accvgpr_write_b32 a90, v170
    v_accvgpr_write_b32 a91, v171
    v_accvgpr_read_b32 v168, a92
    v_accvgpr_read_b32 v169, a93
    v_accvgpr_read_b32 v170, a94
    v_accvgpr_read_b32 v171, a95
    v_mul_f32 v168, v168, v167
    v_mul_f32 v169, v169, v167
    v_mul_f32 v170, v170, v167
    v_mul_f32 v171, v171, v167
    v_accvgpr_write_b32 a92, v168
    v_accvgpr_write_b32 a93, v169
    v_accvgpr_write_b32 a94, v170
    v_accvgpr_write_b32 a95, v171
    v_sub_f32 v168, v36, v166
    v_sub_f32 v169, v37, v166
    v_exp_f32 v168, v168
    v_exp_f32 v169, v169
    s_nop 0
    v_add_f32 v157, v157, v168
    v_add_f32 v157, v157, v169
    v_cvt_pk_bf16_f32 v52, v168, v169
    v_sub_f32 v168, v38, v166
    v_sub_f32 v169, v39, v166
    v_exp_f32 v168, v168
    v_exp_f32 v169, v169
    s_nop 0
    v_add_f32 v157, v157, v168
    v_add_f32 v157, v157, v169
    v_cvt_pk_bf16_f32 v53, v168, v169
    v_sub_f32 v168, v40, v166
    v_sub_f32 v169, v41, v166
    v_exp_f32 v168, v168
    v_exp_f32 v169, v169
    s_nop 0
    v_add_f32 v157, v157, v168
    v_add_f32 v157, v157, v169
    v_cvt_pk_bf16_f32 v54, v168, v169
    v_sub_f32 v168, v42, v166
    v_sub_f32 v169, v43, v166
    v_exp_f32 v168, v168
    v_exp_f32 v169, v169
    s_nop 0
    v_add_f32 v157, v157, v168
    v_add_f32 v157, v157, v169
    v_cvt_pk_bf16_f32 v55, v168, v169
    s_nop 3
    s_setpc_b64 s[42:43]
L_rarefn_2_1:
    s_nop 15
    v_max3_f32 v166, v36, v37, v38
    v_max3_f32 v166, v166, v39, v40
    v_max3_f32 v166, v166, v41, v42
    v_max_f32 v166, v166, v43
    v_mov_b32 v167, v166
    s_nop 1
    v_permlane32_swap_b32 v166, v167
    v_max_f32 v166, v166, v167
    v_mov_b32 v167, v166
    s_nop 1
    v_permlane16_swap_b32 v166, v167
    v_max3_f32 v166, v166, v167, 0
    v_exp_f32 v167, -v166
    s_nop 0
    v_mul_f32 v154, v157, v167
    v_sub_f32 v16, v16, v166
    v_sub_f32 v17, v17, v166
    v_sub_f32 v18, v18, v166
    v_sub_f32 v19, v19, v166
    v_accvgpr_read_b32 v168, a64
    v_accvgpr_read_b32 v169, a65
    v_accvgpr_read_b32 v170, a66
    v_accvgpr_read_b32 v171, a67
    v_mul_f32 v168, v168, v167
    v_mul_f32 v169, v169, v167
    v_mul_f32 v170, v170, v167
    v_mul_f32 v171, v171, v167
    v_accvgpr_write_b32 a64, v168
    v_accvgpr_write_b32 a65, v169
    v_accvgpr_write_b32 a66, v170
    v_accvgpr_write_b32 a67, v171
    v_accvgpr_read_b32 v168, a68
    v_accvgpr_read_b32 v169, a69
    v_accvgpr_read_b32 v170, a70
    v_accvgpr_read_b32 v171, a71
    v_mul_f32 v168, v168, v167
    v_mul_f32 v169, v169, v167
    v_mul_f32 v170, v170, v167
    v_mul_f32 v171, v171, v167
    v_accvgpr_write_b32 a68, v168
    v_accvgpr_write_b32 a69, v169
    v_accvgpr_write_b32 a70, v170
    v_accvgpr_write_b32 a71, v171
    v_accvgpr_read_b32 v168, a72
    v_accvgpr_read_b32 v169, a73
    v_accvgpr_read_b32 v170, a74
    v_accvgpr_read_b32 v171, a75
    v_mul_f32 v168, v168, v167
    v_mul_f32 v169, v169, v167
    v_mul_f32 v170, v170, v167
    v_mul_f32 v171, v171, v167
    v_accvgpr_write_b32 a72, v168
    v_accvgpr_write_b32 a73, v169
    v_accvgpr_write_b32 a74, v170
    v_accvgpr_write_b32 a75, v171
    v_accvgpr_read_b32 v168, a76
    v_accvgpr_read_b32 v169, a77
    v_accvgpr_read_b32 v170, a78
    v_accvgpr_read_b32 v171, a79
    v_mul_f32 v168, v168, v167
    v_mul_f32 v169, v169, v167
    v_mul_f32 v170, v170, v167
    v_mul_f32 v171, v171, v167
    v_accvgpr_write_b32 a76, v168
    v_accvgpr_write_b32 a77, v169
    v_accvgpr_write_b32 a78, v170
    v_accvgpr_write_b32 a79, v171
    v_accvgpr_read_b32 v168, a80
    v_accvgpr_read_b32 v169, a81
    v_accvgpr_read_b32 v170, a82
    v_accvgpr_read_b32 v171, a83
    v_mul_f32 v168, v168, v167
    v_mul_f32 v169, v169, v167
    v_mul_f32 v170, v170, v167
    v_mul_f32 v171, v171, v167
    v_accvgpr_write_b32 a80, v168
    v_accvgpr_write_b32 a81, v169
    v_accvgpr_write_b32 a82, v170
    v_accvgpr_write_b32 a83, v171
    v_accvgpr_read_b32 v168, a84
    v_accvgpr_read_b32 v169, a85
    v_accvgpr_read_b32 v170, a86
    v_accvgpr_read_b32 v171, a87
    v_mul_f32 v168, v168, v167
    v_mul_f32 v169, v169, v167
    v_mul_f32 v170, v170, v167
    v_mul_f32 v171, v171, v167
    v_accvgpr_write_b32 a84, v168
    v_accvgpr_write_b32 a85, v169
    v_accvgpr_write_b32 a86, v170
    v_accvgpr_write_b32 a87, v171
    v_accvgpr_read_b32 v168, a88
    v_accvgpr_read_b32 v169, a89
    v_accvgpr_read_b32 v170, a90
    v_accvgpr_read_b32 v171, a91
    v_mul_f32 v168, v168, v167
    v_mul_f32 v169, v169, v167
    v_mul_f32 v170, v170, v167
    v_mul_f32 v171, v171, v167
    v_accvgpr_write_b32 a88, v168
    v_accvgpr_write_b32 a89, v169
    v_accvgpr_write_b32 a90, v170
    v_accvgpr_write_b32 a91, v171
    v_accvgpr_read_b32 v168, a92
    v_accvgpr_read_b32 v169, a93
    v_accvgpr_read_b32 v170, a94
    v_accvgpr_read_b32 v171, a95
    v_mul_f32 v168, v168, v167
    v_mul_f32 v169, v169, v167
    v_mul_f32 v170, v170, v167
    v_mul_f32 v171, v171, v167
    v_accvgpr_write_b32 a92, v168
    v_accvgpr_write_b32 a93, v169
    v_accvgpr_write_b32 a94, v170
    v_accvgpr_write_b32 a95, v171
    v_sub_f32 v168, v36, v166
    v_sub_f32 v169, v37, v166
    v_exp_f32 v168, v168
    v_exp_f32 v169, v169
    s_nop 0
    v_add_f32 v154, v154, v168
    v_add_f32 v154, v154, v169
    v_cvt_pk_bf16_f32 v52, v168, v169
    v_sub_f32 v168, v38, v166
    v_sub_f32 v169, v39, v166
    v_exp_f32 v168, v168
    v_exp_f32 v169, v169
    s_nop 0
    v_add_f32 v154, v154, v168
    v_add_f32 v154, v154, v169
    v_cvt_pk_bf16_f32 v53, v168, v169
    v_sub_f32 v168, v40, v166
    v_sub_f32 v169, v41, v166
    v_exp_f32 v168, v168
    v_exp_f32 v169, v169
    s_nop 0
    v_add_f32 v154, v154, v168
    v_add_f32 v154, v154, v169
    v_cvt_pk_bf16_f32 v54, v168, v169
    v_sub_f32 v168, v42, v166
    v_sub_f32 v169, v43, v166
    v_exp_f32 v168, v168
    v_exp_f32 v169, v169
    s_nop 0
    v_add_f32 v154, v154, v168
    v_add_f32 v154, v154, v169
    v_cvt_pk_bf16_f32 v55, v168, v169
    s_nop 3
    s_setpc_b64 s[42:43]
.section .rodata,"a"
.p2align 6
.amdhsa_kernel standalone__gqa_block_cached__near_ridge_kernel
  .amdhsa_next_free_vgpr 512
  .amdhsa_next_free_sgpr 102
  .amdhsa_accum_offset 256
  .amdhsa_group_segment_fixed_size 0
  .amdhsa_kernarg_size 64
  .amdhsa_user_sgpr_count 2
  .amdhsa_user_sgpr_kernarg_segment_ptr 1
  .amdhsa_system_sgpr_workgroup_id_x 1
.end_amdhsa_kernel
```
